```python
import torch

def _softmax(x, axis=-1):
    return torch.softmax(x, dim=axis)
def _gelu(x):
    return torch.nn.functional.gelu(x, approximate="tanh")
def _silu(x):
    return torch.nn.functional.silu(x)
def _sigmoid(x):
    return torch.sigmoid(x)
def _layernorm(x, axis=-1, eps=1e-5):
    m = x.mean(dim=axis, keepdim=True)
    v = x.var(dim=axis, keepdim=True, unbiased=False)
    return (x - m) / torch.sqrt(v + eps)
def _scatter_add(tgt, idx, src, axis=0):
    return tgt.clone().index_add_(axis, idx, src)
def _segment_sum(src, seg, n):
    out = torch.zeros((n,) + src.shape[1:], dtype=src.dtype)
    return out.index_add_(0, seg, src)
def _pad(x, pw):
    flat = tuple(v for pair in reversed(pw) for v in pair)
    return torch.nn.functional.pad(x, flat)

kernel_name = 'sequential_preLN__compressed_kv_cla__glu_gated_glu__prompt'

def setup_inputs():

    _w = (lambda a: (lambda t: t.to(torch.bfloat16) if t.is_floating_point() else t)(torch.as_tensor(a)))
    def _A_setup():
        B, H, Sq, Sk, D, M = 1, 32, 2048, 2048, 128, 512
        Dc = 4 * D
        return {
            "x": _w((lambda *s: torch.randn(*s, dtype=torch.bfloat16) * 0.05)(B, Sq, M)),
            "c_kv": _w((lambda *s: torch.randn(*s, dtype=torch.bfloat16) * 0.4)(B, Sk, Dc)),
            "w_q": _w((lambda *s: torch.randn(*s, dtype=torch.bfloat16) * 3.2)(M, H, D) * (M ** -0.5)),
            "w_uk": _w((lambda *s: torch.randn(*s, dtype=torch.bfloat16) * 3.2)(Dc, H, D) * (Dc ** -0.5)),
            "w_uv": _w((lambda *s: torch.randn(*s, dtype=torch.bfloat16) * 0.4)(Dc, H, D) * (Dc ** -0.5)),
            "w_o": _w((lambda *s: torch.randn(*s, dtype=torch.bfloat16) * 0.4)(H, D, M) * ((H * D) ** -0.5)),
        }
    _A_in = _A_setup()

    def _B_setup():
        B, S, D, F = 1, 2048, 512, 1792
        return {
            "x": _w((lambda *s: torch.randn(*s, dtype=torch.bfloat16) * 0.05)(B, S, D)),
            "w_gate": _w((lambda *s: torch.randn(*s, dtype=torch.bfloat16) * 0.05)(D, F)),
            "w_up": _w((lambda *s: torch.randn(*s, dtype=torch.bfloat16) * 0.05)(D, F)),
            "w_down": _w((lambda *s: torch.randn(*s, dtype=torch.bfloat16) * 0.05)(F, D)),
        }
    _B_in = _B_setup()

    return {
        "A_x": _A_in["x"],
        "A_c_kv": _A_in["c_kv"],
        "A_w_q": _A_in["w_q"],
        "A_w_uk": _A_in["w_uk"],
        "A_w_uv": _A_in["w_uv"],
        "A_w_o": _A_in["w_o"],
        "B_x": _B_in["x"],
        "B_w_gate": _B_in["w_gate"],
        "B_w_up": _B_in["w_up"],
        "B_w_down": _B_in["w_down"],
    }

def reference(A_x, A_c_kv, A_w_q, A_w_uk, A_w_uv, A_w_o, B_x, B_w_gate, B_w_up, B_w_down):
    def _A_ref(x, c_kv, w_q, w_uk, w_uv, w_o):
        B, Sq, M = x.shape[0], x.shape[1], x.shape[2]
        Sk = c_kv.shape[1]
        H, D = w_q.shape[1], w_q.shape[2]
        q = torch.einsum("bqm,mhd->bhqd", x, w_q)
        k = torch.einsum("bkc,chd->bhkd", c_kv, w_uk)
        v = torch.einsum("bkc,chd->bhkd", c_kv, w_uv)
        scores = torch.einsum("bhqd,bhkd->bhqk", q, k) * (D ** -0.5)
        off = Sk - Sq
        qi = torch.arange(Sq)[:, None]
        kj = torch.arange(Sk)[None, :]
        cmask = kj <= (qi + off)
        scores = torch.where(cmask[None, None], scores, -1e9)
        p = _softmax(scores, axis=-1)
        ctx = torch.einsum("bhqk,bhkd->bhqd", p, v)
        return torch.einsum("bhqd,hdm->bqm", ctx, w_o)

    def _B_ref(x, w_gate, w_up, w_down):
        g = torch.einsum("bsd,df->bsf", x, w_gate)
        u = torch.einsum("bsd,df->bsf", x, w_up)
        h = _sigmoid(g) * u
        return torch.einsum("bsf,fd->bsd", h, w_down)

    x = A_x
    h = x + _A_ref(_layernorm(x, axis=-1), A_c_kv, A_w_q, A_w_uk, A_w_uv, A_w_o)
    h2 = h + _B_ref(_layernorm(h, axis=-1), B_w_gate, B_w_up, B_w_down)
    return h2
```

```asm
; @launch kernel=kv_kernel grid=(256,1,1) block=(512,1,1) lds=131072
; @launch kernel=attn_kernel grid=(256,1,1) block=(512,1,1) lds=163840
; @launch kernel=oproj_kernel grid=(256,1,1) block=(512,1,1) lds=163840
; @launch kernel=redln_kernel grid=(512,1,1) block=(256,1,1) lds=0
; @launch kernel=glu_kernel grid=(224,1,1) block=(512,1,1) lds=147456
; @launch kernel=down_kernel grid=(256,1,1) block=(256,1,1) lds=131072
.amdgcn_target "amdgcn-amd-amdhsa--gfx950"
.text
.globl kv_kernel
.p2align 8
.type kv_kernel,@function
kv_kernel:
    s_cmp_ge_u32 s2, 256
    s_cbranch_scc1 L_end_1
    s_load_dwordx4 s[36:39], s[0:1], 0
    s_load_dwordx4 s[40:43], s[0:1], 24
    s_load_dwordx2 s[44:45], s[0:1], 96
    s_and_b32 s46, s2, 7
    s_lshl_b32 s46, s46, 2
    s_bfe_u32 s47, s2, 0x20003
    s_add_u32 s46, s46, s47
    s_lshr_b32 s47, s2, 5
    s_lshl_b32 s47, s47, 8
    s_and_b32 s48, s46, 15
    s_lshl_b32 s48, s48, 8
    s_waitcnt lgkmcnt(0)
    s_mov_b32 s4, s38
    s_mov_b32 s5, s39
    s_mov_b32 s6, 2097152
    s_mov_b32 s7, 0x00020000
    s_cmp_lt_u32 s46, 16
    s_cselect_b32 s8, s40, s42
    s_cselect_b32 s9, s41, s43
    s_mov_b32 s10, 4194304
    s_mov_b32 s11, 0x00020000
    s_mov_b32 s50, 50331648
    s_cselect_b32 s49, 33554432, s50
    s_add_u32 s16, s44, s49
    s_addc_u32 s17, s45, 0
    s_mov_b32 s18, 16777216
    s_mov_b32 s19, 0x00020000
    v_and_b32 v1, 63, v0
    v_lshrrev_b32 v2, 6, v0
    s_nop 0
    v_readfirstlane_b32 s24, v2
    s_nop 3
    s_lshl_b32 s29, s24, 10
    s_and_b32 s30, s24, 1
    s_and_b32 s32, s24, 3
    s_lshr_b32 s33, s24, 2
    s_lshl_b32 s31, s30, 2
    v_lshrrev_b32 v2, 4, v1
    v_add_u32 v2, s31, v2
    v_and_b32 v2, 7, v2
    v_and_b32 v3, 7, v1
    v_xor_b32 v2, v2, v3
    v_lshlrev_b32 v2, 4, v2
    v_lshrrev_b32 v3, 3, v1
    s_mov_b32 s31, 1024
    v_mul_lo_u32 v3, v3, s31
    v_add_u32 v10, v2, v3
    v_lshrrev_b32 v2, 5, v1
    s_lshl_b32 s31, s30, 1
    v_add_u32 v3, s31, v2
    v_and_b32 v3, 3, v3
    v_lshlrev_b32 v3, 2, v3
    v_and_b32 v4, 31, v1
    v_xor_b32 v3, v3, v4
    v_lshlrev_b32 v3, 4, v3
    s_mov_b32 s31, 8192
    v_mul_lo_u32 v2, v2, s31
    v_add_u32 v11, v2, v3
    s_mul_i32 s30, s24, 8
    s_add_u32 s30, s30, s47
    s_mul_i32 s25, s30, 1024
    s_mul_i32 s30, s24, 2
    s_mul_i32 s26, s30, 8192
    s_lshl_b32 s30, s48, 1
    s_add_u32 s26, s26, s30
    s_add_u32 m0, s29, 0
    s_add_u32 s30, s25, 0
    buffer_load_dwordx4 v10, s[4:7], s30 offen lds
    s_add_u32 m0, s29, 8192
    s_add_u32 s30, s25, 65536
    buffer_load_dwordx4 v10, s[4:7], s30 offen lds
    s_add_u32 m0, s29, 16384
    s_add_u32 s30, s25, 131072
    buffer_load_dwordx4 v10, s[4:7], s30 offen lds
    s_add_u32 m0, s29, 24576
    s_add_u32 s30, s25, 196608
    buffer_load_dwordx4 v10, s[4:7], s30 offen lds
    s_add_u32 s25, s25, 128
    s_add_u32 m0, s29, 32768
    s_add_u32 s30, s26, 0
    buffer_load_dwordx4 v11, s[8:11], s30 offen lds
    s_add_u32 m0, s29, 40960
    s_add_u32 s30, s26, 131072
    buffer_load_dwordx4 v11, s[8:11], s30 offen lds
    s_add_u32 m0, s29, 49152
    s_add_u32 s30, s26, 262144
    buffer_load_dwordx4 v11, s[8:11], s30 offen lds
    s_add_u32 m0, s29, 57344
    s_add_u32 s30, s26, 393216
    buffer_load_dwordx4 v11, s[8:11], s30 offen lds
    s_add_u32 s26, s26, 524288
    s_mov_b32 s52, s36
    s_mov_b32 s53, s37
    s_mov_b32 s54, 2097152
    s_mov_b32 s55, 0x00020000
    s_mov_b32 s56, s44
    s_mov_b32 s57, s45
    s_mov_b32 s58, 2097152
    s_mov_b32 s59, 0x00020000
    s_lshl_b32 s60, s2, 3
    s_add_u32 s60, s60, s24
    s_lshl_b32 s60, s60, 10
    v_lshlrev_b32 v200, 4, v1
    buffer_load_dwordx4 v[196:199], v200, s[52:55], s60 offen
    v_and_b32 v2, 31, v1
    s_mul_i32 s30, s32, 64
    v_add_u32 v2, s30, v2
    v_bfe_u32 v3, v2, 1, 3
    v_lshrrev_b32 v4, 5, v1
    v_xor_b32 v3, v3, v4
    v_lshlrev_b32 v2, 7, v2
    v_xor_b32 v5, 0, v3
    v_lshl_add_u32 v16, v5, 4, v2
    v_xor_b32 v5, 2, v3
    v_lshl_add_u32 v17, v5, 4, v2
    v_xor_b32 v5, 4, v3
    v_lshl_add_u32 v18, v5, 4, v2
    v_xor_b32 v5, 6, v3
    v_lshl_add_u32 v19, v5, 4, v2
    v_and_b32 v2, 15, v1
    v_lshrrev_b32 v3, 2, v2
    v_and_b32 v4, 3, v2
    v_lshrrev_b32 v5, 5, v1
    v_lshl_add_u32 v5, v5, 3, v3
    v_lshlrev_b32 v5, 9, v5
    v_and_b32 v6, 1, v4
    v_lshl_add_u32 v5, v6, 3, v5
    v_lshrrev_b32 v6, 1, v4
    v_bfe_u32 v7, v1, 4, 1
    v_lshl_add_u32 v6, v7, 1, v6
    v_lshl_add_u32 v5, v6, 4, v5
    s_mul_i32 s30, s33, 4
    s_add_u32 s30, s30, 0
    v_xor_b32 v6, s30, v3
    v_lshl_add_u32 v6, v6, 6, v5
    v_add_u32 v12, 32768, v6
    s_mul_i32 s30, s33, 4
    s_add_u32 s30, s30, 1
    v_xor_b32 v6, s30, v3
    v_lshl_add_u32 v6, v6, 6, v5
    v_add_u32 v13, 32768, v6
    s_mul_i32 s30, s33, 4
    s_add_u32 s30, s30, 2
    v_xor_b32 v6, s30, v3
    v_lshl_add_u32 v6, v6, 6, v5
    v_add_u32 v14, 32768, v6
    s_mul_i32 s30, s33, 4
    s_add_u32 s30, s30, 3
    v_xor_b32 v6, s30, v3
    v_lshl_add_u32 v6, v6, 6, v5
    v_add_u32 v15, 32768, v6
    s_waitcnt vmcnt(0)
    s_barrier
    ds_read_b64_tr_b16 v[20:21], v12 offset:0
    ds_read_b64_tr_b16 v[22:23], v12 offset:2048
    ds_read_b64_tr_b16 v[24:25], v13 offset:0
    ds_read_b64_tr_b16 v[26:27], v13 offset:2048
    ds_read_b64_tr_b16 v[28:29], v14 offset:0
    ds_read_b64_tr_b16 v[30:31], v14 offset:2048
    ds_read_b64_tr_b16 v[32:33], v15 offset:0
    ds_read_b64_tr_b16 v[34:35], v15 offset:2048
    ds_read_b128 v[52:55], v16 offset:0
    ds_read_b128 v[56:59], v16 offset:4096
    ds_read_b64_tr_b16 v[36:37], v12 offset:8192
    ds_read_b64_tr_b16 v[38:39], v12 offset:10240
    ds_read_b64_tr_b16 v[40:41], v13 offset:8192
    ds_read_b64_tr_b16 v[42:43], v13 offset:10240
    ds_read_b64_tr_b16 v[44:45], v14 offset:8192
    ds_read_b64_tr_b16 v[46:47], v14 offset:10240
    ds_read_b64_tr_b16 v[48:49], v15 offset:8192
    ds_read_b64_tr_b16 v[50:51], v15 offset:10240
    ds_read_b128 v[60:63], v17 offset:0
    ds_read_b128 v[64:67], v17 offset:4096
    s_waitcnt lgkmcnt(10)
    v_mfma_f32_32x32x16_bf16 v[68:83], v[20:23], v[52:55], 0
    s_add_u32 m0, s29, 65536
    s_add_u32 s30, s25, 0
    buffer_load_dwordx4 v10, s[4:7], s30 offen lds
    v_mfma_f32_32x32x16_bf16 v[84:99], v[20:23], v[56:59], 0
    s_add_u32 m0, s29, 73728
    s_add_u32 s30, s25, 65536
    buffer_load_dwordx4 v10, s[4:7], s30 offen lds
    v_mfma_f32_32x32x16_bf16 v[100:115], v[24:27], v[52:55], 0
    s_add_u32 m0, s29, 81920
    s_add_u32 s30, s25, 131072
    buffer_load_dwordx4 v10, s[4:7], s30 offen lds
    v_mfma_f32_32x32x16_bf16 v[116:131], v[24:27], v[56:59], 0
    s_add_u32 m0, s29, 90112
    s_add_u32 s30, s25, 196608
    buffer_load_dwordx4 v10, s[4:7], s30 offen lds
    s_add_u32 s25, s25, 128
    v_mfma_f32_32x32x16_bf16 v[132:147], v[28:31], v[52:55], 0
    s_add_u32 m0, s29, 98304
    s_add_u32 s30, s26, 0
    buffer_load_dwordx4 v11, s[8:11], s30 offen lds
    v_mfma_f32_32x32x16_bf16 v[148:163], v[28:31], v[56:59], 0
    s_add_u32 m0, s29, 106496
    s_add_u32 s30, s26, 131072
    buffer_load_dwordx4 v11, s[8:11], s30 offen lds
    v_mfma_f32_32x32x16_bf16 v[164:179], v[32:35], v[52:55], 0
    s_add_u32 m0, s29, 114688
    s_add_u32 s30, s26, 262144
    buffer_load_dwordx4 v11, s[8:11], s30 offen lds
    v_mfma_f32_32x32x16_bf16 v[180:195], v[32:35], v[56:59], 0
    s_add_u32 m0, s29, 122880
    s_add_u32 s30, s26, 393216
    buffer_load_dwordx4 v11, s[8:11], s30 offen lds
    s_add_u32 s26, s26, 524288
    ds_read_b64_tr_b16 v[20:21], v12 offset:16384
    ds_read_b64_tr_b16 v[22:23], v12 offset:18432
    ds_read_b64_tr_b16 v[24:25], v13 offset:16384
    ds_read_b64_tr_b16 v[26:27], v13 offset:18432
    ds_read_b64_tr_b16 v[28:29], v14 offset:16384
    ds_read_b64_tr_b16 v[30:31], v14 offset:18432
    ds_read_b64_tr_b16 v[32:33], v15 offset:16384
    ds_read_b64_tr_b16 v[34:35], v15 offset:18432
    ds_read_b128 v[52:55], v18 offset:0
    ds_read_b128 v[56:59], v18 offset:4096
    s_waitcnt lgkmcnt(10)
    v_mfma_f32_32x32x16_bf16 v[68:83], v[36:39], v[60:63], v[68:83]
    v_mfma_f32_32x32x16_bf16 v[84:99], v[36:39], v[64:67], v[84:99]
    v_mfma_f32_32x32x16_bf16 v[100:115], v[40:43], v[60:63], v[100:115]
    v_mfma_f32_32x32x16_bf16 v[116:131], v[40:43], v[64:67], v[116:131]
    v_mfma_f32_32x32x16_bf16 v[132:147], v[44:47], v[60:63], v[132:147]
    v_mfma_f32_32x32x16_bf16 v[148:163], v[44:47], v[64:67], v[148:163]
    v_mfma_f32_32x32x16_bf16 v[164:179], v[48:51], v[60:63], v[164:179]
    v_mfma_f32_32x32x16_bf16 v[180:195], v[48:51], v[64:67], v[180:195]
    ds_read_b64_tr_b16 v[36:37], v12 offset:24576
    ds_read_b64_tr_b16 v[38:39], v12 offset:26624
    ds_read_b64_tr_b16 v[40:41], v13 offset:24576
    ds_read_b64_tr_b16 v[42:43], v13 offset:26624
    ds_read_b64_tr_b16 v[44:45], v14 offset:24576
    ds_read_b64_tr_b16 v[46:47], v14 offset:26624
    ds_read_b64_tr_b16 v[48:49], v15 offset:24576
    ds_read_b64_tr_b16 v[50:51], v15 offset:26624
    ds_read_b128 v[60:63], v19 offset:0
    ds_read_b128 v[64:67], v19 offset:4096
    s_waitcnt lgkmcnt(10)
    v_mfma_f32_32x32x16_bf16 v[68:83], v[20:23], v[52:55], v[68:83]
    v_mfma_f32_32x32x16_bf16 v[84:99], v[20:23], v[56:59], v[84:99]
    v_mfma_f32_32x32x16_bf16 v[100:115], v[24:27], v[52:55], v[100:115]
    v_mfma_f32_32x32x16_bf16 v[116:131], v[24:27], v[56:59], v[116:131]
    v_mfma_f32_32x32x16_bf16 v[132:147], v[28:31], v[52:55], v[132:147]
    v_mfma_f32_32x32x16_bf16 v[148:163], v[28:31], v[56:59], v[148:163]
    v_mfma_f32_32x32x16_bf16 v[164:179], v[32:35], v[52:55], v[164:179]
    v_mfma_f32_32x32x16_bf16 v[180:195], v[32:35], v[56:59], v[180:195]
    s_waitcnt lgkmcnt(0)
    v_add_u32 v12, 65536, v12
    v_add_u32 v13, 65536, v13
    v_add_u32 v14, 65536, v14
    v_add_u32 v15, 65536, v15
    v_add_u32 v16, 65536, v16
    v_add_u32 v17, 65536, v17
    v_add_u32 v18, 65536, v18
    v_add_u32 v19, 65536, v19
    v_mfma_f32_32x32x16_bf16 v[68:83], v[36:39], v[60:63], v[68:83]
    v_mfma_f32_32x32x16_bf16 v[84:99], v[36:39], v[64:67], v[84:99]
    v_mfma_f32_32x32x16_bf16 v[100:115], v[40:43], v[60:63], v[100:115]
    v_mfma_f32_32x32x16_bf16 v[116:131], v[40:43], v[64:67], v[116:131]
    s_waitcnt vmcnt(0)
    s_barrier
    ds_read_b64_tr_b16 v[20:21], v12 offset:0
    ds_read_b64_tr_b16 v[22:23], v12 offset:2048
    ds_read_b64_tr_b16 v[24:25], v13 offset:0
    ds_read_b64_tr_b16 v[26:27], v13 offset:2048
    ds_read_b64_tr_b16 v[28:29], v14 offset:0
    ds_read_b64_tr_b16 v[30:31], v14 offset:2048
    ds_read_b64_tr_b16 v[32:33], v15 offset:0
    ds_read_b64_tr_b16 v[34:35], v15 offset:2048
    ds_read_b128 v[52:55], v16 offset:0
    ds_read_b128 v[56:59], v16 offset:4096
    v_mfma_f32_32x32x16_bf16 v[132:147], v[44:47], v[60:63], v[132:147]
    v_mfma_f32_32x32x16_bf16 v[148:163], v[44:47], v[64:67], v[148:163]
    v_mfma_f32_32x32x16_bf16 v[164:179], v[48:51], v[60:63], v[164:179]
    v_mfma_f32_32x32x16_bf16 v[180:195], v[48:51], v[64:67], v[180:195]
    ds_read_b64_tr_b16 v[36:37], v12 offset:8192
    ds_read_b64_tr_b16 v[38:39], v12 offset:10240
    ds_read_b64_tr_b16 v[40:41], v13 offset:8192
    ds_read_b64_tr_b16 v[42:43], v13 offset:10240
    ds_read_b64_tr_b16 v[44:45], v14 offset:8192
    ds_read_b64_tr_b16 v[46:47], v14 offset:10240
    ds_read_b64_tr_b16 v[48:49], v15 offset:8192
    ds_read_b64_tr_b16 v[50:51], v15 offset:10240
    ds_read_b128 v[60:63], v17 offset:0
    ds_read_b128 v[64:67], v17 offset:4096
    s_waitcnt lgkmcnt(10)
    v_mfma_f32_32x32x16_bf16 v[68:83], v[20:23], v[52:55], v[68:83]
    s_add_u32 m0, s29, 0
    s_add_u32 s30, s25, 0
    buffer_load_dwordx4 v10, s[4:7], s30 offen lds
    v_mfma_f32_32x32x16_bf16 v[84:99], v[20:23], v[56:59], v[84:99]
    s_add_u32 m0, s29, 8192
    s_add_u32 s30, s25, 65536
    buffer_load_dwordx4 v10, s[4:7], s30 offen lds
    v_mfma_f32_32x32x16_bf16 v[100:115], v[24:27], v[52:55], v[100:115]
    s_add_u32 m0, s29, 16384
    s_add_u32 s30, s25, 131072
    buffer_load_dwordx4 v10, s[4:7], s30 offen lds
    v_mfma_f32_32x32x16_bf16 v[116:131], v[24:27], v[56:59], v[116:131]
    s_add_u32 m0, s29, 24576
    s_add_u32 s30, s25, 196608
    buffer_load_dwordx4 v10, s[4:7], s30 offen lds
    s_add_u32 s25, s25, 128
    v_mfma_f32_32x32x16_bf16 v[132:147], v[28:31], v[52:55], v[132:147]
    s_add_u32 m0, s29, 32768
    s_add_u32 s30, s26, 0
    buffer_load_dwordx4 v11, s[8:11], s30 offen lds
    v_mfma_f32_32x32x16_bf16 v[148:163], v[28:31], v[56:59], v[148:163]
    s_add_u32 m0, s29, 40960
    s_add_u32 s30, s26, 131072
    buffer_load_dwordx4 v11, s[8:11], s30 offen lds
    v_mfma_f32_32x32x16_bf16 v[164:179], v[32:35], v[52:55], v[164:179]
    s_add_u32 m0, s29, 49152
    s_add_u32 s30, s26, 262144
    buffer_load_dwordx4 v11, s[8:11], s30 offen lds
    v_mfma_f32_32x32x16_bf16 v[180:195], v[32:35], v[56:59], v[180:195]
    s_add_u32 m0, s29, 57344
    s_add_u32 s30, s26, 393216
    buffer_load_dwordx4 v11, s[8:11], s30 offen lds
    s_add_u32 s26, s26, 524288
    ds_read_b64_tr_b16 v[20:21], v12 offset:16384
    ds_read_b64_tr_b16 v[22:23], v12 offset:18432
    ds_read_b64_tr_b16 v[24:25], v13 offset:16384
    ds_read_b64_tr_b16 v[26:27], v13 offset:18432
    ds_read_b64_tr_b16 v[28:29], v14 offset:16384
    ds_read_b64_tr_b16 v[30:31], v14 offset:18432
    ds_read_b64_tr_b16 v[32:33], v15 offset:16384
    ds_read_b64_tr_b16 v[34:35], v15 offset:18432
    ds_read_b128 v[52:55], v18 offset:0
    ds_read_b128 v[56:59], v18 offset:4096
    s_waitcnt lgkmcnt(10)
    v_mfma_f32_32x32x16_bf16 v[68:83], v[36:39], v[60:63], v[68:83]
    v_mfma_f32_32x32x16_bf16 v[84:99], v[36:39], v[64:67], v[84:99]
    v_mfma_f32_32x32x16_bf16 v[100:115], v[40:43], v[60:63], v[100:115]
    v_mfma_f32_32x32x16_bf16 v[116:131], v[40:43], v[64:67], v[116:131]
    v_mfma_f32_32x32x16_bf16 v[132:147], v[44:47], v[60:63], v[132:147]
    v_mfma_f32_32x32x16_bf16 v[148:163], v[44:47], v[64:67], v[148:163]
    v_mfma_f32_32x32x16_bf16 v[164:179], v[48:51], v[60:63], v[164:179]
    v_mfma_f32_32x32x16_bf16 v[180:195], v[48:51], v[64:67], v[180:195]
    ds_read_b64_tr_b16 v[36:37], v12 offset:24576
    ds_read_b64_tr_b16 v[38:39], v12 offset:26624
    ds_read_b64_tr_b16 v[40:41], v13 offset:24576
    ds_read_b64_tr_b16 v[42:43], v13 offset:26624
    ds_read_b64_tr_b16 v[44:45], v14 offset:24576
    ds_read_b64_tr_b16 v[46:47], v14 offset:26624
    ds_read_b64_tr_b16 v[48:49], v15 offset:24576
    ds_read_b64_tr_b16 v[50:51], v15 offset:26624
    ds_read_b128 v[60:63], v19 offset:0
    ds_read_b128 v[64:67], v19 offset:4096
    s_waitcnt lgkmcnt(10)
    v_mfma_f32_32x32x16_bf16 v[68:83], v[20:23], v[52:55], v[68:83]
    v_mfma_f32_32x32x16_bf16 v[84:99], v[20:23], v[56:59], v[84:99]
    v_mfma_f32_32x32x16_bf16 v[100:115], v[24:27], v[52:55], v[100:115]
    v_mfma_f32_32x32x16_bf16 v[116:131], v[24:27], v[56:59], v[116:131]
    v_mfma_f32_32x32x16_bf16 v[132:147], v[28:31], v[52:55], v[132:147]
    v_mfma_f32_32x32x16_bf16 v[148:163], v[28:31], v[56:59], v[148:163]
    v_mfma_f32_32x32x16_bf16 v[164:179], v[32:35], v[52:55], v[164:179]
    v_mfma_f32_32x32x16_bf16 v[180:195], v[32:35], v[56:59], v[180:195]
    s_waitcnt lgkmcnt(0)
    v_add_u32 v12, 4294901760, v12
    v_add_u32 v13, 4294901760, v13
    v_add_u32 v14, 4294901760, v14
    v_add_u32 v15, 4294901760, v15
    v_add_u32 v16, 4294901760, v16
    v_add_u32 v17, 4294901760, v17
    v_add_u32 v18, 4294901760, v18
    v_add_u32 v19, 4294901760, v19
    v_mfma_f32_32x32x16_bf16 v[68:83], v[36:39], v[60:63], v[68:83]
    v_mfma_f32_32x32x16_bf16 v[84:99], v[36:39], v[64:67], v[84:99]
    v_mfma_f32_32x32x16_bf16 v[100:115], v[40:43], v[60:63], v[100:115]
    v_mfma_f32_32x32x16_bf16 v[116:131], v[40:43], v[64:67], v[116:131]
    s_waitcnt vmcnt(0)
    s_barrier
    ds_read_b64_tr_b16 v[20:21], v12 offset:0
    ds_read_b64_tr_b16 v[22:23], v12 offset:2048
    ds_read_b64_tr_b16 v[24:25], v13 offset:0
    ds_read_b64_tr_b16 v[26:27], v13 offset:2048
    ds_read_b64_tr_b16 v[28:29], v14 offset:0
    ds_read_b64_tr_b16 v[30:31], v14 offset:2048
    ds_read_b64_tr_b16 v[32:33], v15 offset:0
    ds_read_b64_tr_b16 v[34:35], v15 offset:2048
    ds_read_b128 v[52:55], v16 offset:0
    ds_read_b128 v[56:59], v16 offset:4096
    v_mfma_f32_32x32x16_bf16 v[132:147], v[44:47], v[60:63], v[132:147]
    v_mfma_f32_32x32x16_bf16 v[148:163], v[44:47], v[64:67], v[148:163]
    v_mfma_f32_32x32x16_bf16 v[164:179], v[48:51], v[60:63], v[164:179]
    v_mfma_f32_32x32x16_bf16 v[180:195], v[48:51], v[64:67], v[180:195]
    ds_read_b64_tr_b16 v[36:37], v12 offset:8192
    ds_read_b64_tr_b16 v[38:39], v12 offset:10240
    ds_read_b64_tr_b16 v[40:41], v13 offset:8192
    ds_read_b64_tr_b16 v[42:43], v13 offset:10240
    ds_read_b64_tr_b16 v[44:45], v14 offset:8192
    ds_read_b64_tr_b16 v[46:47], v14 offset:10240
    ds_read_b64_tr_b16 v[48:49], v15 offset:8192
    ds_read_b64_tr_b16 v[50:51], v15 offset:10240
    ds_read_b128 v[60:63], v17 offset:0
    ds_read_b128 v[64:67], v17 offset:4096
    s_waitcnt lgkmcnt(10)
    v_mfma_f32_32x32x16_bf16 v[68:83], v[20:23], v[52:55], v[68:83]
    s_add_u32 m0, s29, 65536
    s_add_u32 s30, s25, 0
    buffer_load_dwordx4 v10, s[4:7], s30 offen lds
    v_mfma_f32_32x32x16_bf16 v[84:99], v[20:23], v[56:59], v[84:99]
    s_add_u32 m0, s29, 73728
    s_add_u32 s30, s25, 65536
    buffer_load_dwordx4 v10, s[4:7], s30 offen lds
    v_mfma_f32_32x32x16_bf16 v[100:115], v[24:27], v[52:55], v[100:115]
    s_add_u32 m0, s29, 81920
    s_add_u32 s30, s25, 131072
    buffer_load_dwordx4 v10, s[4:7], s30 offen lds
    v_mfma_f32_32x32x16_bf16 v[116:131], v[24:27], v[56:59], v[116:131]
    s_add_u32 m0, s29, 90112
    s_add_u32 s30, s25, 196608
    buffer_load_dwordx4 v10, s[4:7], s30 offen lds
    s_add_u32 s25, s25, 128
    v_mfma_f32_32x32x16_bf16 v[132:147], v[28:31], v[52:55], v[132:147]
    s_add_u32 m0, s29, 98304
    s_add_u32 s30, s26, 0
    buffer_load_dwordx4 v11, s[8:11], s30 offen lds
    v_mfma_f32_32x32x16_bf16 v[148:163], v[28:31], v[56:59], v[148:163]
    s_add_u32 m0, s29, 106496
    s_add_u32 s30, s26, 131072
    buffer_load_dwordx4 v11, s[8:11], s30 offen lds
    v_mfma_f32_32x32x16_bf16 v[164:179], v[32:35], v[52:55], v[164:179]
    s_add_u32 m0, s29, 114688
    s_add_u32 s30, s26, 262144
    buffer_load_dwordx4 v11, s[8:11], s30 offen lds
    v_mfma_f32_32x32x16_bf16 v[180:195], v[32:35], v[56:59], v[180:195]
    s_add_u32 m0, s29, 122880
    s_add_u32 s30, s26, 393216
    buffer_load_dwordx4 v11, s[8:11], s30 offen lds
    s_add_u32 s26, s26, 524288
    ds_read_b64_tr_b16 v[20:21], v12 offset:16384
    ds_read_b64_tr_b16 v[22:23], v12 offset:18432
    ds_read_b64_tr_b16 v[24:25], v13 offset:16384
    ds_read_b64_tr_b16 v[26:27], v13 offset:18432
    ds_read_b64_tr_b16 v[28:29], v14 offset:16384
    ds_read_b64_tr_b16 v[30:31], v14 offset:18432
    ds_read_b64_tr_b16 v[32:33], v15 offset:16384
    ds_read_b64_tr_b16 v[34:35], v15 offset:18432
    ds_read_b128 v[52:55], v18 offset:0
    ds_read_b128 v[56:59], v18 offset:4096
    s_waitcnt lgkmcnt(10)
    v_mfma_f32_32x32x16_bf16 v[68:83], v[36:39], v[60:63], v[68:83]
    v_lshlrev_b32 v204, 16, v196
    v_and_b32 v205, 0xffff0000, v196
    v_lshlrev_b32 v206, 16, v197
    v_mfma_f32_32x32x16_bf16 v[84:99], v[36:39], v[64:67], v[84:99]
    v_and_b32 v207, 0xffff0000, v197
    v_lshlrev_b32 v208, 16, v198
    v_and_b32 v209, 0xffff0000, v198
    v_mfma_f32_32x32x16_bf16 v[100:115], v[40:43], v[60:63], v[100:115]
    v_lshlrev_b32 v210, 16, v199
    v_and_b32 v211, 0xffff0000, v199
    v_add_f32 v212, v204, v205
    v_mfma_f32_32x32x16_bf16 v[116:131], v[40:43], v[64:67], v[116:131]
    v_add_f32 v212, v212, v206
    v_add_f32 v212, v212, v207
    v_add_f32 v212, v212, v208
    v_mfma_f32_32x32x16_bf16 v[132:147], v[44:47], v[60:63], v[132:147]
    v_add_f32 v212, v212, v209
    v_add_f32 v212, v212, v210
    v_add_f32 v212, v212, v211
    v_mfma_f32_32x32x16_bf16 v[148:163], v[44:47], v[64:67], v[148:163]
    s_nop 1
    v_add_f32_dpp v213, v212, v212 quad_perm:[1,0,3,2] row_mask:0xf bank_mask:0xf
    s_nop 1
    v_mfma_f32_32x32x16_bf16 v[164:179], v[48:51], v[60:63], v[164:179]
    v_add_f32_dpp v212, v213, v213 quad_perm:[2,3,0,1] row_mask:0xf bank_mask:0xf
    s_nop 1
    v_add_f32_dpp v213, v212, v212 row_half_mirror row_mask:0xf bank_mask:0xf
    v_mfma_f32_32x32x16_bf16 v[180:195], v[48:51], v[64:67], v[180:195]
    s_nop 1
    v_add_f32_dpp v212, v213, v213 row_mirror row_mask:0xf bank_mask:0xf
    s_nop 1
    ds_read_b64_tr_b16 v[36:37], v12 offset:24576
    ds_read_b64_tr_b16 v[38:39], v12 offset:26624
    ds_read_b64_tr_b16 v[40:41], v13 offset:24576
    ds_read_b64_tr_b16 v[42:43], v13 offset:26624
    ds_read_b64_tr_b16 v[44:45], v14 offset:24576
    ds_read_b64_tr_b16 v[46:47], v14 offset:26624
    ds_read_b64_tr_b16 v[48:49], v15 offset:24576
    ds_read_b64_tr_b16 v[50:51], v15 offset:26624
    ds_read_b128 v[60:63], v19 offset:0
    ds_read_b128 v[64:67], v19 offset:4096
    s_waitcnt lgkmcnt(10)
    v_mfma_f32_32x32x16_bf16 v[68:83], v[20:23], v[52:55], v[68:83]
    v_readlane_b32 s64, v212, 0
    v_readlane_b32 s65, v212, 16
    v_readlane_b32 s66, v212, 32
    v_mfma_f32_32x32x16_bf16 v[84:99], v[20:23], v[56:59], v[84:99]
    v_readlane_b32 s67, v212, 48
    s_nop 1
    v_mov_b32 v212, s64
    v_mfma_f32_32x32x16_bf16 v[100:115], v[24:27], v[52:55], v[100:115]
    v_add_f32 v212, s65, v212
    v_add_f32 v212, s66, v212
    v_add_f32 v212, s67, v212
    v_mfma_f32_32x32x16_bf16 v[116:131], v[24:27], v[56:59], v[116:131]
    v_mul_f32 v214, 0x3b000000, v212
    v_sub_f32 v213, v204, v214
    v_mul_f32 v212, v213, v213
    v_mfma_f32_32x32x16_bf16 v[132:147], v[28:31], v[52:55], v[132:147]
    v_sub_f32 v213, v205, v214
    v_fmac_f32 v212, v213, v213
    v_sub_f32 v213, v206, v214
    v_mfma_f32_32x32x16_bf16 v[148:163], v[28:31], v[56:59], v[148:163]
    v_fmac_f32 v212, v213, v213
    v_sub_f32 v213, v207, v214
    v_fmac_f32 v212, v213, v213
    v_mfma_f32_32x32x16_bf16 v[164:179], v[32:35], v[52:55], v[164:179]
    v_sub_f32 v213, v208, v214
    v_fmac_f32 v212, v213, v213
    v_sub_f32 v213, v209, v214
    v_mfma_f32_32x32x16_bf16 v[180:195], v[32:35], v[56:59], v[180:195]
    v_fmac_f32 v212, v213, v213
    v_sub_f32 v213, v210, v214
    v_fmac_f32 v212, v213, v213
    s_waitcnt lgkmcnt(0)
    v_add_u32 v12, 65536, v12
    v_add_u32 v13, 65536, v13
    v_add_u32 v14, 65536, v14
    v_add_u32 v15, 65536, v15
    v_add_u32 v16, 65536, v16
    v_add_u32 v17, 65536, v17
    v_add_u32 v18, 65536, v18
    v_add_u32 v19, 65536, v19
    v_mfma_f32_32x32x16_bf16 v[68:83], v[36:39], v[60:63], v[68:83]
    v_sub_f32 v213, v211, v214
    v_fmac_f32 v212, v213, v213
    s_nop 1
    v_mfma_f32_32x32x16_bf16 v[84:99], v[36:39], v[64:67], v[84:99]
    v_add_f32_dpp v213, v212, v212 quad_perm:[1,0,3,2] row_mask:0xf bank_mask:0xf
    s_nop 1
    v_add_f32_dpp v212, v213, v213 quad_perm:[2,3,0,1] row_mask:0xf bank_mask:0xf
    v_mfma_f32_32x32x16_bf16 v[100:115], v[40:43], v[60:63], v[100:115]
    s_nop 1
    v_add_f32_dpp v213, v212, v212 row_half_mirror row_mask:0xf bank_mask:0xf
    s_nop 1
    v_mfma_f32_32x32x16_bf16 v[116:131], v[40:43], v[64:67], v[116:131]
    v_add_f32_dpp v212, v213, v213 row_mirror row_mask:0xf bank_mask:0xf
    s_nop 1
    v_readlane_b32 s64, v212, 0
    s_waitcnt vmcnt(0)
    s_barrier
    ds_read_b64_tr_b16 v[20:21], v12 offset:0
    ds_read_b64_tr_b16 v[22:23], v12 offset:2048
    ds_read_b64_tr_b16 v[24:25], v13 offset:0
    ds_read_b64_tr_b16 v[26:27], v13 offset:2048
    ds_read_b64_tr_b16 v[28:29], v14 offset:0
    ds_read_b64_tr_b16 v[30:31], v14 offset:2048
    ds_read_b64_tr_b16 v[32:33], v15 offset:0
    ds_read_b64_tr_b16 v[34:35], v15 offset:2048
    ds_read_b128 v[52:55], v16 offset:0
    ds_read_b128 v[56:59], v16 offset:4096
    v_mfma_f32_32x32x16_bf16 v[132:147], v[44:47], v[60:63], v[132:147]
    v_readlane_b32 s65, v212, 16
    v_readlane_b32 s66, v212, 32
    v_readlane_b32 s67, v212, 48
    v_mfma_f32_32x32x16_bf16 v[148:163], v[44:47], v[64:67], v[148:163]
    s_nop 1
    v_mov_b32 v212, s64
    v_add_f32 v212, s65, v212
    v_mfma_f32_32x32x16_bf16 v[164:179], v[48:51], v[60:63], v[164:179]
    v_add_f32 v212, s66, v212
    v_add_f32 v212, s67, v212
    v_mul_f32 v212, 0x3b000000, v212
    v_mfma_f32_32x32x16_bf16 v[180:195], v[48:51], v[64:67], v[180:195]
    v_cvt_pk_bf16_f32 v213, v214, v212
    v_lshlrev_b32 v214, 16, v213
    v_and_b32 v212, 0xffff0000, v213
    ds_read_b64_tr_b16 v[36:37], v12 offset:8192
    ds_read_b64_tr_b16 v[38:39], v12 offset:10240
    ds_read_b64_tr_b16 v[40:41], v13 offset:8192
    ds_read_b64_tr_b16 v[42:43], v13 offset:10240
    ds_read_b64_tr_b16 v[44:45], v14 offset:8192
    ds_read_b64_tr_b16 v[46:47], v14 offset:10240
    ds_read_b64_tr_b16 v[48:49], v15 offset:8192
    ds_read_b64_tr_b16 v[50:51], v15 offset:10240
    ds_read_b128 v[60:63], v17 offset:0
    ds_read_b128 v[64:67], v17 offset:4096
    s_waitcnt lgkmcnt(10)
    v_mfma_f32_32x32x16_bf16 v[68:83], v[20:23], v[52:55], v[68:83]
    s_add_u32 m0, s29, 0
    s_add_u32 s30, s25, 0
    buffer_load_dwordx4 v10, s[4:7], s30 offen lds
    v_mfma_f32_32x32x16_bf16 v[84:99], v[20:23], v[56:59], v[84:99]
    s_add_u32 m0, s29, 8192
    s_add_u32 s30, s25, 65536
    buffer_load_dwordx4 v10, s[4:7], s30 offen lds
    v_mfma_f32_32x32x16_bf16 v[100:115], v[24:27], v[52:55], v[100:115]
    s_add_u32 m0, s29, 16384
    s_add_u32 s30, s25, 131072
    buffer_load_dwordx4 v10, s[4:7], s30 offen lds
    v_mfma_f32_32x32x16_bf16 v[116:131], v[24:27], v[56:59], v[116:131]
    s_add_u32 m0, s29, 24576
    s_add_u32 s30, s25, 196608
    buffer_load_dwordx4 v10, s[4:7], s30 offen lds
    s_add_u32 s25, s25, 128
    v_mfma_f32_32x32x16_bf16 v[132:147], v[28:31], v[52:55], v[132:147]
    s_add_u32 m0, s29, 32768
    s_add_u32 s30, s26, 0
    buffer_load_dwordx4 v11, s[8:11], s30 offen lds
    v_mfma_f32_32x32x16_bf16 v[148:163], v[28:31], v[56:59], v[148:163]
    s_add_u32 m0, s29, 40960
    s_add_u32 s30, s26, 131072
    buffer_load_dwordx4 v11, s[8:11], s30 offen lds
    v_mfma_f32_32x32x16_bf16 v[164:179], v[32:35], v[52:55], v[164:179]
    s_add_u32 m0, s29, 49152
    s_add_u32 s30, s26, 262144
    buffer_load_dwordx4 v11, s[8:11], s30 offen lds
    v_mfma_f32_32x32x16_bf16 v[180:195], v[32:35], v[56:59], v[180:195]
    s_add_u32 m0, s29, 57344
    s_add_u32 s30, s26, 393216
    buffer_load_dwordx4 v11, s[8:11], s30 offen lds
    s_add_u32 s26, s26, 524288
    ds_read_b64_tr_b16 v[20:21], v12 offset:16384
    ds_read_b64_tr_b16 v[22:23], v12 offset:18432
    ds_read_b64_tr_b16 v[24:25], v13 offset:16384
    ds_read_b64_tr_b16 v[26:27], v13 offset:18432
    ds_read_b64_tr_b16 v[28:29], v14 offset:16384
    ds_read_b64_tr_b16 v[30:31], v14 offset:18432
    ds_read_b64_tr_b16 v[32:33], v15 offset:16384
    ds_read_b64_tr_b16 v[34:35], v15 offset:18432
    ds_read_b128 v[52:55], v18 offset:0
    ds_read_b128 v[56:59], v18 offset:4096
    s_waitcnt lgkmcnt(10)
    v_mfma_f32_32x32x16_bf16 v[68:83], v[36:39], v[60:63], v[68:83]
    v_add_f32 v212, 0x3727c5ac, v212
    v_cvt_pk_bf16_f32 v213, v212, v212
    v_lshlrev_b32 v212, 16, v213
    v_mfma_f32_32x32x16_bf16 v[84:99], v[36:39], v[64:67], v[84:99]
    v_sqrt_f32 v212, v212
    s_nop 0
    v_cvt_pk_bf16_f32 v213, v212, v212
    v_mfma_f32_32x32x16_bf16 v[100:115], v[40:43], v[60:63], v[100:115]
    v_lshlrev_b32 v212, 16, v213
    v_rcp_f32 v215, v212
    v_sub_f32 v204, v204, v214
    v_mfma_f32_32x32x16_bf16 v[116:131], v[40:43], v[64:67], v[116:131]
    v_sub_f32 v205, v205, v214
    v_sub_f32 v206, v206, v214
    v_sub_f32 v207, v207, v214
    v_mfma_f32_32x32x16_bf16 v[132:147], v[44:47], v[60:63], v[132:147]
    v_sub_f32 v208, v208, v214
    v_sub_f32 v209, v209, v214
    v_sub_f32 v210, v210, v214
    v_mfma_f32_32x32x16_bf16 v[148:163], v[44:47], v[64:67], v[148:163]
    v_sub_f32 v211, v211, v214
    v_cvt_pk_bf16_f32 v213, v204, v205
    v_lshlrev_b32 v204, 16, v213
    v_mfma_f32_32x32x16_bf16 v[164:179], v[48:51], v[60:63], v[164:179]
    v_and_b32 v205, 0xffff0000, v213
    v_cvt_pk_bf16_f32 v213, v206, v207
    v_lshlrev_b32 v206, 16, v213
    v_mfma_f32_32x32x16_bf16 v[180:195], v[48:51], v[64:67], v[180:195]
    v_and_b32 v207, 0xffff0000, v213
    v_cvt_pk_bf16_f32 v213, v208, v209
    v_lshlrev_b32 v208, 16, v213
    ds_read_b64_tr_b16 v[36:37], v12 offset:24576
    ds_read_b64_tr_b16 v[38:39], v12 offset:26624
    ds_read_b64_tr_b16 v[40:41], v13 offset:24576
    ds_read_b64_tr_b16 v[42:43], v13 offset:26624
    ds_read_b64_tr_b16 v[44:45], v14 offset:24576
    ds_read_b64_tr_b16 v[46:47], v14 offset:26624
    ds_read_b64_tr_b16 v[48:49], v15 offset:24576
    ds_read_b64_tr_b16 v[50:51], v15 offset:26624
    ds_read_b128 v[60:63], v19 offset:0
    ds_read_b128 v[64:67], v19 offset:4096
    s_waitcnt lgkmcnt(10)
    v_mfma_f32_32x32x16_bf16 v[68:83], v[20:23], v[52:55], v[68:83]
    v_and_b32 v209, 0xffff0000, v213
    v_cvt_pk_bf16_f32 v213, v210, v211
    v_lshlrev_b32 v210, 16, v213
    v_mfma_f32_32x32x16_bf16 v[84:99], v[20:23], v[56:59], v[84:99]
    v_and_b32 v211, 0xffff0000, v213
    v_mul_f32 v204, v204, v215
    v_mul_f32 v205, v205, v215
    v_mfma_f32_32x32x16_bf16 v[100:115], v[24:27], v[52:55], v[100:115]
    v_mul_f32 v206, v206, v215
    v_mul_f32 v207, v207, v215
    v_mul_f32 v208, v208, v215
    v_mfma_f32_32x32x16_bf16 v[116:131], v[24:27], v[56:59], v[116:131]
    v_mul_f32 v209, v209, v215
    v_mul_f32 v210, v210, v215
    v_mul_f32 v211, v211, v215
    v_mfma_f32_32x32x16_bf16 v[132:147], v[28:31], v[52:55], v[132:147]
    v_cvt_pk_bf16_f32 v220, v204, v205
    v_cvt_pk_bf16_f32 v221, v206, v207
    v_cvt_pk_bf16_f32 v222, v208, v209
    v_mfma_f32_32x32x16_bf16 v[148:163], v[28:31], v[56:59], v[148:163]
    v_cvt_pk_bf16_f32 v223, v210, v211
    buffer_store_dwordx4 v[220:223], v200, s[56:59], s60 offen
    v_mfma_f32_32x32x16_bf16 v[164:179], v[32:35], v[52:55], v[164:179]
    v_mfma_f32_32x32x16_bf16 v[180:195], v[32:35], v[56:59], v[180:195]
    s_waitcnt lgkmcnt(0)
    v_add_u32 v12, 4294901760, v12
    v_add_u32 v13, 4294901760, v13
    v_add_u32 v14, 4294901760, v14
    v_add_u32 v15, 4294901760, v15
    v_add_u32 v16, 4294901760, v16
    v_add_u32 v17, 4294901760, v17
    v_add_u32 v18, 4294901760, v18
    v_add_u32 v19, 4294901760, v19
    v_mfma_f32_32x32x16_bf16 v[68:83], v[36:39], v[60:63], v[68:83]
    v_mfma_f32_32x32x16_bf16 v[84:99], v[36:39], v[64:67], v[84:99]
    v_mfma_f32_32x32x16_bf16 v[100:115], v[40:43], v[60:63], v[100:115]
    v_mfma_f32_32x32x16_bf16 v[116:131], v[40:43], v[64:67], v[116:131]
    s_waitcnt vmcnt(0)
    s_barrier
    ds_read_b64_tr_b16 v[20:21], v12 offset:0
    ds_read_b64_tr_b16 v[22:23], v12 offset:2048
    ds_read_b64_tr_b16 v[24:25], v13 offset:0
    ds_read_b64_tr_b16 v[26:27], v13 offset:2048
    ds_read_b64_tr_b16 v[28:29], v14 offset:0
    ds_read_b64_tr_b16 v[30:31], v14 offset:2048
    ds_read_b64_tr_b16 v[32:33], v15 offset:0
    ds_read_b64_tr_b16 v[34:35], v15 offset:2048
    ds_read_b128 v[52:55], v16 offset:0
    ds_read_b128 v[56:59], v16 offset:4096
    v_mfma_f32_32x32x16_bf16 v[132:147], v[44:47], v[60:63], v[132:147]
    v_mfma_f32_32x32x16_bf16 v[148:163], v[44:47], v[64:67], v[148:163]
    v_mfma_f32_32x32x16_bf16 v[164:179], v[48:51], v[60:63], v[164:179]
    v_mfma_f32_32x32x16_bf16 v[180:195], v[48:51], v[64:67], v[180:195]
    ds_read_b64_tr_b16 v[36:37], v12 offset:8192
    ds_read_b64_tr_b16 v[38:39], v12 offset:10240
    ds_read_b64_tr_b16 v[40:41], v13 offset:8192
    ds_read_b64_tr_b16 v[42:43], v13 offset:10240
    ds_read_b64_tr_b16 v[44:45], v14 offset:8192
    ds_read_b64_tr_b16 v[46:47], v14 offset:10240
    ds_read_b64_tr_b16 v[48:49], v15 offset:8192
    ds_read_b64_tr_b16 v[50:51], v15 offset:10240
    ds_read_b128 v[60:63], v17 offset:0
    ds_read_b128 v[64:67], v17 offset:4096
    s_waitcnt lgkmcnt(10)
    v_mfma_f32_32x32x16_bf16 v[68:83], v[20:23], v[52:55], v[68:83]
    s_add_u32 m0, s29, 65536
    s_add_u32 s30, s25, 0
    buffer_load_dwordx4 v10, s[4:7], s30 offen lds
    v_mfma_f32_32x32x16_bf16 v[84:99], v[20:23], v[56:59], v[84:99]
    s_add_u32 m0, s29, 73728
    s_add_u32 s30, s25, 65536
    buffer_load_dwordx4 v10, s[4:7], s30 offen lds
    v_mfma_f32_32x32x16_bf16 v[100:115], v[24:27], v[52:55], v[100:115]
    s_add_u32 m0, s29, 81920
    s_add_u32 s30, s25, 131072
    buffer_load_dwordx4 v10, s[4:7], s30 offen lds
    v_mfma_f32_32x32x16_bf16 v[116:131], v[24:27], v[56:59], v[116:131]
    s_add_u32 m0, s29, 90112
    s_add_u32 s30, s25, 196608
    buffer_load_dwordx4 v10, s[4:7], s30 offen lds
    s_add_u32 s25, s25, 128
    v_mfma_f32_32x32x16_bf16 v[132:147], v[28:31], v[52:55], v[132:147]
    s_add_u32 m0, s29, 98304
    s_add_u32 s30, s26, 0
    buffer_load_dwordx4 v11, s[8:11], s30 offen lds
    v_mfma_f32_32x32x16_bf16 v[148:163], v[28:31], v[56:59], v[148:163]
    s_add_u32 m0, s29, 106496
    s_add_u32 s30, s26, 131072
    buffer_load_dwordx4 v11, s[8:11], s30 offen lds
    v_mfma_f32_32x32x16_bf16 v[164:179], v[32:35], v[52:55], v[164:179]
    s_add_u32 m0, s29, 114688
    s_add_u32 s30, s26, 262144
    buffer_load_dwordx4 v11, s[8:11], s30 offen lds
    v_mfma_f32_32x32x16_bf16 v[180:195], v[32:35], v[56:59], v[180:195]
    s_add_u32 m0, s29, 122880
    s_add_u32 s30, s26, 393216
    buffer_load_dwordx4 v11, s[8:11], s30 offen lds
    s_add_u32 s26, s26, 524288
    ds_read_b64_tr_b16 v[20:21], v12 offset:16384
    ds_read_b64_tr_b16 v[22:23], v12 offset:18432
    ds_read_b64_tr_b16 v[24:25], v13 offset:16384
    ds_read_b64_tr_b16 v[26:27], v13 offset:18432
    ds_read_b64_tr_b16 v[28:29], v14 offset:16384
    ds_read_b64_tr_b16 v[30:31], v14 offset:18432
    ds_read_b64_tr_b16 v[32:33], v15 offset:16384
    ds_read_b64_tr_b16 v[34:35], v15 offset:18432
    ds_read_b128 v[52:55], v18 offset:0
    ds_read_b128 v[56:59], v18 offset:4096
    s_waitcnt lgkmcnt(10)
    v_mfma_f32_32x32x16_bf16 v[68:83], v[36:39], v[60:63], v[68:83]
    v_mfma_f32_32x32x16_bf16 v[84:99], v[36:39], v[64:67], v[84:99]
    v_mfma_f32_32x32x16_bf16 v[100:115], v[40:43], v[60:63], v[100:115]
    v_mfma_f32_32x32x16_bf16 v[116:131], v[40:43], v[64:67], v[116:131]
    v_mfma_f32_32x32x16_bf16 v[132:147], v[44:47], v[60:63], v[132:147]
    v_mfma_f32_32x32x16_bf16 v[148:163], v[44:47], v[64:67], v[148:163]
    v_mfma_f32_32x32x16_bf16 v[164:179], v[48:51], v[60:63], v[164:179]
    v_mfma_f32_32x32x16_bf16 v[180:195], v[48:51], v[64:67], v[180:195]
    ds_read_b64_tr_b16 v[36:37], v12 offset:24576
    ds_read_b64_tr_b16 v[38:39], v12 offset:26624
    ds_read_b64_tr_b16 v[40:41], v13 offset:24576
    ds_read_b64_tr_b16 v[42:43], v13 offset:26624
    ds_read_b64_tr_b16 v[44:45], v14 offset:24576
    ds_read_b64_tr_b16 v[46:47], v14 offset:26624
    ds_read_b64_tr_b16 v[48:49], v15 offset:24576
    ds_read_b64_tr_b16 v[50:51], v15 offset:26624
    ds_read_b128 v[60:63], v19 offset:0
    ds_read_b128 v[64:67], v19 offset:4096
    s_waitcnt lgkmcnt(10)
    v_mfma_f32_32x32x16_bf16 v[68:83], v[20:23], v[52:55], v[68:83]
    v_mfma_f32_32x32x16_bf16 v[84:99], v[20:23], v[56:59], v[84:99]
    v_mfma_f32_32x32x16_bf16 v[100:115], v[24:27], v[52:55], v[100:115]
    v_mfma_f32_32x32x16_bf16 v[116:131], v[24:27], v[56:59], v[116:131]
    v_mfma_f32_32x32x16_bf16 v[132:147], v[28:31], v[52:55], v[132:147]
    v_mfma_f32_32x32x16_bf16 v[148:163], v[28:31], v[56:59], v[148:163]
    v_mfma_f32_32x32x16_bf16 v[164:179], v[32:35], v[52:55], v[164:179]
    v_mfma_f32_32x32x16_bf16 v[180:195], v[32:35], v[56:59], v[180:195]
    s_waitcnt lgkmcnt(0)
    v_add_u32 v12, 65536, v12
    v_add_u32 v13, 65536, v13
    v_add_u32 v14, 65536, v14
    v_add_u32 v15, 65536, v15
    v_add_u32 v16, 65536, v16
    v_add_u32 v17, 65536, v17
    v_add_u32 v18, 65536, v18
    v_add_u32 v19, 65536, v19
    v_mfma_f32_32x32x16_bf16 v[68:83], v[36:39], v[60:63], v[68:83]
    v_mfma_f32_32x32x16_bf16 v[84:99], v[36:39], v[64:67], v[84:99]
    v_mfma_f32_32x32x16_bf16 v[100:115], v[40:43], v[60:63], v[100:115]
    v_mfma_f32_32x32x16_bf16 v[116:131], v[40:43], v[64:67], v[116:131]
    s_waitcnt vmcnt(0)
    s_barrier
    ds_read_b64_tr_b16 v[20:21], v12 offset:0
    ds_read_b64_tr_b16 v[22:23], v12 offset:2048
    ds_read_b64_tr_b16 v[24:25], v13 offset:0
    ds_read_b64_tr_b16 v[26:27], v13 offset:2048
    ds_read_b64_tr_b16 v[28:29], v14 offset:0
    ds_read_b64_tr_b16 v[30:31], v14 offset:2048
    ds_read_b64_tr_b16 v[32:33], v15 offset:0
    ds_read_b64_tr_b16 v[34:35], v15 offset:2048
    ds_read_b128 v[52:55], v16 offset:0
    ds_read_b128 v[56:59], v16 offset:4096
    v_mfma_f32_32x32x16_bf16 v[132:147], v[44:47], v[60:63], v[132:147]
    v_mfma_f32_32x32x16_bf16 v[148:163], v[44:47], v[64:67], v[148:163]
    v_mfma_f32_32x32x16_bf16 v[164:179], v[48:51], v[60:63], v[164:179]
    v_mfma_f32_32x32x16_bf16 v[180:195], v[48:51], v[64:67], v[180:195]
    ds_read_b64_tr_b16 v[36:37], v12 offset:8192
    ds_read_b64_tr_b16 v[38:39], v12 offset:10240
    ds_read_b64_tr_b16 v[40:41], v13 offset:8192
    ds_read_b64_tr_b16 v[42:43], v13 offset:10240
    ds_read_b64_tr_b16 v[44:45], v14 offset:8192
    ds_read_b64_tr_b16 v[46:47], v14 offset:10240
    ds_read_b64_tr_b16 v[48:49], v15 offset:8192
    ds_read_b64_tr_b16 v[50:51], v15 offset:10240
    ds_read_b128 v[60:63], v17 offset:0
    ds_read_b128 v[64:67], v17 offset:4096
    s_waitcnt lgkmcnt(10)
    v_mfma_f32_32x32x16_bf16 v[68:83], v[20:23], v[52:55], v[68:83]
    s_add_u32 m0, s29, 0
    s_add_u32 s30, s25, 0
    buffer_load_dwordx4 v10, s[4:7], s30 offen lds
    v_mfma_f32_32x32x16_bf16 v[84:99], v[20:23], v[56:59], v[84:99]
    s_add_u32 m0, s29, 8192
    s_add_u32 s30, s25, 65536
    buffer_load_dwordx4 v10, s[4:7], s30 offen lds
    v_mfma_f32_32x32x16_bf16 v[100:115], v[24:27], v[52:55], v[100:115]
    s_add_u32 m0, s29, 16384
    s_add_u32 s30, s25, 131072
    buffer_load_dwordx4 v10, s[4:7], s30 offen lds
    v_mfma_f32_32x32x16_bf16 v[116:131], v[24:27], v[56:59], v[116:131]
    s_add_u32 m0, s29, 24576
    s_add_u32 s30, s25, 196608
    buffer_load_dwordx4 v10, s[4:7], s30 offen lds
    s_add_u32 s25, s25, 128
    v_mfma_f32_32x32x16_bf16 v[132:147], v[28:31], v[52:55], v[132:147]
    s_add_u32 m0, s29, 32768
    s_add_u32 s30, s26, 0
    buffer_load_dwordx4 v11, s[8:11], s30 offen lds
    v_mfma_f32_32x32x16_bf16 v[148:163], v[28:31], v[56:59], v[148:163]
    s_add_u32 m0, s29, 40960
    s_add_u32 s30, s26, 131072
    buffer_load_dwordx4 v11, s[8:11], s30 offen lds
    v_mfma_f32_32x32x16_bf16 v[164:179], v[32:35], v[52:55], v[164:179]
    s_add_u32 m0, s29, 49152
    s_add_u32 s30, s26, 262144
    buffer_load_dwordx4 v11, s[8:11], s30 offen lds
    v_mfma_f32_32x32x16_bf16 v[180:195], v[32:35], v[56:59], v[180:195]
    s_add_u32 m0, s29, 57344
    s_add_u32 s30, s26, 393216
    buffer_load_dwordx4 v11, s[8:11], s30 offen lds
    s_add_u32 s26, s26, 524288
    ds_read_b64_tr_b16 v[20:21], v12 offset:16384
    ds_read_b64_tr_b16 v[22:23], v12 offset:18432
    ds_read_b64_tr_b16 v[24:25], v13 offset:16384
    ds_read_b64_tr_b16 v[26:27], v13 offset:18432
    ds_read_b64_tr_b16 v[28:29], v14 offset:16384
    ds_read_b64_tr_b16 v[30:31], v14 offset:18432
    ds_read_b64_tr_b16 v[32:33], v15 offset:16384
    ds_read_b64_tr_b16 v[34:35], v15 offset:18432
    ds_read_b128 v[52:55], v18 offset:0
    ds_read_b128 v[56:59], v18 offset:4096
    s_waitcnt lgkmcnt(10)
    v_mfma_f32_32x32x16_bf16 v[68:83], v[36:39], v[60:63], v[68:83]
    v_mfma_f32_32x32x16_bf16 v[84:99], v[36:39], v[64:67], v[84:99]
    v_mfma_f32_32x32x16_bf16 v[100:115], v[40:43], v[60:63], v[100:115]
    v_mfma_f32_32x32x16_bf16 v[116:131], v[40:43], v[64:67], v[116:131]
    v_mfma_f32_32x32x16_bf16 v[132:147], v[44:47], v[60:63], v[132:147]
    v_mfma_f32_32x32x16_bf16 v[148:163], v[44:47], v[64:67], v[148:163]
    v_mfma_f32_32x32x16_bf16 v[164:179], v[48:51], v[60:63], v[164:179]
    v_mfma_f32_32x32x16_bf16 v[180:195], v[48:51], v[64:67], v[180:195]
    ds_read_b64_tr_b16 v[36:37], v12 offset:24576
    ds_read_b64_tr_b16 v[38:39], v12 offset:26624
    ds_read_b64_tr_b16 v[40:41], v13 offset:24576
    ds_read_b64_tr_b16 v[42:43], v13 offset:26624
    ds_read_b64_tr_b16 v[44:45], v14 offset:24576
    ds_read_b64_tr_b16 v[46:47], v14 offset:26624
    ds_read_b64_tr_b16 v[48:49], v15 offset:24576
    ds_read_b64_tr_b16 v[50:51], v15 offset:26624
    ds_read_b128 v[60:63], v19 offset:0
    ds_read_b128 v[64:67], v19 offset:4096
    s_waitcnt lgkmcnt(10)
    v_mfma_f32_32x32x16_bf16 v[68:83], v[20:23], v[52:55], v[68:83]
    v_mfma_f32_32x32x16_bf16 v[84:99], v[20:23], v[56:59], v[84:99]
    v_mfma_f32_32x32x16_bf16 v[100:115], v[24:27], v[52:55], v[100:115]
    v_mfma_f32_32x32x16_bf16 v[116:131], v[24:27], v[56:59], v[116:131]
    v_mfma_f32_32x32x16_bf16 v[132:147], v[28:31], v[52:55], v[132:147]
    v_mfma_f32_32x32x16_bf16 v[148:163], v[28:31], v[56:59], v[148:163]
    v_mfma_f32_32x32x16_bf16 v[164:179], v[32:35], v[52:55], v[164:179]
    v_mfma_f32_32x32x16_bf16 v[180:195], v[32:35], v[56:59], v[180:195]
    s_waitcnt lgkmcnt(0)
    v_add_u32 v12, 4294901760, v12
    v_add_u32 v13, 4294901760, v13
    v_add_u32 v14, 4294901760, v14
    v_add_u32 v15, 4294901760, v15
    v_add_u32 v16, 4294901760, v16
    v_add_u32 v17, 4294901760, v17
    v_add_u32 v18, 4294901760, v18
    v_add_u32 v19, 4294901760, v19
    v_mfma_f32_32x32x16_bf16 v[68:83], v[36:39], v[60:63], v[68:83]
    v_mfma_f32_32x32x16_bf16 v[84:99], v[36:39], v[64:67], v[84:99]
    v_mfma_f32_32x32x16_bf16 v[100:115], v[40:43], v[60:63], v[100:115]
    v_mfma_f32_32x32x16_bf16 v[116:131], v[40:43], v[64:67], v[116:131]
    s_waitcnt vmcnt(0)
    s_barrier
    ds_read_b64_tr_b16 v[20:21], v12 offset:0
    ds_read_b64_tr_b16 v[22:23], v12 offset:2048
    ds_read_b64_tr_b16 v[24:25], v13 offset:0
    ds_read_b64_tr_b16 v[26:27], v13 offset:2048
    ds_read_b64_tr_b16 v[28:29], v14 offset:0
    ds_read_b64_tr_b16 v[30:31], v14 offset:2048
    ds_read_b64_tr_b16 v[32:33], v15 offset:0
    ds_read_b64_tr_b16 v[34:35], v15 offset:2048
    ds_read_b128 v[52:55], v16 offset:0
    ds_read_b128 v[56:59], v16 offset:4096
    v_mfma_f32_32x32x16_bf16 v[132:147], v[44:47], v[60:63], v[132:147]
    v_mfma_f32_32x32x16_bf16 v[148:163], v[44:47], v[64:67], v[148:163]
    v_mfma_f32_32x32x16_bf16 v[164:179], v[48:51], v[60:63], v[164:179]
    v_mfma_f32_32x32x16_bf16 v[180:195], v[48:51], v[64:67], v[180:195]
    ds_read_b64_tr_b16 v[36:37], v12 offset:8192
    ds_read_b64_tr_b16 v[38:39], v12 offset:10240
    ds_read_b64_tr_b16 v[40:41], v13 offset:8192
    ds_read_b64_tr_b16 v[42:43], v13 offset:10240
    ds_read_b64_tr_b16 v[44:45], v14 offset:8192
    ds_read_b64_tr_b16 v[46:47], v14 offset:10240
    ds_read_b64_tr_b16 v[48:49], v15 offset:8192
    ds_read_b64_tr_b16 v[50:51], v15 offset:10240
    ds_read_b128 v[60:63], v17 offset:0
    ds_read_b128 v[64:67], v17 offset:4096
    s_waitcnt lgkmcnt(10)
    v_mfma_f32_32x32x16_bf16 v[68:83], v[20:23], v[52:55], v[68:83]
    s_add_u32 m0, s29, 65536
    s_add_u32 s30, s25, 0
    buffer_load_dwordx4 v10, s[4:7], s30 offen lds
    v_mfma_f32_32x32x16_bf16 v[84:99], v[20:23], v[56:59], v[84:99]
    s_add_u32 m0, s29, 73728
    s_add_u32 s30, s25, 65536
    buffer_load_dwordx4 v10, s[4:7], s30 offen lds
    v_mfma_f32_32x32x16_bf16 v[100:115], v[24:27], v[52:55], v[100:115]
    s_add_u32 m0, s29, 81920
    s_add_u32 s30, s25, 131072
    buffer_load_dwordx4 v10, s[4:7], s30 offen lds
    v_mfma_f32_32x32x16_bf16 v[116:131], v[24:27], v[56:59], v[116:131]
    s_add_u32 m0, s29, 90112
    s_add_u32 s30, s25, 196608
    buffer_load_dwordx4 v10, s[4:7], s30 offen lds
    s_add_u32 s25, s25, 128
    v_mfma_f32_32x32x16_bf16 v[132:147], v[28:31], v[52:55], v[132:147]
    s_add_u32 m0, s29, 98304
    s_add_u32 s30, s26, 0
    buffer_load_dwordx4 v11, s[8:11], s30 offen lds
    v_mfma_f32_32x32x16_bf16 v[148:163], v[28:31], v[56:59], v[148:163]
    s_add_u32 m0, s29, 106496
    s_add_u32 s30, s26, 131072
    buffer_load_dwordx4 v11, s[8:11], s30 offen lds
    v_mfma_f32_32x32x16_bf16 v[164:179], v[32:35], v[52:55], v[164:179]
    s_add_u32 m0, s29, 114688
    s_add_u32 s30, s26, 262144
    buffer_load_dwordx4 v11, s[8:11], s30 offen lds
    v_mfma_f32_32x32x16_bf16 v[180:195], v[32:35], v[56:59], v[180:195]
    s_add_u32 m0, s29, 122880
    s_add_u32 s30, s26, 393216
    buffer_load_dwordx4 v11, s[8:11], s30 offen lds
    s_add_u32 s26, s26, 524288
    ds_read_b64_tr_b16 v[20:21], v12 offset:16384
    ds_read_b64_tr_b16 v[22:23], v12 offset:18432
    ds_read_b64_tr_b16 v[24:25], v13 offset:16384
    ds_read_b64_tr_b16 v[26:27], v13 offset:18432
    ds_read_b64_tr_b16 v[28:29], v14 offset:16384
    ds_read_b64_tr_b16 v[30:31], v14 offset:18432
    ds_read_b64_tr_b16 v[32:33], v15 offset:16384
    ds_read_b64_tr_b16 v[34:35], v15 offset:18432
    ds_read_b128 v[52:55], v18 offset:0
    ds_read_b128 v[56:59], v18 offset:4096
    s_waitcnt lgkmcnt(10)
    v_mfma_f32_32x32x16_bf16 v[68:83], v[36:39], v[60:63], v[68:83]
    v_mfma_f32_32x32x16_bf16 v[84:99], v[36:39], v[64:67], v[84:99]
    v_mfma_f32_32x32x16_bf16 v[100:115], v[40:43], v[60:63], v[100:115]
    v_mfma_f32_32x32x16_bf16 v[116:131], v[40:43], v[64:67], v[116:131]
    v_mfma_f32_32x32x16_bf16 v[132:147], v[44:47], v[60:63], v[132:147]
    v_mfma_f32_32x32x16_bf16 v[148:163], v[44:47], v[64:67], v[148:163]
    v_mfma_f32_32x32x16_bf16 v[164:179], v[48:51], v[60:63], v[164:179]
    v_mfma_f32_32x32x16_bf16 v[180:195], v[48:51], v[64:67], v[180:195]
    ds_read_b64_tr_b16 v[36:37], v12 offset:24576
    ds_read_b64_tr_b16 v[38:39], v12 offset:26624
    ds_read_b64_tr_b16 v[40:41], v13 offset:24576
    ds_read_b64_tr_b16 v[42:43], v13 offset:26624
    ds_read_b64_tr_b16 v[44:45], v14 offset:24576
    ds_read_b64_tr_b16 v[46:47], v14 offset:26624
    ds_read_b64_tr_b16 v[48:49], v15 offset:24576
    ds_read_b64_tr_b16 v[50:51], v15 offset:26624
    ds_read_b128 v[60:63], v19 offset:0
    ds_read_b128 v[64:67], v19 offset:4096
    s_waitcnt lgkmcnt(10)
    v_mfma_f32_32x32x16_bf16 v[68:83], v[20:23], v[52:55], v[68:83]
    v_mfma_f32_32x32x16_bf16 v[84:99], v[20:23], v[56:59], v[84:99]
    v_mfma_f32_32x32x16_bf16 v[100:115], v[24:27], v[52:55], v[100:115]
    v_mfma_f32_32x32x16_bf16 v[116:131], v[24:27], v[56:59], v[116:131]
    v_mfma_f32_32x32x16_bf16 v[132:147], v[28:31], v[52:55], v[132:147]
    v_mfma_f32_32x32x16_bf16 v[148:163], v[28:31], v[56:59], v[148:163]
    v_mfma_f32_32x32x16_bf16 v[164:179], v[32:35], v[52:55], v[164:179]
    v_mfma_f32_32x32x16_bf16 v[180:195], v[32:35], v[56:59], v[180:195]
    s_waitcnt lgkmcnt(0)
    v_add_u32 v12, 65536, v12
    v_add_u32 v13, 65536, v13
    v_add_u32 v14, 65536, v14
    v_add_u32 v15, 65536, v15
    v_add_u32 v16, 65536, v16
    v_add_u32 v17, 65536, v17
    v_add_u32 v18, 65536, v18
    v_add_u32 v19, 65536, v19
    v_mfma_f32_32x32x16_bf16 v[68:83], v[36:39], v[60:63], v[68:83]
    v_mfma_f32_32x32x16_bf16 v[84:99], v[36:39], v[64:67], v[84:99]
    v_mfma_f32_32x32x16_bf16 v[100:115], v[40:43], v[60:63], v[100:115]
    v_mfma_f32_32x32x16_bf16 v[116:131], v[40:43], v[64:67], v[116:131]
    s_waitcnt vmcnt(0)
    s_barrier
    ds_read_b64_tr_b16 v[20:21], v12 offset:0
    ds_read_b64_tr_b16 v[22:23], v12 offset:2048
    ds_read_b64_tr_b16 v[24:25], v13 offset:0
    ds_read_b64_tr_b16 v[26:27], v13 offset:2048
    ds_read_b64_tr_b16 v[28:29], v14 offset:0
    ds_read_b64_tr_b16 v[30:31], v14 offset:2048
    ds_read_b64_tr_b16 v[32:33], v15 offset:0
    ds_read_b64_tr_b16 v[34:35], v15 offset:2048
    ds_read_b128 v[52:55], v16 offset:0
    ds_read_b128 v[56:59], v16 offset:4096
    v_mfma_f32_32x32x16_bf16 v[132:147], v[44:47], v[60:63], v[132:147]
    v_mfma_f32_32x32x16_bf16 v[148:163], v[44:47], v[64:67], v[148:163]
    v_mfma_f32_32x32x16_bf16 v[164:179], v[48:51], v[60:63], v[164:179]
    v_mfma_f32_32x32x16_bf16 v[180:195], v[48:51], v[64:67], v[180:195]
    ds_read_b64_tr_b16 v[36:37], v12 offset:8192
    ds_read_b64_tr_b16 v[38:39], v12 offset:10240
    ds_read_b64_tr_b16 v[40:41], v13 offset:8192
    ds_read_b64_tr_b16 v[42:43], v13 offset:10240
    ds_read_b64_tr_b16 v[44:45], v14 offset:8192
    ds_read_b64_tr_b16 v[46:47], v14 offset:10240
    ds_read_b64_tr_b16 v[48:49], v15 offset:8192
    ds_read_b64_tr_b16 v[50:51], v15 offset:10240
    ds_read_b128 v[60:63], v17 offset:0
    ds_read_b128 v[64:67], v17 offset:4096
    s_waitcnt lgkmcnt(10)
    v_mfma_f32_32x32x16_bf16 v[68:83], v[20:23], v[52:55], v[68:83]
    v_mfma_f32_32x32x16_bf16 v[84:99], v[20:23], v[56:59], v[84:99]
    v_mfma_f32_32x32x16_bf16 v[100:115], v[24:27], v[52:55], v[100:115]
    v_mfma_f32_32x32x16_bf16 v[116:131], v[24:27], v[56:59], v[116:131]
    v_mfma_f32_32x32x16_bf16 v[132:147], v[28:31], v[52:55], v[132:147]
    v_mfma_f32_32x32x16_bf16 v[148:163], v[28:31], v[56:59], v[148:163]
    v_mfma_f32_32x32x16_bf16 v[164:179], v[32:35], v[52:55], v[164:179]
    v_mfma_f32_32x32x16_bf16 v[180:195], v[32:35], v[56:59], v[180:195]
    ds_read_b64_tr_b16 v[20:21], v12 offset:16384
    ds_read_b64_tr_b16 v[22:23], v12 offset:18432
    ds_read_b64_tr_b16 v[24:25], v13 offset:16384
    ds_read_b64_tr_b16 v[26:27], v13 offset:18432
    ds_read_b64_tr_b16 v[28:29], v14 offset:16384
    ds_read_b64_tr_b16 v[30:31], v14 offset:18432
    ds_read_b64_tr_b16 v[32:33], v15 offset:16384
    ds_read_b64_tr_b16 v[34:35], v15 offset:18432
    ds_read_b128 v[52:55], v18 offset:0
    ds_read_b128 v[56:59], v18 offset:4096
    s_waitcnt lgkmcnt(10)
    v_mfma_f32_32x32x16_bf16 v[68:83], v[36:39], v[60:63], v[68:83]
    v_mfma_f32_32x32x16_bf16 v[84:99], v[36:39], v[64:67], v[84:99]
    v_mfma_f32_32x32x16_bf16 v[100:115], v[40:43], v[60:63], v[100:115]
    v_mfma_f32_32x32x16_bf16 v[116:131], v[40:43], v[64:67], v[116:131]
    v_mfma_f32_32x32x16_bf16 v[132:147], v[44:47], v[60:63], v[132:147]
    v_mfma_f32_32x32x16_bf16 v[148:163], v[44:47], v[64:67], v[148:163]
    v_mfma_f32_32x32x16_bf16 v[164:179], v[48:51], v[60:63], v[164:179]
    v_mfma_f32_32x32x16_bf16 v[180:195], v[48:51], v[64:67], v[180:195]
    ds_read_b64_tr_b16 v[36:37], v12 offset:24576
    ds_read_b64_tr_b16 v[38:39], v12 offset:26624
    ds_read_b64_tr_b16 v[40:41], v13 offset:24576
    ds_read_b64_tr_b16 v[42:43], v13 offset:26624
    ds_read_b64_tr_b16 v[44:45], v14 offset:24576
    ds_read_b64_tr_b16 v[46:47], v14 offset:26624
    ds_read_b64_tr_b16 v[48:49], v15 offset:24576
    ds_read_b64_tr_b16 v[50:51], v15 offset:26624
    ds_read_b128 v[60:63], v19 offset:0
    ds_read_b128 v[64:67], v19 offset:4096
    s_waitcnt lgkmcnt(10)
    v_mfma_f32_32x32x16_bf16 v[68:83], v[20:23], v[52:55], v[68:83]
    v_mfma_f32_32x32x16_bf16 v[84:99], v[20:23], v[56:59], v[84:99]
    v_mfma_f32_32x32x16_bf16 v[100:115], v[24:27], v[52:55], v[100:115]
    v_mfma_f32_32x32x16_bf16 v[116:131], v[24:27], v[56:59], v[116:131]
    v_mfma_f32_32x32x16_bf16 v[132:147], v[28:31], v[52:55], v[132:147]
    v_mfma_f32_32x32x16_bf16 v[148:163], v[28:31], v[56:59], v[148:163]
    v_mfma_f32_32x32x16_bf16 v[164:179], v[32:35], v[52:55], v[164:179]
    v_mfma_f32_32x32x16_bf16 v[180:195], v[32:35], v[56:59], v[180:195]
    s_waitcnt lgkmcnt(0)
    v_mfma_f32_32x32x16_bf16 v[68:83], v[36:39], v[60:63], v[68:83]
    v_mfma_f32_32x32x16_bf16 v[84:99], v[36:39], v[64:67], v[84:99]
    v_mfma_f32_32x32x16_bf16 v[100:115], v[40:43], v[60:63], v[100:115]
    v_mfma_f32_32x32x16_bf16 v[116:131], v[40:43], v[64:67], v[116:131]
    v_mfma_f32_32x32x16_bf16 v[132:147], v[44:47], v[60:63], v[132:147]
    v_mfma_f32_32x32x16_bf16 v[148:163], v[44:47], v[64:67], v[148:163]
    v_mfma_f32_32x32x16_bf16 v[164:179], v[48:51], v[60:63], v[164:179]
    v_mfma_f32_32x32x16_bf16 v[180:195], v[48:51], v[64:67], v[180:195]
    s_lshr_b32 s50, s48, 7
    s_add_u32 s50, s50, s33
    s_lshl_b32 s50, s50, 19
    s_mul_i32 s51, s32, 64
    s_add_u32 s51, s51, s47
    s_lshl_b32 s51, s51, 8
    s_add_u32 s50, s50, s51
    s_load_dwordx2 s[68:69], s[0:1], 16
    s_lshl_b32 s70, s60, 1
    s_waitcnt lgkmcnt(0)
    s_mov_b32 s72, s68
    s_mov_b32 s73, s69
    s_mov_b32 s74, 4194304
    s_mov_b32 s75, 0x00020000
    s_barrier
    v_and_b32 v2, 31, v1
    v_lshlrev_b32 v3, 8, v2
    v_lshrrev_b32 v4, 5, v1
    v_lshl_add_u32 v3, v4, 3, v3
    s_mul_i32 s30, s24, 16384
    v_add_u32 v3, s30, v3
    v_bfe_u32 v4, v2, 0, 4
    v_lshlrev_b32 v4, 4, v4
    v_xor_b32 v5, 0, v4
    v_add_u32 v5, v5, v3
    v_cvt_pk_bf16_f32 v20, v68, v69
    v_cvt_pk_bf16_f32 v21, v70, v71
    ds_write_b64 v5, v[20:21] offset:0
    v_cvt_pk_bf16_f32 v22, v84, v85
    v_cvt_pk_bf16_f32 v23, v86, v87
    ds_write_b64 v5, v[22:23] offset:8192
    v_xor_b32 v5, 16, v4
    v_add_u32 v5, v5, v3
    v_cvt_pk_bf16_f32 v24, v72, v73
    v_cvt_pk_bf16_f32 v25, v74, v75
    ds_write_b64 v5, v[24:25] offset:0
    v_cvt_pk_bf16_f32 v26, v88, v89
    v_cvt_pk_bf16_f32 v27, v90, v91
    ds_write_b64 v5, v[26:27] offset:8192
    v_xor_b32 v5, 32, v4
    v_add_u32 v5, v5, v3
    v_cvt_pk_bf16_f32 v28, v76, v77
    v_cvt_pk_bf16_f32 v29, v78, v79
    ds_write_b64 v5, v[28:29] offset:0
    v_cvt_pk_bf16_f32 v30, v92, v93
    v_cvt_pk_bf16_f32 v31, v94, v95
    ds_write_b64 v5, v[30:31] offset:8192
    v_xor_b32 v5, 48, v4
    v_add_u32 v5, v5, v3
    v_cvt_pk_bf16_f32 v32, v80, v81
    v_cvt_pk_bf16_f32 v33, v82, v83
    ds_write_b64 v5, v[32:33] offset:0
    v_cvt_pk_bf16_f32 v34, v96, v97
    v_cvt_pk_bf16_f32 v35, v98, v99
    ds_write_b64 v5, v[34:35] offset:8192
    v_xor_b32 v5, 64, v4
    v_add_u32 v5, v5, v3
    v_cvt_pk_bf16_f32 v36, v100, v101
    v_cvt_pk_bf16_f32 v37, v102, v103
    ds_write_b64 v5, v[36:37] offset:0
    v_cvt_pk_bf16_f32 v38, v116, v117
    v_cvt_pk_bf16_f32 v39, v118, v119
    ds_write_b64 v5, v[38:39] offset:8192
    v_xor_b32 v5, 80, v4
    v_add_u32 v5, v5, v3
    v_cvt_pk_bf16_f32 v40, v104, v105
    v_cvt_pk_bf16_f32 v41, v106, v107
    ds_write_b64 v5, v[40:41] offset:0
    v_cvt_pk_bf16_f32 v42, v120, v121
    v_cvt_pk_bf16_f32 v43, v122, v123
    ds_write_b64 v5, v[42:43] offset:8192
    v_xor_b32 v5, 96, v4
    v_add_u32 v5, v5, v3
    v_cvt_pk_bf16_f32 v44, v108, v109
    v_cvt_pk_bf16_f32 v45, v110, v111
    ds_write_b64 v5, v[44:45] offset:0
    v_cvt_pk_bf16_f32 v46, v124, v125
    v_cvt_pk_bf16_f32 v47, v126, v127
    ds_write_b64 v5, v[46:47] offset:8192
    v_xor_b32 v5, 112, v4
    v_add_u32 v5, v5, v3
    v_cvt_pk_bf16_f32 v48, v112, v113
    v_cvt_pk_bf16_f32 v49, v114, v115
    ds_write_b64 v5, v[48:49] offset:0
    v_cvt_pk_bf16_f32 v50, v128, v129
    v_cvt_pk_bf16_f32 v51, v130, v131
    ds_write_b64 v5, v[50:51] offset:8192
    v_xor_b32 v5, 128, v4
    v_add_u32 v5, v5, v3
    v_cvt_pk_bf16_f32 v20, v132, v133
    v_cvt_pk_bf16_f32 v21, v134, v135
    ds_write_b64 v5, v[20:21] offset:0
    v_cvt_pk_bf16_f32 v22, v148, v149
    v_cvt_pk_bf16_f32 v23, v150, v151
    ds_write_b64 v5, v[22:23] offset:8192
    v_xor_b32 v5, 144, v4
    v_add_u32 v5, v5, v3
    v_cvt_pk_bf16_f32 v24, v136, v137
    v_cvt_pk_bf16_f32 v25, v138, v139
    ds_write_b64 v5, v[24:25] offset:0
    v_cvt_pk_bf16_f32 v26, v152, v153
    v_cvt_pk_bf16_f32 v27, v154, v155
    ds_write_b64 v5, v[26:27] offset:8192
    v_xor_b32 v5, 160, v4
    v_add_u32 v5, v5, v3
    v_cvt_pk_bf16_f32 v28, v140, v141
    v_cvt_pk_bf16_f32 v29, v142, v143
    ds_write_b64 v5, v[28:29] offset:0
    v_cvt_pk_bf16_f32 v30, v156, v157
    v_cvt_pk_bf16_f32 v31, v158, v159
    ds_write_b64 v5, v[30:31] offset:8192
    v_xor_b32 v5, 176, v4
    v_add_u32 v5, v5, v3
    v_cvt_pk_bf16_f32 v32, v144, v145
    v_cvt_pk_bf16_f32 v33, v146, v147
    ds_write_b64 v5, v[32:33] offset:0
    v_cvt_pk_bf16_f32 v34, v160, v161
    v_cvt_pk_bf16_f32 v35, v162, v163
    ds_write_b64 v5, v[34:35] offset:8192
    v_xor_b32 v5, 192, v4
    v_add_u32 v5, v5, v3
    v_cvt_pk_bf16_f32 v36, v164, v165
    v_cvt_pk_bf16_f32 v37, v166, v167
    ds_write_b64 v5, v[36:37] offset:0
    v_cvt_pk_bf16_f32 v38, v180, v181
    v_cvt_pk_bf16_f32 v39, v182, v183
    ds_write_b64 v5, v[38:39] offset:8192
    v_xor_b32 v5, 208, v4
    v_add_u32 v5, v5, v3
    v_cvt_pk_bf16_f32 v40, v168, v169
    v_cvt_pk_bf16_f32 v41, v170, v171
    ds_write_b64 v5, v[40:41] offset:0
    v_cvt_pk_bf16_f32 v42, v184, v185
    v_cvt_pk_bf16_f32 v43, v186, v187
    ds_write_b64 v5, v[42:43] offset:8192
    v_xor_b32 v5, 224, v4
    v_add_u32 v5, v5, v3
    v_cvt_pk_bf16_f32 v44, v172, v173
    v_cvt_pk_bf16_f32 v45, v174, v175
    ds_write_b64 v5, v[44:45] offset:0
    v_cvt_pk_bf16_f32 v46, v188, v189
    v_cvt_pk_bf16_f32 v47, v190, v191
    ds_write_b64 v5, v[46:47] offset:8192
    v_xor_b32 v5, 240, v4
    v_add_u32 v5, v5, v3
    v_cvt_pk_bf16_f32 v48, v176, v177
    v_cvt_pk_bf16_f32 v49, v178, v179
    ds_write_b64 v5, v[48:49] offset:0
    v_cvt_pk_bf16_f32 v50, v192, v193
    v_cvt_pk_bf16_f32 v51, v194, v195
    ds_write_b64 v5, v[50:51] offset:8192
    v_lshrrev_b32 v2, 4, v1
    v_lshlrev_b32 v2, 8, v2
    s_mul_i32 s30, s24, 16384
    v_add_u32 v2, s30, v2
    v_and_b32 v3, 15, v1
    v_lshrrev_b32 v4, 4, v1
    v_xor_b32 v3, v3, v4
    v_lshlrev_b32 v3, 4, v3
    v_xor_b32 v4, 0, v3
    v_add_u32 v12, v4, v2
    v_xor_b32 v4, 64, v3
    v_add_u32 v13, v4, v2
    v_xor_b32 v4, 128, v3
    v_add_u32 v14, v4, v2
    v_xor_b32 v4, 192, v3
    v_add_u32 v15, v4, v2
    v_lshrrev_b32 v2, 4, v1
    v_lshlrev_b32 v2, 8, v2
    v_and_b32 v3, 15, v1
    v_lshl_add_u32 v10, v3, 4, v2
    s_waitcnt lgkmcnt(0)
    ds_read_b128 v[68:71], v12 offset:0
    ds_read_b128 v[72:75], v13 offset:1024
    ds_read_b128 v[76:79], v14 offset:2048
    ds_read_b128 v[80:83], v15 offset:3072
    ds_read_b128 v[84:87], v12 offset:4096
    ds_read_b128 v[88:91], v13 offset:5120
    ds_read_b128 v[92:95], v14 offset:6144
    ds_read_b128 v[96:99], v15 offset:7168
    ds_read_b128 v[100:103], v12 offset:8192
    ds_read_b128 v[104:107], v13 offset:9216
    ds_read_b128 v[108:111], v14 offset:10240
    ds_read_b128 v[112:115], v15 offset:11264
    ds_read_b128 v[116:119], v12 offset:12288
    ds_read_b128 v[120:123], v13 offset:13312
    ds_read_b128 v[124:127], v14 offset:14336
    ds_read_b128 v[128:131], v15 offset:15360
    s_waitcnt lgkmcnt(15)
    s_add_u32 s30, s50, 0
    buffer_store_dwordx4 v[68:71], v10, s[16:19], s30 offen
    s_waitcnt lgkmcnt(14)
    s_add_u32 s30, s50, 1024
    buffer_store_dwordx4 v[72:75], v10, s[16:19], s30 offen
    s_waitcnt lgkmcnt(13)
    s_add_u32 s30, s50, 2048
    buffer_store_dwordx4 v[76:79], v10, s[16:19], s30 offen
    s_waitcnt lgkmcnt(12)
    s_add_u32 s30, s50, 3072
    buffer_store_dwordx4 v[80:83], v10, s[16:19], s30 offen
    s_waitcnt lgkmcnt(11)
    s_add_u32 s30, s50, 4096
    buffer_store_dwordx4 v[84:87], v10, s[16:19], s30 offen
    s_waitcnt lgkmcnt(10)
    s_add_u32 s30, s50, 5120
    buffer_store_dwordx4 v[88:91], v10, s[16:19], s30 offen
    s_waitcnt lgkmcnt(9)
    s_add_u32 s30, s50, 6144
    buffer_store_dwordx4 v[92:95], v10, s[16:19], s30 offen
    s_waitcnt lgkmcnt(8)
    s_add_u32 s30, s50, 7168
    buffer_store_dwordx4 v[96:99], v10, s[16:19], s30 offen
    s_waitcnt lgkmcnt(7)
    s_add_u32 s30, s50, 8192
    buffer_store_dwordx4 v[100:103], v10, s[16:19], s30 offen
    s_waitcnt lgkmcnt(6)
    s_add_u32 s30, s50, 9216
    buffer_store_dwordx4 v[104:107], v10, s[16:19], s30 offen
    s_waitcnt lgkmcnt(5)
    s_add_u32 s30, s50, 10240
    buffer_store_dwordx4 v[108:111], v10, s[16:19], s30 offen
    s_waitcnt lgkmcnt(4)
    s_add_u32 s30, s50, 11264
    buffer_store_dwordx4 v[112:115], v10, s[16:19], s30 offen
    s_waitcnt lgkmcnt(3)
    s_add_u32 s30, s50, 12288
    buffer_store_dwordx4 v[116:119], v10, s[16:19], s30 offen
    s_waitcnt lgkmcnt(2)
    s_add_u32 s30, s50, 13312
    buffer_store_dwordx4 v[120:123], v10, s[16:19], s30 offen
    s_waitcnt lgkmcnt(1)
    s_add_u32 s30, s50, 14336
    buffer_store_dwordx4 v[124:127], v10, s[16:19], s30 offen
    s_waitcnt lgkmcnt(0)
    s_add_u32 s30, s50, 15360
    buffer_store_dwordx4 v[128:131], v10, s[16:19], s30 offen
    buffer_load_dwordx4 v[52:55], v200, s[72:75], s70 offen
    buffer_load_dwordx4 v[56:59], v200, s[72:75], s70 offen offset:1024
L_end_1:
    s_endpgm
.globl attn_kernel
.p2align 8
.type attn_kernel,@function
attn_kernel:
    s_cmp_ge_u32 s2, 256
    s_cbranch_scc1 L_end_2
    s_load_dwordx2 s[20:21], s[0:1], 96
    s_load_dwordx2 s[66:67], s[0:1], 16
    v_lshrrev_b32 v2, 6, v0
    s_nop 0
    v_readfirstlane_b32 s24, v2
    s_nop 3
    s_lshr_b32 s34, s24, 2
    s_and_b32 s35, s24, 3
    s_and_b32 s36, s2, 7
    s_lshl_b32 s36, s36, 2
    s_bfe_u32 s30, s2, 0x20003
    s_add_u32 s36, s36, s30
    s_lshl_b32 s22, s36, 8
    s_lshl_b32 s68, s36, 7
    s_lshl_b32 s36, s36, 19
    s_lshr_b32 s23, s2, 5
    s_mov_b32 s41, 0x41f00000
    s_lshl_b32 s42, s34, 16
    s_lshl_b32 s30, s35, 10
    s_add_u32 s42, s42, s30
    s_sub_u32 s37, 15, s23
    s_cmp_eq_u32 s34, 0
    s_cselect_b32 s69, s37, s23
    s_lshl_b32 s69, s69, 7
    s_lshl_b32 s30, s34, 5
    s_sub_u32 s69, s69, s30
    s_waitcnt lgkmcnt(0)
    s_mov_b32 s4, s20
    s_mov_b32 s5, s21
    s_mov_b32 s6, 2097152
    s_mov_b32 s7, 0x00020000
    s_mov_b32 s8, s66
    s_mov_b32 s9, s67
    s_mov_b32 s10, 4194304
    s_mov_b32 s11, 0x00020000
    v_and_b32 v1, 63, v0
    v_lshrrev_b32 v2, 6, v0
    s_nop 0
    v_readfirstlane_b32 s24, v2
    s_nop 3
    s_lshl_b32 s29, s24, 10
    s_and_b32 s30, s24, 1
    s_and_b32 s32, s24, 3
    s_lshr_b32 s33, s24, 2
    s_lshl_b32 s31, s30, 2
    v_lshrrev_b32 v2, 4, v1
    v_add_u32 v2, s31, v2
    v_and_b32 v2, 7, v2
    v_and_b32 v3, 7, v1
    v_xor_b32 v2, v2, v3
    v_lshlrev_b32 v2, 4, v2
    v_lshrrev_b32 v3, 3, v1
    s_mov_b32 s31, 1024
    v_mul_lo_u32 v3, v3, s31
    v_add_u32 v160, v2, v3
    v_lshrrev_b32 v2, 4, v1
    v_and_b32 v3, 3, v2
    v_lshlrev_b32 v3, 2, v3
    v_and_b32 v4, 15, v1
    v_xor_b32 v3, v3, v4
    v_lshlrev_b32 v3, 4, v3
    s_mov_b32 s31, 8192
    v_mul_lo_u32 v2, v2, s31
    v_add_u32 v161, v2, v3
    s_mul_i32 s30, s24, 8
    s_add_u32 s30, s30, s69
    s_mul_i32 s25, s30, 1024
    s_mul_i32 s30, s24, 4
    s_mul_i32 s26, s30, 8192
    s_lshl_b32 s30, s68, 1
    s_add_u32 s26, s26, s30
    s_add_u32 m0, s29, 0
    s_add_u32 s30, s25, 0
    buffer_load_dwordx4 v160, s[4:7], s30 offen lds
    s_add_u32 m0, s29, 8192
    s_add_u32 s30, s25, 32768
    buffer_load_dwordx4 v160, s[4:7], s30 offen lds
    s_add_u32 m0, s29, 16384
    s_add_u32 s30, s25, 65536
    buffer_load_dwordx4 v160, s[4:7], s30 offen lds
    s_add_u32 m0, s29, 24576
    s_add_u32 s30, s25, 98304
    buffer_load_dwordx4 v160, s[4:7], s30 offen lds
    s_add_u32 s25, s25, 128
    s_add_u32 m0, s29, 32768
    s_add_u32 s30, s26, 0
    buffer_load_dwordx4 v161, s[8:11], s30 offen lds
    s_add_u32 m0, s29, 40960
    s_add_u32 s30, s26, 262144
    buffer_load_dwordx4 v161, s[8:11], s30 offen lds
    s_add_u32 s26, s26, 524288
    s_add_u32 m0, s29, 49152
    s_add_u32 s30, s25, 0
    buffer_load_dwordx4 v160, s[4:7], s30 offen lds
    s_add_u32 m0, s29, 57344
    s_add_u32 s30, s25, 32768
    buffer_load_dwordx4 v160, s[4:7], s30 offen lds
    s_add_u32 m0, s29, 65536
    s_add_u32 s30, s25, 65536
    buffer_load_dwordx4 v160, s[4:7], s30 offen lds
    s_add_u32 m0, s29, 73728
    s_add_u32 s30, s25, 98304
    buffer_load_dwordx4 v160, s[4:7], s30 offen lds
    s_add_u32 s25, s25, 128
    s_add_u32 m0, s29, 81920
    s_add_u32 s30, s26, 0
    buffer_load_dwordx4 v161, s[8:11], s30 offen lds
    s_add_u32 m0, s29, 90112
    s_add_u32 s30, s26, 262144
    buffer_load_dwordx4 v161, s[8:11], s30 offen lds
    s_add_u32 s26, s26, 524288
    v_and_b32 v2, 31, v1
    s_mul_i32 s30, s32, 64
    v_add_u32 v2, s30, v2
    v_bfe_u32 v3, v2, 1, 3
    v_lshrrev_b32 v4, 5, v1
    v_xor_b32 v3, v3, v4
    v_lshlrev_b32 v2, 7, v2
    v_xor_b32 v5, 0, v3
    v_lshl_add_u32 v168, v5, 4, v2
    v_xor_b32 v5, 2, v3
    v_lshl_add_u32 v169, v5, 4, v2
    v_xor_b32 v5, 4, v3
    v_lshl_add_u32 v170, v5, 4, v2
    v_xor_b32 v5, 6, v3
    v_lshl_add_u32 v171, v5, 4, v2
    v_and_b32 v2, 15, v1
    v_lshrrev_b32 v3, 2, v2
    v_and_b32 v4, 3, v2
    v_lshrrev_b32 v5, 5, v1
    v_lshl_add_u32 v5, v5, 3, v3
    v_lshlrev_b32 v5, 8, v5
    v_and_b32 v6, 1, v4
    v_lshl_add_u32 v5, v6, 3, v5
    v_lshrrev_b32 v6, 1, v4
    v_bfe_u32 v7, v1, 4, 1
    v_lshl_add_u32 v6, v7, 1, v6
    v_lshl_add_u32 v5, v6, 4, v5
    s_mul_i32 s30, s33, 2
    s_add_u32 s30, s30, 0
    v_xor_b32 v6, s30, v3
    v_lshl_add_u32 v6, v6, 6, v5
    v_add_u32 v164, 32768, v6
    s_mul_i32 s30, s33, 2
    s_add_u32 s30, s30, 1
    v_xor_b32 v6, s30, v3
    v_lshl_add_u32 v6, v6, 6, v5
    v_add_u32 v165, 32768, v6
    v_lshrrev_b32 v2, 4, v1
    v_and_b32 v3, 15, v1
    s_lshl_b32 s30, s35, 2
    v_add_u32 v4, s30, v2
    v_xor_b32 v4, v4, v3
    v_lshlrev_b32 v4, 4, v4
    v_lshl_add_u32 v12, v2, 8, v4
    v_lshlrev_b32 v4, 2, v2
    v_xor_b32 v4, v4, v3
    v_lshlrev_b32 v4, 4, v4
    v_lshl_add_u32 v13, v2, 8, v4
    v_and_b32 v2, 31, v1
    v_and_b32 v3, 15, v1
    v_lshrrev_b32 v4, 5, v1
    v_xor_b32 v3, v3, v4
    v_lshlrev_b32 v2, 8, v2
    s_lshl_b32 s30, s34, 16
    v_add_u32 v2, s30, v2
    v_xor_b32 v5, 0, v3
    v_lshl_add_u32 v14, v5, 4, v2
    v_xor_b32 v5, 2, v3
    v_lshl_add_u32 v15, v5, 4, v2
    v_xor_b32 v5, 4, v3
    v_lshl_add_u32 v16, v5, 4, v2
    v_xor_b32 v5, 6, v3
    v_lshl_add_u32 v17, v5, 4, v2
    v_xor_b32 v5, 8, v3
    v_lshl_add_u32 v18, v5, 4, v2
    v_xor_b32 v5, 10, v3
    v_lshl_add_u32 v19, v5, 4, v2
    v_xor_b32 v5, 12, v3
    v_lshl_add_u32 v20, v5, 4, v2
    v_xor_b32 v5, 14, v3
    v_lshl_add_u32 v21, v5, 4, v2
    v_and_b32 v2, 15, v1
    v_lshrrev_b32 v3, 2, v2
    v_and_b32 v4, 3, v2
    v_lshrrev_b32 v5, 5, v1
    v_lshl_add_u32 v5, v5, 2, v3
    v_lshlrev_b32 v5, 8, v5
    v_and_b32 v6, 1, v4
    v_lshl_add_u32 v5, v6, 3, v5
    v_lshrrev_b32 v6, 1, v4
    v_bfe_u32 v7, v1, 4, 1
    v_lshl_add_u32 v6, v7, 1, v6
    v_lshl_add_u32 v5, v6, 4, v5
    s_add_u32 s30, s30, 16384
    v_add_u32 v5, s30, v5
    v_xor_b32 v6, 0, v3
    v_lshl_add_u32 v22, v6, 6, v5
    v_xor_b32 v6, 1, v3
    v_lshl_add_u32 v23, v6, 6, v5
    v_xor_b32 v6, 2, v3
    v_lshl_add_u32 v24, v6, 6, v5
    v_xor_b32 v6, 3, v3
    v_lshl_add_u32 v25, v6, 6, v5
    v_and_b32 v2, 31, v1
    s_lshl_b32 s30, s35, 5
    s_lshl_b32 s31, s34, 6
    s_sub_u32 s30, s30, s31
    v_add_u32 v2, s30, v2
    v_lshrrev_b32 v3, 5, v1
    v_lshlrev_b32 v3, 2, v3
    v_sub_u32 v29, v2, v3
    v_and_b32 v2, 31, v1
    v_lshrrev_b32 v3, 5, v1
    v_lshlrev_b32 v3, 4, v3
    v_lshl_add_u32 v30, v2, 8, v3
    v_mov_b32 v31, 0xf149f2ca
    s_mov_b32 s43, 0
    s_waitcnt vmcnt(6)
    s_barrier
    ds_read_b64_tr_b16 v[128:129], v164 offset:0
    ds_read_b64_tr_b16 v[130:131], v164 offset:1024
    ds_read_b64_tr_b16 v[132:133], v165 offset:0
    ds_read_b64_tr_b16 v[134:135], v165 offset:1024
    ds_read_b128 v[144:147], v168 offset:0
    ds_read_b128 v[148:151], v168 offset:4096
    ds_read_b64_tr_b16 v[136:137], v164 offset:4096
    ds_read_b64_tr_b16 v[138:139], v164 offset:5120
    ds_read_b64_tr_b16 v[140:141], v165 offset:4096
    ds_read_b64_tr_b16 v[142:143], v165 offset:5120
    ds_read_b128 v[152:155], v169 offset:0
    ds_read_b128 v[156:159], v169 offset:4096
    s_waitcnt lgkmcnt(6)
    v_mfma_f32_32x32x16_bf16 v[64:79], v[128:131], v[144:147], 0
    v_mfma_f32_32x32x16_bf16 v[80:95], v[128:131], v[148:151], 0
    s_add_u32 m0, s29, 98304
    s_add_u32 s30, s25, 0
    buffer_load_dwordx4 v160, s[4:7], s30 offen lds
    v_mfma_f32_32x32x16_bf16 v[96:111], v[132:135], v[144:147], 0
    v_mfma_f32_32x32x16_bf16 v[112:127], v[132:135], v[148:151], 0
    s_add_u32 m0, s29, 106496
    s_add_u32 s30, s25, 32768
    buffer_load_dwordx4 v160, s[4:7], s30 offen lds
    ds_read_b64_tr_b16 v[128:129], v164 offset:8192
    ds_read_b64_tr_b16 v[130:131], v164 offset:9216
    ds_read_b64_tr_b16 v[132:133], v165 offset:8192
    ds_read_b64_tr_b16 v[134:135], v165 offset:9216
    ds_read_b128 v[144:147], v170 offset:0
    ds_read_b128 v[148:151], v170 offset:4096
    s_waitcnt lgkmcnt(6)
    v_mfma_f32_32x32x16_bf16 v[64:79], v[136:139], v[152:155], v[64:79]
    v_mfma_f32_32x32x16_bf16 v[80:95], v[136:139], v[156:159], v[80:95]
    s_add_u32 m0, s29, 114688
    s_add_u32 s30, s25, 65536
    buffer_load_dwordx4 v160, s[4:7], s30 offen lds
    v_mfma_f32_32x32x16_bf16 v[96:111], v[140:143], v[152:155], v[96:111]
    v_mfma_f32_32x32x16_bf16 v[112:127], v[140:143], v[156:159], v[112:127]
    s_add_u32 m0, s29, 122880
    s_add_u32 s30, s25, 98304
    buffer_load_dwordx4 v160, s[4:7], s30 offen lds
    s_add_u32 s25, s25, 128
    ds_read_b64_tr_b16 v[136:137], v164 offset:12288
    ds_read_b64_tr_b16 v[138:139], v164 offset:13312
    ds_read_b64_tr_b16 v[140:141], v165 offset:12288
    ds_read_b64_tr_b16 v[142:143], v165 offset:13312
    ds_read_b128 v[152:155], v171 offset:0
    ds_read_b128 v[156:159], v171 offset:4096
    s_waitcnt lgkmcnt(6)
    v_mfma_f32_32x32x16_bf16 v[64:79], v[128:131], v[144:147], v[64:79]
    v_mfma_f32_32x32x16_bf16 v[80:95], v[128:131], v[148:151], v[80:95]
    s_add_u32 m0, s29, 131072
    s_add_u32 s30, s26, 0
    buffer_load_dwordx4 v161, s[8:11], s30 offen lds
    v_mfma_f32_32x32x16_bf16 v[96:111], v[132:135], v[144:147], v[96:111]
    v_mfma_f32_32x32x16_bf16 v[112:127], v[132:135], v[148:151], v[112:127]
    s_add_u32 m0, s29, 139264
    s_add_u32 s30, s26, 262144
    buffer_load_dwordx4 v161, s[8:11], s30 offen lds
    s_add_u32 s26, s26, 524288
    s_waitcnt lgkmcnt(0)
    v_add_u32 v164, 49152, v164
    v_add_u32 v165, 49152, v165
    v_add_u32 v168, 49152, v168
    v_add_u32 v169, 49152, v169
    v_add_u32 v170, 49152, v170
    v_add_u32 v171, 49152, v171
    v_mfma_f32_32x32x16_bf16 v[64:79], v[136:139], v[152:155], v[64:79]
    v_mfma_f32_32x32x16_bf16 v[80:95], v[136:139], v[156:159], v[80:95]
    s_waitcnt vmcnt(6)
    s_barrier
    ds_read_b64_tr_b16 v[128:129], v164 offset:0
    ds_read_b64_tr_b16 v[130:131], v164 offset:1024
    ds_read_b64_tr_b16 v[132:133], v165 offset:0
    ds_read_b64_tr_b16 v[134:135], v165 offset:1024
    ds_read_b128 v[144:147], v168 offset:0
    ds_read_b128 v[148:151], v168 offset:4096
    v_mfma_f32_32x32x16_bf16 v[96:111], v[140:143], v[152:155], v[96:111]
    v_mfma_f32_32x32x16_bf16 v[112:127], v[140:143], v[156:159], v[112:127]
    ds_read_b64_tr_b16 v[136:137], v164 offset:4096
    ds_read_b64_tr_b16 v[138:139], v164 offset:5120
    ds_read_b64_tr_b16 v[140:141], v165 offset:4096
    ds_read_b64_tr_b16 v[142:143], v165 offset:5120
    ds_read_b128 v[152:155], v169 offset:0
    ds_read_b128 v[156:159], v169 offset:4096
    s_waitcnt lgkmcnt(6)
    v_mfma_f32_32x32x16_bf16 v[64:79], v[128:131], v[144:147], v[64:79]
    v_mfma_f32_32x32x16_bf16 v[80:95], v[128:131], v[148:151], v[80:95]
    s_add_u32 m0, s29, 0
    s_add_u32 s30, s25, 0
    buffer_load_dwordx4 v160, s[4:7], s30 offen lds
    v_mfma_f32_32x32x16_bf16 v[96:111], v[132:135], v[144:147], v[96:111]
    v_mfma_f32_32x32x16_bf16 v[112:127], v[132:135], v[148:151], v[112:127]
    s_add_u32 m0, s29, 8192
    s_add_u32 s30, s25, 32768
    buffer_load_dwordx4 v160, s[4:7], s30 offen lds
    ds_read_b64_tr_b16 v[128:129], v164 offset:8192
    ds_read_b64_tr_b16 v[130:131], v164 offset:9216
    ds_read_b64_tr_b16 v[132:133], v165 offset:8192
    ds_read_b64_tr_b16 v[134:135], v165 offset:9216
    ds_read_b128 v[144:147], v170 offset:0
    ds_read_b128 v[148:151], v170 offset:4096
    s_waitcnt lgkmcnt(6)
    v_mfma_f32_32x32x16_bf16 v[64:79], v[136:139], v[152:155], v[64:79]
    v_mfma_f32_32x32x16_bf16 v[80:95], v[136:139], v[156:159], v[80:95]
    s_add_u32 m0, s29, 16384
    s_add_u32 s30, s25, 65536
    buffer_load_dwordx4 v160, s[4:7], s30 offen lds
    v_mfma_f32_32x32x16_bf16 v[96:111], v[140:143], v[152:155], v[96:111]
    v_mfma_f32_32x32x16_bf16 v[112:127], v[140:143], v[156:159], v[112:127]
    s_add_u32 m0, s29, 24576
    s_add_u32 s30, s25, 98304
    buffer_load_dwordx4 v160, s[4:7], s30 offen lds
    s_add_u32 s25, s25, 128
    ds_read_b64_tr_b16 v[136:137], v164 offset:12288
    ds_read_b64_tr_b16 v[138:139], v164 offset:13312
    ds_read_b64_tr_b16 v[140:141], v165 offset:12288
    ds_read_b64_tr_b16 v[142:143], v165 offset:13312
    ds_read_b128 v[152:155], v171 offset:0
    ds_read_b128 v[156:159], v171 offset:4096
    s_waitcnt lgkmcnt(6)
    v_mfma_f32_32x32x16_bf16 v[64:79], v[128:131], v[144:147], v[64:79]
    v_mfma_f32_32x32x16_bf16 v[80:95], v[128:131], v[148:151], v[80:95]
    s_add_u32 m0, s29, 32768
    s_add_u32 s30, s26, 0
    buffer_load_dwordx4 v161, s[8:11], s30 offen lds
    v_mfma_f32_32x32x16_bf16 v[96:111], v[132:135], v[144:147], v[96:111]
    v_mfma_f32_32x32x16_bf16 v[112:127], v[132:135], v[148:151], v[112:127]
    s_add_u32 m0, s29, 40960
    s_add_u32 s30, s26, 262144
    buffer_load_dwordx4 v161, s[8:11], s30 offen lds
    s_add_u32 s26, s26, 524288
    s_waitcnt lgkmcnt(0)
    v_add_u32 v164, 49152, v164
    v_add_u32 v165, 49152, v165
    v_add_u32 v168, 49152, v168
    v_add_u32 v169, 49152, v169
    v_add_u32 v170, 49152, v170
    v_add_u32 v171, 49152, v171
    v_mfma_f32_32x32x16_bf16 v[64:79], v[136:139], v[152:155], v[64:79]
    v_mfma_f32_32x32x16_bf16 v[80:95], v[136:139], v[156:159], v[80:95]
    s_waitcnt vmcnt(6)
    s_barrier
    ds_read_b64_tr_b16 v[128:129], v164 offset:0
    ds_read_b64_tr_b16 v[130:131], v164 offset:1024
    ds_read_b64_tr_b16 v[132:133], v165 offset:0
    ds_read_b64_tr_b16 v[134:135], v165 offset:1024
    ds_read_b128 v[144:147], v168 offset:0
    ds_read_b128 v[148:151], v168 offset:4096
    v_mfma_f32_32x32x16_bf16 v[96:111], v[140:143], v[152:155], v[96:111]
    v_mfma_f32_32x32x16_bf16 v[112:127], v[140:143], v[156:159], v[112:127]
    ds_read_b64_tr_b16 v[136:137], v164 offset:4096
    ds_read_b64_tr_b16 v[138:139], v164 offset:5120
    ds_read_b64_tr_b16 v[140:141], v165 offset:4096
    ds_read_b64_tr_b16 v[142:143], v165 offset:5120
    ds_read_b128 v[152:155], v169 offset:0
    ds_read_b128 v[156:159], v169 offset:4096
    s_waitcnt lgkmcnt(6)
    v_mfma_f32_32x32x16_bf16 v[64:79], v[128:131], v[144:147], v[64:79]
    v_mfma_f32_32x32x16_bf16 v[80:95], v[128:131], v[148:151], v[80:95]
    s_add_u32 m0, s29, 49152
    s_add_u32 s30, s25, 0
    buffer_load_dwordx4 v160, s[4:7], s30 offen lds
    v_mfma_f32_32x32x16_bf16 v[96:111], v[132:135], v[144:147], v[96:111]
    v_mfma_f32_32x32x16_bf16 v[112:127], v[132:135], v[148:151], v[112:127]
    s_add_u32 m0, s29, 57344
    s_add_u32 s30, s25, 32768
    buffer_load_dwordx4 v160, s[4:7], s30 offen lds
    ds_read_b64_tr_b16 v[128:129], v164 offset:8192
    ds_read_b64_tr_b16 v[130:131], v164 offset:9216
    ds_read_b64_tr_b16 v[132:133], v165 offset:8192
    ds_read_b64_tr_b16 v[134:135], v165 offset:9216
    ds_read_b128 v[144:147], v170 offset:0
    ds_read_b128 v[148:151], v170 offset:4096
    s_waitcnt lgkmcnt(6)
    v_mfma_f32_32x32x16_bf16 v[64:79], v[136:139], v[152:155], v[64:79]
    v_mfma_f32_32x32x16_bf16 v[80:95], v[136:139], v[156:159], v[80:95]
    s_add_u32 m0, s29, 65536
    s_add_u32 s30, s25, 65536
    buffer_load_dwordx4 v160, s[4:7], s30 offen lds
    v_mfma_f32_32x32x16_bf16 v[96:111], v[140:143], v[152:155], v[96:111]
    v_mfma_f32_32x32x16_bf16 v[112:127], v[140:143], v[156:159], v[112:127]
    s_add_u32 m0, s29, 73728
    s_add_u32 s30, s25, 98304
    buffer_load_dwordx4 v160, s[4:7], s30 offen lds
    s_add_u32 s25, s25, 128
    ds_read_b64_tr_b16 v[136:137], v164 offset:12288
    ds_read_b64_tr_b16 v[138:139], v164 offset:13312
    ds_read_b64_tr_b16 v[140:141], v165 offset:12288
    ds_read_b64_tr_b16 v[142:143], v165 offset:13312
    ds_read_b128 v[152:155], v171 offset:0
    ds_read_b128 v[156:159], v171 offset:4096
    s_waitcnt lgkmcnt(6)
    v_mfma_f32_32x32x16_bf16 v[64:79], v[128:131], v[144:147], v[64:79]
    v_mfma_f32_32x32x16_bf16 v[80:95], v[128:131], v[148:151], v[80:95]
    s_add_u32 m0, s29, 81920
    s_add_u32 s30, s26, 0
    buffer_load_dwordx4 v161, s[8:11], s30 offen lds
    v_mfma_f32_32x32x16_bf16 v[96:111], v[132:135], v[144:147], v[96:111]
    v_mfma_f32_32x32x16_bf16 v[112:127], v[132:135], v[148:151], v[112:127]
    s_add_u32 m0, s29, 90112
    s_add_u32 s30, s26, 262144
    buffer_load_dwordx4 v161, s[8:11], s30 offen lds
    s_add_u32 s26, s26, 524288
    s_waitcnt lgkmcnt(0)
    v_add_u32 v164, 4294868992, v164
    v_add_u32 v165, 4294868992, v165
    v_add_u32 v168, 4294868992, v168
    v_add_u32 v169, 4294868992, v169
    v_add_u32 v170, 4294868992, v170
    v_add_u32 v171, 4294868992, v171
    v_mfma_f32_32x32x16_bf16 v[64:79], v[136:139], v[152:155], v[64:79]
    v_mfma_f32_32x32x16_bf16 v[80:95], v[136:139], v[156:159], v[80:95]
    s_waitcnt vmcnt(6)
    s_barrier
    ds_read_b64_tr_b16 v[128:129], v164 offset:0
    ds_read_b64_tr_b16 v[130:131], v164 offset:1024
    ds_read_b64_tr_b16 v[132:133], v165 offset:0
    ds_read_b64_tr_b16 v[134:135], v165 offset:1024
    ds_read_b128 v[144:147], v168 offset:0
    ds_read_b128 v[148:151], v168 offset:4096
    v_mfma_f32_32x32x16_bf16 v[96:111], v[140:143], v[152:155], v[96:111]
    v_mfma_f32_32x32x16_bf16 v[112:127], v[140:143], v[156:159], v[112:127]
    ds_read_b64_tr_b16 v[136:137], v164 offset:4096
    ds_read_b64_tr_b16 v[138:139], v164 offset:5120
    ds_read_b64_tr_b16 v[140:141], v165 offset:4096
    ds_read_b64_tr_b16 v[142:143], v165 offset:5120
    ds_read_b128 v[152:155], v169 offset:0
    ds_read_b128 v[156:159], v169 offset:4096
    s_waitcnt lgkmcnt(6)
    v_mfma_f32_32x32x16_bf16 v[64:79], v[128:131], v[144:147], v[64:79]
    v_mfma_f32_32x32x16_bf16 v[80:95], v[128:131], v[148:151], v[80:95]
    s_add_u32 m0, s29, 98304
    s_add_u32 s30, s25, 0
    buffer_load_dwordx4 v160, s[4:7], s30 offen lds
    v_mfma_f32_32x32x16_bf16 v[96:111], v[132:135], v[144:147], v[96:111]
    v_mfma_f32_32x32x16_bf16 v[112:127], v[132:135], v[148:151], v[112:127]
    s_add_u32 m0, s29, 106496
    s_add_u32 s30, s25, 32768
    buffer_load_dwordx4 v160, s[4:7], s30 offen lds
    ds_read_b64_tr_b16 v[128:129], v164 offset:8192
    ds_read_b64_tr_b16 v[130:131], v164 offset:9216
    ds_read_b64_tr_b16 v[132:133], v165 offset:8192
    ds_read_b64_tr_b16 v[134:135], v165 offset:9216
    ds_read_b128 v[144:147], v170 offset:0
    ds_read_b128 v[148:151], v170 offset:4096
    s_waitcnt lgkmcnt(6)
    v_mfma_f32_32x32x16_bf16 v[64:79], v[136:139], v[152:155], v[64:79]
    v_mfma_f32_32x32x16_bf16 v[80:95], v[136:139], v[156:159], v[80:95]
    s_add_u32 m0, s29, 114688
    s_add_u32 s30, s25, 65536
    buffer_load_dwordx4 v160, s[4:7], s30 offen lds
    v_mfma_f32_32x32x16_bf16 v[96:111], v[140:143], v[152:155], v[96:111]
    v_mfma_f32_32x32x16_bf16 v[112:127], v[140:143], v[156:159], v[112:127]
    s_add_u32 m0, s29, 122880
    s_add_u32 s30, s25, 98304
    buffer_load_dwordx4 v160, s[4:7], s30 offen lds
    s_add_u32 s25, s25, 128
    ds_read_b64_tr_b16 v[136:137], v164 offset:12288
    ds_read_b64_tr_b16 v[138:139], v164 offset:13312
    ds_read_b64_tr_b16 v[140:141], v165 offset:12288
    ds_read_b64_tr_b16 v[142:143], v165 offset:13312
    ds_read_b128 v[152:155], v171 offset:0
    ds_read_b128 v[156:159], v171 offset:4096
    s_waitcnt lgkmcnt(6)
    v_mfma_f32_32x32x16_bf16 v[64:79], v[128:131], v[144:147], v[64:79]
    v_mfma_f32_32x32x16_bf16 v[80:95], v[128:131], v[148:151], v[80:95]
    s_add_u32 m0, s29, 131072
    s_add_u32 s30, s26, 0
    buffer_load_dwordx4 v161, s[8:11], s30 offen lds
    v_mfma_f32_32x32x16_bf16 v[96:111], v[132:135], v[144:147], v[96:111]
    v_mfma_f32_32x32x16_bf16 v[112:127], v[132:135], v[148:151], v[112:127]
    s_add_u32 m0, s29, 139264
    s_add_u32 s30, s26, 262144
    buffer_load_dwordx4 v161, s[8:11], s30 offen lds
    s_add_u32 s26, s26, 524288
    s_waitcnt lgkmcnt(0)
    v_add_u32 v164, 49152, v164
    v_add_u32 v165, 49152, v165
    v_add_u32 v168, 49152, v168
    v_add_u32 v169, 49152, v169
    v_add_u32 v170, 49152, v170
    v_add_u32 v171, 49152, v171
    v_mfma_f32_32x32x16_bf16 v[64:79], v[136:139], v[152:155], v[64:79]
    v_mfma_f32_32x32x16_bf16 v[80:95], v[136:139], v[156:159], v[80:95]
    s_waitcnt vmcnt(6)
    s_barrier
    ds_read_b64_tr_b16 v[128:129], v164 offset:0
    ds_read_b64_tr_b16 v[130:131], v164 offset:1024
    ds_read_b64_tr_b16 v[132:133], v165 offset:0
    ds_read_b64_tr_b16 v[134:135], v165 offset:1024
    ds_read_b128 v[144:147], v168 offset:0
    ds_read_b128 v[148:151], v168 offset:4096
    v_mfma_f32_32x32x16_bf16 v[96:111], v[140:143], v[152:155], v[96:111]
    v_mfma_f32_32x32x16_bf16 v[112:127], v[140:143], v[156:159], v[112:127]
    ds_read_b64_tr_b16 v[136:137], v164 offset:4096
    ds_read_b64_tr_b16 v[138:139], v164 offset:5120
    ds_read_b64_tr_b16 v[140:141], v165 offset:4096
    ds_read_b64_tr_b16 v[142:143], v165 offset:5120
    ds_read_b128 v[152:155], v169 offset:0
    ds_read_b128 v[156:159], v169 offset:4096
    s_waitcnt lgkmcnt(6)
    v_mfma_f32_32x32x16_bf16 v[64:79], v[128:131], v[144:147], v[64:79]
    v_mfma_f32_32x32x16_bf16 v[80:95], v[128:131], v[148:151], v[80:95]
    s_add_u32 m0, s29, 0
    s_add_u32 s30, s25, 0
    buffer_load_dwordx4 v160, s[4:7], s30 offen lds
    v_mfma_f32_32x32x16_bf16 v[96:111], v[132:135], v[144:147], v[96:111]
    v_mfma_f32_32x32x16_bf16 v[112:127], v[132:135], v[148:151], v[112:127]
    s_add_u32 m0, s29, 8192
    s_add_u32 s30, s25, 32768
    buffer_load_dwordx4 v160, s[4:7], s30 offen lds
    ds_read_b64_tr_b16 v[128:129], v164 offset:8192
    ds_read_b64_tr_b16 v[130:131], v164 offset:9216
    ds_read_b64_tr_b16 v[132:133], v165 offset:8192
    ds_read_b64_tr_b16 v[134:135], v165 offset:9216
    ds_read_b128 v[144:147], v170 offset:0
    ds_read_b128 v[148:151], v170 offset:4096
    s_waitcnt lgkmcnt(6)
    v_mfma_f32_32x32x16_bf16 v[64:79], v[136:139], v[152:155], v[64:79]
    v_mfma_f32_32x32x16_bf16 v[80:95], v[136:139], v[156:159], v[80:95]
    s_add_u32 m0, s29, 16384
    s_add_u32 s30, s25, 65536
    buffer_load_dwordx4 v160, s[4:7], s30 offen lds
    v_mfma_f32_32x32x16_bf16 v[96:111], v[140:143], v[152:155], v[96:111]
    v_mfma_f32_32x32x16_bf16 v[112:127], v[140:143], v[156:159], v[112:127]
    s_add_u32 m0, s29, 24576
    s_add_u32 s30, s25, 98304
    buffer_load_dwordx4 v160, s[4:7], s30 offen lds
    s_add_u32 s25, s25, 128
    ds_read_b64_tr_b16 v[136:137], v164 offset:12288
    ds_read_b64_tr_b16 v[138:139], v164 offset:13312
    ds_read_b64_tr_b16 v[140:141], v165 offset:12288
    ds_read_b64_tr_b16 v[142:143], v165 offset:13312
    ds_read_b128 v[152:155], v171 offset:0
    ds_read_b128 v[156:159], v171 offset:4096
    s_waitcnt lgkmcnt(6)
    v_mfma_f32_32x32x16_bf16 v[64:79], v[128:131], v[144:147], v[64:79]
    v_mfma_f32_32x32x16_bf16 v[80:95], v[128:131], v[148:151], v[80:95]
    s_add_u32 m0, s29, 32768
    s_add_u32 s30, s26, 0
    buffer_load_dwordx4 v161, s[8:11], s30 offen lds
    v_mfma_f32_32x32x16_bf16 v[96:111], v[132:135], v[144:147], v[96:111]
    v_mfma_f32_32x32x16_bf16 v[112:127], v[132:135], v[148:151], v[112:127]
    s_add_u32 m0, s29, 40960
    s_add_u32 s30, s26, 262144
    buffer_load_dwordx4 v161, s[8:11], s30 offen lds
    s_add_u32 s26, s26, 524288
    s_waitcnt lgkmcnt(0)
    v_add_u32 v164, 49152, v164
    v_add_u32 v165, 49152, v165
    v_add_u32 v168, 49152, v168
    v_add_u32 v169, 49152, v169
    v_add_u32 v170, 49152, v170
    v_add_u32 v171, 49152, v171
    v_mfma_f32_32x32x16_bf16 v[64:79], v[136:139], v[152:155], v[64:79]
    v_mfma_f32_32x32x16_bf16 v[80:95], v[136:139], v[156:159], v[80:95]
    s_waitcnt vmcnt(6)
    s_barrier
    ds_read_b64_tr_b16 v[128:129], v164 offset:0
    ds_read_b64_tr_b16 v[130:131], v164 offset:1024
    ds_read_b64_tr_b16 v[132:133], v165 offset:0
    ds_read_b64_tr_b16 v[134:135], v165 offset:1024
    ds_read_b128 v[144:147], v168 offset:0
    ds_read_b128 v[148:151], v168 offset:4096
    v_mfma_f32_32x32x16_bf16 v[96:111], v[140:143], v[152:155], v[96:111]
    v_mfma_f32_32x32x16_bf16 v[112:127], v[140:143], v[156:159], v[112:127]
    ds_read_b64_tr_b16 v[136:137], v164 offset:4096
    ds_read_b64_tr_b16 v[138:139], v164 offset:5120
    ds_read_b64_tr_b16 v[140:141], v165 offset:4096
    ds_read_b64_tr_b16 v[142:143], v165 offset:5120
    ds_read_b128 v[152:155], v169 offset:0
    ds_read_b128 v[156:159], v169 offset:4096
    s_waitcnt lgkmcnt(6)
    v_mfma_f32_32x32x16_bf16 v[64:79], v[128:131], v[144:147], v[64:79]
    v_mfma_f32_32x32x16_bf16 v[80:95], v[128:131], v[148:151], v[80:95]
    s_add_u32 m0, s29, 49152
    s_add_u32 s30, s25, 0
    buffer_load_dwordx4 v160, s[4:7], s30 offen lds
    v_mfma_f32_32x32x16_bf16 v[96:111], v[132:135], v[144:147], v[96:111]
    v_mfma_f32_32x32x16_bf16 v[112:127], v[132:135], v[148:151], v[112:127]
    s_add_u32 m0, s29, 57344
    s_add_u32 s30, s25, 32768
    buffer_load_dwordx4 v160, s[4:7], s30 offen lds
    ds_read_b64_tr_b16 v[128:129], v164 offset:8192
    ds_read_b64_tr_b16 v[130:131], v164 offset:9216
    ds_read_b64_tr_b16 v[132:133], v165 offset:8192
    ds_read_b64_tr_b16 v[134:135], v165 offset:9216
    ds_read_b128 v[144:147], v170 offset:0
    ds_read_b128 v[148:151], v170 offset:4096
    s_waitcnt lgkmcnt(6)
    v_mfma_f32_32x32x16_bf16 v[64:79], v[136:139], v[152:155], v[64:79]
    v_mfma_f32_32x32x16_bf16 v[80:95], v[136:139], v[156:159], v[80:95]
    s_add_u32 m0, s29, 65536
    s_add_u32 s30, s25, 65536
    buffer_load_dwordx4 v160, s[4:7], s30 offen lds
    v_mfma_f32_32x32x16_bf16 v[96:111], v[140:143], v[152:155], v[96:111]
    v_mfma_f32_32x32x16_bf16 v[112:127], v[140:143], v[156:159], v[112:127]
    s_add_u32 m0, s29, 73728
    s_add_u32 s30, s25, 98304
    buffer_load_dwordx4 v160, s[4:7], s30 offen lds
    s_add_u32 s25, s25, 128
    ds_read_b64_tr_b16 v[136:137], v164 offset:12288
    ds_read_b64_tr_b16 v[138:139], v164 offset:13312
    ds_read_b64_tr_b16 v[140:141], v165 offset:12288
    ds_read_b64_tr_b16 v[142:143], v165 offset:13312
    ds_read_b128 v[152:155], v171 offset:0
    ds_read_b128 v[156:159], v171 offset:4096
    s_waitcnt lgkmcnt(6)
    v_mfma_f32_32x32x16_bf16 v[64:79], v[128:131], v[144:147], v[64:79]
    v_mfma_f32_32x32x16_bf16 v[80:95], v[128:131], v[148:151], v[80:95]
    s_add_u32 m0, s29, 81920
    s_add_u32 s30, s26, 0
    buffer_load_dwordx4 v161, s[8:11], s30 offen lds
    v_mfma_f32_32x32x16_bf16 v[96:111], v[132:135], v[144:147], v[96:111]
    v_mfma_f32_32x32x16_bf16 v[112:127], v[132:135], v[148:151], v[112:127]
    s_add_u32 m0, s29, 90112
    s_add_u32 s30, s26, 262144
    buffer_load_dwordx4 v161, s[8:11], s30 offen lds
    s_add_u32 s26, s26, 524288
    s_waitcnt lgkmcnt(0)
    v_add_u32 v164, 4294868992, v164
    v_add_u32 v165, 4294868992, v165
    v_add_u32 v168, 4294868992, v168
    v_add_u32 v169, 4294868992, v169
    v_add_u32 v170, 4294868992, v170
    v_add_u32 v171, 4294868992, v171
    v_mfma_f32_32x32x16_bf16 v[64:79], v[136:139], v[152:155], v[64:79]
    v_mfma_f32_32x32x16_bf16 v[80:95], v[136:139], v[156:159], v[80:95]
    s_waitcnt vmcnt(6)
    s_barrier
    ds_read_b64_tr_b16 v[128:129], v164 offset:0
    ds_read_b64_tr_b16 v[130:131], v164 offset:1024
    ds_read_b64_tr_b16 v[132:133], v165 offset:0
    ds_read_b64_tr_b16 v[134:135], v165 offset:1024
    ds_read_b128 v[144:147], v168 offset:0
    ds_read_b128 v[148:151], v168 offset:4096
    v_mfma_f32_32x32x16_bf16 v[96:111], v[140:143], v[152:155], v[96:111]
    v_mfma_f32_32x32x16_bf16 v[112:127], v[140:143], v[156:159], v[112:127]
    ds_read_b64_tr_b16 v[136:137], v164 offset:4096
    ds_read_b64_tr_b16 v[138:139], v164 offset:5120
    ds_read_b64_tr_b16 v[140:141], v165 offset:4096
    ds_read_b64_tr_b16 v[142:143], v165 offset:5120
    ds_read_b128 v[152:155], v169 offset:0
    ds_read_b128 v[156:159], v169 offset:4096
    s_waitcnt lgkmcnt(6)
    v_mfma_f32_32x32x16_bf16 v[64:79], v[128:131], v[144:147], v[64:79]
    v_mfma_f32_32x32x16_bf16 v[80:95], v[128:131], v[148:151], v[80:95]
    v_mfma_f32_32x32x16_bf16 v[96:111], v[132:135], v[144:147], v[96:111]
    v_mfma_f32_32x32x16_bf16 v[112:127], v[132:135], v[148:151], v[112:127]
    ds_read_b64_tr_b16 v[128:129], v164 offset:8192
    ds_read_b64_tr_b16 v[130:131], v164 offset:9216
    ds_read_b64_tr_b16 v[132:133], v165 offset:8192
    ds_read_b64_tr_b16 v[134:135], v165 offset:9216
    ds_read_b128 v[144:147], v170 offset:0
    ds_read_b128 v[148:151], v170 offset:4096
    s_waitcnt lgkmcnt(6)
    v_mfma_f32_32x32x16_bf16 v[64:79], v[136:139], v[152:155], v[64:79]
    v_mfma_f32_32x32x16_bf16 v[80:95], v[136:139], v[156:159], v[80:95]
    v_mfma_f32_32x32x16_bf16 v[96:111], v[140:143], v[152:155], v[96:111]
    v_mfma_f32_32x32x16_bf16 v[112:127], v[140:143], v[156:159], v[112:127]
    ds_read_b64_tr_b16 v[136:137], v164 offset:12288
    ds_read_b64_tr_b16 v[138:139], v164 offset:13312
    ds_read_b64_tr_b16 v[140:141], v165 offset:12288
    ds_read_b64_tr_b16 v[142:143], v165 offset:13312
    ds_read_b128 v[152:155], v171 offset:0
    ds_read_b128 v[156:159], v171 offset:4096
    s_waitcnt lgkmcnt(6)
    v_mfma_f32_32x32x16_bf16 v[64:79], v[128:131], v[144:147], v[64:79]
    v_mfma_f32_32x32x16_bf16 v[80:95], v[128:131], v[148:151], v[80:95]
    v_mfma_f32_32x32x16_bf16 v[96:111], v[132:135], v[144:147], v[96:111]
    v_mfma_f32_32x32x16_bf16 v[112:127], v[132:135], v[148:151], v[112:127]
    s_waitcnt lgkmcnt(0)
    v_add_u32 v164, 49152, v164
    v_add_u32 v165, 49152, v165
    v_add_u32 v168, 49152, v168
    v_add_u32 v169, 49152, v169
    v_add_u32 v170, 49152, v170
    v_add_u32 v171, 49152, v171
    v_mfma_f32_32x32x16_bf16 v[64:79], v[136:139], v[152:155], v[64:79]
    v_mfma_f32_32x32x16_bf16 v[80:95], v[136:139], v[156:159], v[80:95]
    s_waitcnt vmcnt(0)
    s_barrier
    ds_read_b64_tr_b16 v[128:129], v164 offset:0
    ds_read_b64_tr_b16 v[130:131], v164 offset:1024
    ds_read_b64_tr_b16 v[132:133], v165 offset:0
    ds_read_b64_tr_b16 v[134:135], v165 offset:1024
    ds_read_b128 v[144:147], v168 offset:0
    ds_read_b128 v[148:151], v168 offset:4096
    v_mfma_f32_32x32x16_bf16 v[96:111], v[140:143], v[152:155], v[96:111]
    v_mfma_f32_32x32x16_bf16 v[112:127], v[140:143], v[156:159], v[112:127]
    ds_read_b64_tr_b16 v[136:137], v164 offset:4096
    ds_read_b64_tr_b16 v[138:139], v164 offset:5120
    ds_read_b64_tr_b16 v[140:141], v165 offset:4096
    ds_read_b64_tr_b16 v[142:143], v165 offset:5120
    ds_read_b128 v[152:155], v169 offset:0
    ds_read_b128 v[156:159], v169 offset:4096
    s_waitcnt lgkmcnt(6)
    v_mfma_f32_32x32x16_bf16 v[64:79], v[128:131], v[144:147], v[64:79]
    v_mfma_f32_32x32x16_bf16 v[80:95], v[128:131], v[148:151], v[80:95]
    v_mfma_f32_32x32x16_bf16 v[96:111], v[132:135], v[144:147], v[96:111]
    v_mfma_f32_32x32x16_bf16 v[112:127], v[132:135], v[148:151], v[112:127]
    ds_read_b64_tr_b16 v[128:129], v164 offset:8192
    ds_read_b64_tr_b16 v[130:131], v164 offset:9216
    ds_read_b64_tr_b16 v[132:133], v165 offset:8192
    ds_read_b64_tr_b16 v[134:135], v165 offset:9216
    ds_read_b128 v[144:147], v170 offset:0
    ds_read_b128 v[148:151], v170 offset:4096
    s_waitcnt lgkmcnt(6)
    v_mfma_f32_32x32x16_bf16 v[64:79], v[136:139], v[152:155], v[64:79]
    v_mfma_f32_32x32x16_bf16 v[80:95], v[136:139], v[156:159], v[80:95]
    v_mfma_f32_32x32x16_bf16 v[96:111], v[140:143], v[152:155], v[96:111]
    v_mfma_f32_32x32x16_bf16 v[112:127], v[140:143], v[156:159], v[112:127]
    ds_read_b64_tr_b16 v[136:137], v164 offset:12288
    ds_read_b64_tr_b16 v[138:139], v164 offset:13312
    ds_read_b64_tr_b16 v[140:141], v165 offset:12288
    ds_read_b64_tr_b16 v[142:143], v165 offset:13312
    ds_read_b128 v[152:155], v171 offset:0
    ds_read_b128 v[156:159], v171 offset:4096
    s_waitcnt lgkmcnt(6)
    v_mfma_f32_32x32x16_bf16 v[64:79], v[128:131], v[144:147], v[64:79]
    v_mfma_f32_32x32x16_bf16 v[80:95], v[128:131], v[148:151], v[80:95]
    v_mfma_f32_32x32x16_bf16 v[96:111], v[132:135], v[144:147], v[96:111]
    v_mfma_f32_32x32x16_bf16 v[112:127], v[132:135], v[148:151], v[112:127]
    s_waitcnt lgkmcnt(0)
    v_mfma_f32_32x32x16_bf16 v[64:79], v[136:139], v[152:155], v[64:79]
    v_mfma_f32_32x32x16_bf16 v[80:95], v[136:139], v[156:159], v[80:95]
    v_mfma_f32_32x32x16_bf16 v[96:111], v[140:143], v[152:155], v[96:111]
    v_mfma_f32_32x32x16_bf16 v[112:127], v[140:143], v[156:159], v[112:127]
    s_add_u32 s8, s20, 33554432
    s_addc_u32 s9, s21, 0
    s_mov_b32 s10, 16777216
    s_mov_b32 s11, 0x00020000
    s_add_u32 s12, s20, 50331648
    s_addc_u32 s13, s21, 0
    s_mov_b32 s14, 16777216
    s_mov_b32 s15, 0x00020000
    s_add_u32 s16, s20, 67108864
    s_addc_u32 s17, s21, 0
    s_mov_b32 s18, 16777216
    s_mov_b32 s19, 0x00020000
    s_barrier
    s_lshl_b32 s39, s34, 14
    s_add_u32 s39, s39, s36
    s_lshl_b32 s30, s35, 10
    s_add_u32 s39, s39, s30
    s_mov_b32 s52, s39
    s_add_u32 m0, s42, 0
    s_nop 0
    buffer_load_dwordx4 v12, s[8:11], s39 offen lds
    s_add_u32 m0, s42, 4096
    s_add_u32 s30, s39, 4096
    buffer_load_dwordx4 v12, s[8:11], s30 offen lds
    s_add_u32 m0, s42, 8192
    s_add_u32 s30, s39, 8192
    buffer_load_dwordx4 v12, s[8:11], s30 offen lds
    s_add_u32 m0, s42, 12288
    s_add_u32 s30, s39, 12288
    buffer_load_dwordx4 v12, s[8:11], s30 offen lds
    s_add_u32 s39, s39, 32768
    s_mov_b32 s31, 0x3e0293ee
    v_and_b32 v2, 31, v1
    s_lshl_b32 s30, s35, 5
    v_add_u32 v3, s30, v2
    v_lshlrev_b32 v3, 8, v3
    v_lshrrev_b32 v4, 5, v1
    v_lshl_add_u32 v3, v4, 3, v3
    v_add_u32 v7, 131072, v3
    v_add_u32 v3, 16384, v3
    v_and_b32 v4, 15, v2
    s_lshl_b32 s30, s34, 3
    v_xor_b32 v4, s30, v4
    v_lshlrev_b32 v4, 4, v4
    v_xor_b32 v5, 0, v4
    v_add_u32 v6, v5, v7
    v_add_u32 v5, v5, v3
    v_mul_f32 v64, s31, v64
    v_mul_f32 v65, s31, v65
    v_mul_f32 v66, s31, v66
    v_mul_f32 v67, s31, v67
    v_cvt_pk_bf16_f32 v128, v64, v65
    v_cvt_pk_bf16_f32 v129, v66, v67
    ds_write_b64 v5, v[128:129]
    v_mul_f32 v80, s31, v80
    v_mul_f32 v81, s31, v81
    v_mul_f32 v82, s31, v82
    v_mul_f32 v83, s31, v83
    v_cvt_pk_bf16_f32 v130, v80, v81
    v_cvt_pk_bf16_f32 v131, v82, v83
    ds_write_b64 v6, v[130:131]
    v_xor_b32 v5, 16, v4
    v_add_u32 v6, v5, v7
    v_add_u32 v5, v5, v3
    v_mul_f32 v68, s31, v68
    v_mul_f32 v69, s31, v69
    v_mul_f32 v70, s31, v70
    v_mul_f32 v71, s31, v71
    v_cvt_pk_bf16_f32 v132, v68, v69
    v_cvt_pk_bf16_f32 v133, v70, v71
    ds_write_b64 v5, v[132:133]
    v_mul_f32 v84, s31, v84
    v_mul_f32 v85, s31, v85
    v_mul_f32 v86, s31, v86
    v_mul_f32 v87, s31, v87
    v_cvt_pk_bf16_f32 v134, v84, v85
    v_cvt_pk_bf16_f32 v135, v86, v87
    ds_write_b64 v6, v[134:135]
    v_xor_b32 v5, 32, v4
    v_add_u32 v6, v5, v7
    v_add_u32 v5, v5, v3
    v_mul_f32 v72, s31, v72
    v_mul_f32 v73, s31, v73
    v_mul_f32 v74, s31, v74
    v_mul_f32 v75, s31, v75
    v_cvt_pk_bf16_f32 v136, v72, v73
    v_cvt_pk_bf16_f32 v137, v74, v75
    ds_write_b64 v5, v[136:137]
    v_mul_f32 v88, s31, v88
    v_mul_f32 v89, s31, v89
    v_mul_f32 v90, s31, v90
    v_mul_f32 v91, s31, v91
    v_cvt_pk_bf16_f32 v138, v88, v89
    v_cvt_pk_bf16_f32 v139, v90, v91
    ds_write_b64 v6, v[138:139]
    v_xor_b32 v5, 48, v4
    v_add_u32 v6, v5, v7
    v_add_u32 v5, v5, v3
    v_mul_f32 v76, s31, v76
    v_mul_f32 v77, s31, v77
    v_mul_f32 v78, s31, v78
    v_mul_f32 v79, s31, v79
    v_cvt_pk_bf16_f32 v140, v76, v77
    v_cvt_pk_bf16_f32 v141, v78, v79
    ds_write_b64 v5, v[140:141]
    v_mul_f32 v92, s31, v92
    v_mul_f32 v93, s31, v93
    v_mul_f32 v94, s31, v94
    v_mul_f32 v95, s31, v95
    v_cvt_pk_bf16_f32 v142, v92, v93
    v_cvt_pk_bf16_f32 v143, v94, v95
    ds_write_b64 v6, v[142:143]
    v_xor_b32 v5, 64, v4
    v_add_u32 v6, v5, v7
    v_add_u32 v5, v5, v3
    v_mul_f32 v96, s31, v96
    v_mul_f32 v97, s31, v97
    v_mul_f32 v98, s31, v98
    v_mul_f32 v99, s31, v99
    v_cvt_pk_bf16_f32 v128, v96, v97
    v_cvt_pk_bf16_f32 v129, v98, v99
    ds_write_b64 v5, v[128:129]
    v_mul_f32 v112, s31, v112
    v_mul_f32 v113, s31, v113
    v_mul_f32 v114, s31, v114
    v_mul_f32 v115, s31, v115
    v_cvt_pk_bf16_f32 v130, v112, v113
    v_cvt_pk_bf16_f32 v131, v114, v115
    ds_write_b64 v6, v[130:131]
    v_xor_b32 v5, 80, v4
    v_add_u32 v6, v5, v7
    v_add_u32 v5, v5, v3
    v_mul_f32 v100, s31, v100
    v_mul_f32 v101, s31, v101
    v_mul_f32 v102, s31, v102
    v_mul_f32 v103, s31, v103
    v_cvt_pk_bf16_f32 v132, v100, v101
    v_cvt_pk_bf16_f32 v133, v102, v103
    ds_write_b64 v5, v[132:133]
    v_mul_f32 v116, s31, v116
    v_mul_f32 v117, s31, v117
    v_mul_f32 v118, s31, v118
    v_mul_f32 v119, s31, v119
    v_cvt_pk_bf16_f32 v134, v116, v117
    v_cvt_pk_bf16_f32 v135, v118, v119
    ds_write_b64 v6, v[134:135]
    v_xor_b32 v5, 96, v4
    v_add_u32 v6, v5, v7
    v_add_u32 v5, v5, v3
    v_mul_f32 v104, s31, v104
    v_mul_f32 v105, s31, v105
    v_mul_f32 v106, s31, v106
    v_mul_f32 v107, s31, v107
    v_cvt_pk_bf16_f32 v136, v104, v105
    v_cvt_pk_bf16_f32 v137, v106, v107
    ds_write_b64 v5, v[136:137]
    v_mul_f32 v120, s31, v120
    v_mul_f32 v121, s31, v121
    v_mul_f32 v122, s31, v122
    v_mul_f32 v123, s31, v123
    v_cvt_pk_bf16_f32 v138, v120, v121
    v_cvt_pk_bf16_f32 v139, v122, v123
    ds_write_b64 v6, v[138:139]
    v_xor_b32 v5, 112, v4
    v_add_u32 v6, v5, v7
    v_add_u32 v5, v5, v3
    v_mul_f32 v108, s31, v108
    v_mul_f32 v109, s31, v109
    v_mul_f32 v110, s31, v110
    v_mul_f32 v111, s31, v111
    v_cvt_pk_bf16_f32 v140, v108, v109
    v_cvt_pk_bf16_f32 v141, v110, v111
    ds_write_b64 v5, v[140:141]
    v_mul_f32 v124, s31, v124
    v_mul_f32 v125, s31, v125
    v_mul_f32 v126, s31, v126
    v_mul_f32 v127, s31, v127
    v_cvt_pk_bf16_f32 v142, v124, v125
    v_cvt_pk_bf16_f32 v143, v126, v127
    ds_write_b64 v6, v[142:143]
    s_waitcnt lgkmcnt(0)
    s_barrier
    s_lshl_b32 s30, s34, 16
    s_lshl_b32 s31, s35, 13
    s_sub_u32 s30, s31, s30
    s_add_u32 s30, s30, 16384
    v_add_u32 v9, s30, v14
    ds_read_b128 v[32:35], v9
    v_add_u32 v9, s30, v15
    ds_read_b128 v[36:39], v9
    v_add_u32 v9, s30, v16
    ds_read_b128 v[40:43], v9
    v_add_u32 v9, s30, v17
    ds_read_b128 v[44:47], v9
    v_add_u32 v9, s30, v18
    ds_read_b128 v[48:51], v9
    v_add_u32 v9, s30, v19
    ds_read_b128 v[52:55], v9
    v_add_u32 v9, s30, v20
    ds_read_b128 v[56:59], v9
    v_add_u32 v9, s30, v21
    ds_read_b128 v[60:63], v9
    s_load_dwordx2 s[66:67], s[0:1], 40
    s_load_dwordx4 s[68:71], s[0:1], 56
    s_load_dwordx2 s[72:73], s[0:1], 72
    s_lshl_b32 s30, s2, 3
    s_add_u32 s30, s30, s24
    s_lshl_b32 s74, s30, 11
    s_lshl_b32 s75, s30, 10
    s_waitcnt lgkmcnt(0)
    s_mul_i32 s30, s35, 8704
    s_add_u32 s30, s30, 16384
    s_lshl_b32 s31, s34, 16
    s_add_u32 s53, s30, s31
    s_xor_b32 s63, s53, 65536
    s_waitcnt vmcnt(0) lgkmcnt(0)
L_phase_3:
    v_mov_b32 v240, 0
    v_mov_b32 v241, 0
    v_mov_b32 v242, 0
    v_mov_b32 v243, 0
    v_mov_b32 v244, 0
    v_mov_b32 v245, 0
    v_mov_b32 v246, 0
    v_mov_b32 v247, 0
    v_mov_b32 v248, 0
    v_mov_b32 v249, 0
    v_mov_b32 v250, 0
    v_mov_b32 v251, 0
    v_mov_b32 v252, 0
    v_mov_b32 v253, 0
    v_mov_b32 v254, 0
    v_mov_b32 v255, 0
    v_mov_b32 v26, 0
    v_mov_b32 v27, 0
    s_add_u32 s38, s37, 1
    s_mov_b32 s40, 0
    s_waitcnt vmcnt(4)
    s_barrier
    s_add_u32 s31, s40, 1
    s_cmp_lt_u32 s31, s38
    s_cselect_b32 s64, 1, 0
    ds_read_b128 v[192:195], v14 offset:0
    ds_read_b128 v[196:199], v14 offset:8192
    ds_read_b128 v[200:203], v15 offset:0
    ds_read_b128 v[204:207], v15 offset:8192
    ds_read_b128 v[208:211], v16 offset:0
    ds_read_b128 v[212:215], v16 offset:8192
    s_waitcnt lgkmcnt(5)
    v_mfma_f32_32x32x16_bf16 v[128:143], v[192:195], v[32:35], v[240:255]
    ds_read_b128 v[192:195], v17 offset:0
    s_cmp_eq_u32 s64, 0
    s_cbranch_scc1 L_nop_4
    s_add_u32 m0, s42, 32768
    s_add_u32 s30, s39, 0
    buffer_load_dwordx4 v12, s[8:11], s30 offen lds
L_nop_4:
    s_waitcnt lgkmcnt(5)
    v_mfma_f32_32x32x16_bf16 v[144:159], v[196:199], v[32:35], v[240:255]
    ds_read_b128 v[196:199], v17 offset:8192
    s_waitcnt lgkmcnt(5)
    v_mfma_f32_32x32x16_bf16 v[128:143], v[200:203], v[36:39], v[128:143]
    ds_read_b128 v[200:203], v18 offset:0
    s_cmp_eq_u32 s64, 0
    s_cbranch_scc1 L_nop_5
    s_add_u32 m0, s42, 36864
    s_add_u32 s30, s39, 4096
    buffer_load_dwordx4 v12, s[8:11], s30 offen lds
L_nop_5:
    s_waitcnt lgkmcnt(5)
    v_mfma_f32_32x32x16_bf16 v[144:159], v[204:207], v[36:39], v[144:159]
    ds_read_b128 v[204:207], v18 offset:8192
    s_waitcnt lgkmcnt(5)
    v_mfma_f32_32x32x16_bf16 v[128:143], v[208:211], v[40:43], v[128:143]
    ds_read_b128 v[208:211], v19 offset:0
    s_cmp_eq_u32 s64, 0
    s_cbranch_scc1 L_nop_6
    s_add_u32 m0, s42, 40960
    s_add_u32 s30, s39, 8192
    buffer_load_dwordx4 v12, s[8:11], s30 offen lds
L_nop_6:
    s_waitcnt lgkmcnt(5)
    v_mfma_f32_32x32x16_bf16 v[144:159], v[212:215], v[40:43], v[144:159]
    ds_read_b128 v[212:215], v19 offset:8192
    s_waitcnt lgkmcnt(5)
    v_mfma_f32_32x32x16_bf16 v[128:143], v[192:195], v[44:47], v[128:143]
    ds_read_b128 v[192:195], v20 offset:0
    s_cmp_eq_u32 s64, 0
    s_cbranch_scc1 L_nop_7
    s_add_u32 m0, s42, 45056
    s_add_u32 s30, s39, 12288
    buffer_load_dwordx4 v12, s[8:11], s30 offen lds
    s_add_u32 s39, s39, 32768
L_nop_7:
    s_waitcnt lgkmcnt(5)
    v_mfma_f32_32x32x16_bf16 v[144:159], v[196:199], v[44:47], v[144:159]
    ds_read_b128 v[196:199], v20 offset:8192
    s_waitcnt lgkmcnt(5)
    v_mfma_f32_32x32x16_bf16 v[128:143], v[200:203], v[48:51], v[128:143]
    ds_read_b128 v[200:203], v21 offset:0
    s_add_u32 m0, s42, 16384
    s_add_u32 s30, s52, 0
    buffer_load_dwordx4 v13, s[12:15], s30 offen lds
    s_waitcnt lgkmcnt(5)
    v_mfma_f32_32x32x16_bf16 v[144:159], v[204:207], v[48:51], v[144:159]
    ds_read_b128 v[204:207], v21 offset:8192
    s_waitcnt lgkmcnt(5)
    v_mfma_f32_32x32x16_bf16 v[128:143], v[208:211], v[52:55], v[128:143]
    s_add_u32 m0, s42, 20480
    s_add_u32 s30, s52, 4096
    buffer_load_dwordx4 v13, s[12:15], s30 offen lds
    s_waitcnt lgkmcnt(4)
    v_mfma_f32_32x32x16_bf16 v[144:159], v[212:215], v[52:55], v[144:159]
    s_waitcnt lgkmcnt(3)
    v_mfma_f32_32x32x16_bf16 v[128:143], v[192:195], v[56:59], v[128:143]
    s_add_u32 m0, s42, 24576
    s_add_u32 s30, s52, 8192
    buffer_load_dwordx4 v13, s[12:15], s30 offen lds
    s_waitcnt lgkmcnt(2)
    v_mfma_f32_32x32x16_bf16 v[144:159], v[196:199], v[56:59], v[144:159]
    s_waitcnt lgkmcnt(1)
    v_mfma_f32_32x32x16_bf16 v[128:143], v[200:203], v[60:63], v[128:143]
    s_add_u32 m0, s42, 28672
    s_add_u32 s30, s52, 12288
    buffer_load_dwordx4 v13, s[12:15], s30 offen lds
    s_add_u32 s52, s52, 32768
    s_waitcnt lgkmcnt(0)
    v_mfma_f32_32x32x16_bf16 v[144:159], v[204:207], v[60:63], v[144:159]
    s_cmp_lg_u32 s64, 0
    s_cbranch_scc1 L_nomask_8
    s_nop 7
    s_nop 3
    v_cmp_le_i32 s[44:45], 0, v29
    v_cmp_le_i32 s[46:47], 1, v29
    v_cmp_le_i32 s[48:49], 2, v29
    v_cmp_le_i32 s[50:51], 3, v29
    s_nop 1
    v_cndmask_b32 v128, v31, v128, s[44:45]
    v_cndmask_b32 v129, v31, v129, s[46:47]
    v_cndmask_b32 v130, v31, v130, s[48:49]
    v_cndmask_b32 v131, v31, v131, s[50:51]
    v_cmp_le_i32 s[44:45], 8, v29
    v_cmp_le_i32 s[46:47], 9, v29
    v_cmp_le_i32 s[48:49], 10, v29
    v_cmp_le_i32 s[50:51], 11, v29
    s_nop 1
    v_cndmask_b32 v132, v31, v132, s[44:45]
    v_cndmask_b32 v133, v31, v133, s[46:47]
    v_cndmask_b32 v134, v31, v134, s[48:49]
    v_cndmask_b32 v135, v31, v135, s[50:51]
    v_cmp_le_i32 s[44:45], 16, v29
    v_cmp_le_i32 s[46:47], 17, v29
    v_cmp_le_i32 s[48:49], 18, v29
    v_cmp_le_i32 s[50:51], 19, v29
    s_nop 1
    v_cndmask_b32 v136, v31, v136, s[44:45]
    v_cndmask_b32 v137, v31, v137, s[46:47]
    v_cndmask_b32 v138, v31, v138, s[48:49]
    v_cndmask_b32 v139, v31, v139, s[50:51]
    v_cmp_le_i32 s[44:45], 24, v29
    v_cmp_le_i32 s[46:47], 25, v29
    v_cmp_le_i32 s[48:49], 26, v29
    v_cmp_le_i32 s[50:51], 27, v29
    s_nop 1
    v_cndmask_b32 v140, v31, v140, s[44:45]
    v_cndmask_b32 v141, v31, v141, s[46:47]
    v_cndmask_b32 v142, v31, v142, s[48:49]
    v_cndmask_b32 v143, v31, v143, s[50:51]
    v_cmp_le_i32 s[44:45], 32, v29
    v_cmp_le_i32 s[46:47], 33, v29
    v_cmp_le_i32 s[48:49], 34, v29
    v_cmp_le_i32 s[50:51], 35, v29
    s_nop 1
    v_cndmask_b32 v144, v31, v144, s[44:45]
    v_cndmask_b32 v145, v31, v145, s[46:47]
    v_cndmask_b32 v146, v31, v146, s[48:49]
    v_cndmask_b32 v147, v31, v147, s[50:51]
    v_cmp_le_i32 s[44:45], 40, v29
    v_cmp_le_i32 s[46:47], 41, v29
    v_cmp_le_i32 s[48:49], 42, v29
    v_cmp_le_i32 s[50:51], 43, v29
    s_nop 1
    v_cndmask_b32 v148, v31, v148, s[44:45]
    v_cndmask_b32 v149, v31, v149, s[46:47]
    v_cndmask_b32 v150, v31, v150, s[48:49]
    v_cndmask_b32 v151, v31, v151, s[50:51]
    v_cmp_le_i32 s[44:45], 48, v29
    v_cmp_le_i32 s[46:47], 49, v29
    v_cmp_le_i32 s[48:49], 50, v29
    v_cmp_le_i32 s[50:51], 51, v29
    s_nop 1
    v_cndmask_b32 v152, v31, v152, s[44:45]
    v_cndmask_b32 v153, v31, v153, s[46:47]
    v_cndmask_b32 v154, v31, v154, s[48:49]
    v_cndmask_b32 v155, v31, v155, s[50:51]
    v_cmp_le_i32 s[44:45], 56, v29
    v_cmp_le_i32 s[46:47], 57, v29
    v_cmp_le_i32 s[48:49], 58, v29
    v_cmp_le_i32 s[50:51], 59, v29
    s_nop 1
    v_cndmask_b32 v156, v31, v156, s[44:45]
    v_cndmask_b32 v157, v31, v157, s[46:47]
    v_cndmask_b32 v158, v31, v158, s[48:49]
    v_cndmask_b32 v159, v31, v159, s[50:51]
L_nomask_8:
    s_nop 7
    s_nop 3
    v_max3_f32 v2, v128, v129, v130
    v_max3_f32 v3, v131, v132, v133
    v_max3_f32 v2, v2, v134, v135
    v_max3_f32 v3, v3, v136, v137
    v_max3_f32 v2, v2, v138, v139
    v_max3_f32 v3, v3, v140, v141
    v_max3_f32 v2, v2, v142, v143
    v_max3_f32 v3, v3, v144, v145
    v_max3_f32 v2, v2, v146, v147
    v_max3_f32 v3, v3, v148, v149
    v_max3_f32 v2, v2, v150, v151
    v_max3_f32 v3, v3, v152, v153
    v_max3_f32 v2, v2, v154, v155
    v_max3_f32 v3, v3, v156, v157
    v_max3_f32 v2, v2, v158, v159
    v_max_f32 v2, v2, v3
    s_waitcnt vmcnt(0) lgkmcnt(0)
    s_barrier
    ds_read_b128 v[192:195], v14 offset:32768
    ds_read_b128 v[196:199], v14 offset:40960
    ds_read_b128 v[200:203], v15 offset:32768
    ds_read_b128 v[204:207], v15 offset:40960
    ds_read_b128 v[208:211], v16 offset:32768
    ds_read_b128 v[212:215], v16 offset:40960
    s_add_u32 s40, s40, 1
    s_add_u32 s31, s40, 1
    s_cmp_lt_u32 s31, s38
    s_cselect_b32 s64, 1, 0
    v_mov_b32 v3, v2
    s_nop 1
    v_permlane32_swap_b32 v2, v3
    v_max_f32 v2, v2, v3
    v_max_f32 v2, 0xe0ad78ec, v2
    v_exp_f32 v28, -v2
    v_add_f32 v26, v26, v2
    v_sub_f32 v128, v128, v2
    v_sub_f32 v129, v129, v2
    v_sub_f32 v130, v130, v2
    v_sub_f32 v131, v131, v2
    v_sub_f32 v132, v132, v2
    v_sub_f32 v133, v133, v2
    v_sub_f32 v134, v134, v2
    v_sub_f32 v135, v135, v2
    v_sub_f32 v136, v136, v2
    v_sub_f32 v137, v137, v2
    v_sub_f32 v138, v138, v2
    v_sub_f32 v139, v139, v2
    v_sub_f32 v140, v140, v2
    v_sub_f32 v141, v141, v2
    v_sub_f32 v142, v142, v2
    v_sub_f32 v143, v143, v2
    v_sub_f32 v144, v144, v2
    v_sub_f32 v145, v145, v2
    v_sub_f32 v146, v146, v2
    v_sub_f32 v147, v147, v2
    v_sub_f32 v148, v148, v2
    v_sub_f32 v149, v149, v2
    v_sub_f32 v150, v150, v2
    v_sub_f32 v151, v151, v2
    v_sub_f32 v152, v152, v2
    v_sub_f32 v153, v153, v2
    v_sub_f32 v154, v154, v2
    v_sub_f32 v155, v155, v2
    v_sub_f32 v156, v156, v2
    v_sub_f32 v157, v157, v2
    v_sub_f32 v158, v158, v2
    v_sub_f32 v159, v159, v2
    v_sub_f32 v240, 0, v26
    v_sub_f32 v241, 0, v26
    v_sub_f32 v242, 0, v26
    v_sub_f32 v243, 0, v26
    v_sub_f32 v244, 0, v26
    v_sub_f32 v245, 0, v26
    v_sub_f32 v246, 0, v26
    v_sub_f32 v247, 0, v26
    v_sub_f32 v248, 0, v26
    v_sub_f32 v249, 0, v26
    v_sub_f32 v250, 0, v26
    v_sub_f32 v251, 0, v26
    v_sub_f32 v252, 0, v26
    v_sub_f32 v253, 0, v26
    v_sub_f32 v254, 0, v26
    v_sub_f32 v255, 0, v26
    s_cmp_ge_u32 s40, s38
    s_cbranch_scc1 L_tail1f_12
    s_waitcnt lgkmcnt(5)
    v_mfma_f32_32x32x16_bf16 v[160:175], v[192:195], v[32:35], v[240:255]
    ds_read_b128 v[192:195], v17 offset:32768
    s_cmp_eq_u32 s64, 0
    s_cbranch_scc1 L_nop_15
    s_add_u32 m0, s42, 0
    s_add_u32 s30, s39, 0
    buffer_load_dwordx4 v12, s[8:11], s30 offen lds
L_nop_15:
    v_exp_f32 v128, v128
    v_exp_f32 v129, v129
    v_exp_f32 v130, v130
    v_exp_f32 v131, v131
    s_waitcnt lgkmcnt(5)
    v_mfma_f32_32x32x16_bf16 v[176:191], v[196:199], v[32:35], v[240:255]
    ds_read_b128 v[196:199], v17 offset:40960
    v_exp_f32 v132, v132
    v_exp_f32 v133, v133
    v_exp_f32 v134, v134
    v_exp_f32 v135, v135
    s_waitcnt lgkmcnt(5)
    v_mfma_f32_32x32x16_bf16 v[160:175], v[200:203], v[36:39], v[160:175]
    ds_read_b128 v[200:203], v18 offset:32768
    s_cmp_eq_u32 s64, 0
    s_cbranch_scc1 L_nop_16
    s_add_u32 m0, s42, 4096
    s_add_u32 s30, s39, 4096
    buffer_load_dwordx4 v12, s[8:11], s30 offen lds
L_nop_16:
    v_add_f32 v10, v128, v129
    v_add_f32 v11, v130, v131
    v_cvt_pk_bf16_f32 v128, v128, v129
    v_cvt_pk_bf16_f32 v129, v130, v131
    s_waitcnt lgkmcnt(5)
    v_mfma_f32_32x32x16_bf16 v[176:191], v[204:207], v[36:39], v[176:191]
    ds_read_b128 v[204:207], v18 offset:40960
    v_exp_f32 v136, v136
    v_exp_f32 v137, v137
    v_exp_f32 v138, v138
    v_exp_f32 v139, v139
    s_waitcnt lgkmcnt(5)
    v_mfma_f32_32x32x16_bf16 v[160:175], v[208:211], v[40:43], v[160:175]
    ds_read_b128 v[208:211], v19 offset:32768
    s_cmp_eq_u32 s64, 0
    s_cbranch_scc1 L_nop_17
    s_add_u32 m0, s42, 8192
    s_add_u32 s30, s39, 8192
    buffer_load_dwordx4 v12, s[8:11], s30 offen lds
L_nop_17:
    v_add_f32 v10, v10, v132
    v_add_f32 v11, v11, v133
    v_add_f32 v10, v10, v134
    v_add_f32 v11, v11, v135
    s_waitcnt lgkmcnt(5)
    v_mfma_f32_32x32x16_bf16 v[176:191], v[212:215], v[40:43], v[176:191]
    ds_read_b128 v[212:215], v19 offset:40960
    v_cvt_pk_bf16_f32 v130, v132, v133
    v_cvt_pk_bf16_f32 v131, v134, v135
    v_exp_f32 v140, v140
    v_exp_f32 v141, v141
    s_waitcnt lgkmcnt(5)
    v_mfma_f32_32x32x16_bf16 v[160:175], v[192:195], v[44:47], v[160:175]
    ds_read_b128 v[192:195], v20 offset:32768
    s_cmp_eq_u32 s64, 0
    s_cbranch_scc1 L_nop_18
    s_add_u32 m0, s42, 12288
    s_add_u32 s30, s39, 12288
    buffer_load_dwordx4 v12, s[8:11], s30 offen lds
    s_add_u32 s39, s39, 32768
L_nop_18:
    v_exp_f32 v142, v142
    v_exp_f32 v143, v143
    v_add_f32 v10, v10, v136
    v_add_f32 v11, v11, v137
    s_waitcnt lgkmcnt(5)
    v_mfma_f32_32x32x16_bf16 v[176:191], v[196:199], v[44:47], v[176:191]
    ds_read_b128 v[196:199], v20 offset:40960
    v_add_f32 v10, v10, v138
    v_add_f32 v11, v11, v139
    v_cvt_pk_bf16_f32 v132, v136, v137
    v_cvt_pk_bf16_f32 v133, v138, v139
    s_waitcnt lgkmcnt(5)
    v_mfma_f32_32x32x16_bf16 v[160:175], v[200:203], v[48:51], v[160:175]
    ds_read_b128 v[200:203], v21 offset:32768
    s_add_u32 m0, s42, 49152
    s_add_u32 s30, s52, 0
    buffer_load_dwordx4 v13, s[12:15], s30 offen lds
    v_exp_f32 v144, v144
    v_exp_f32 v145, v145
    v_exp_f32 v146, v146
    v_exp_f32 v147, v147
    s_waitcnt lgkmcnt(5)
    v_mfma_f32_32x32x16_bf16 v[176:191], v[204:207], v[48:51], v[176:191]
    ds_read_b128 v[204:207], v21 offset:40960
    v_add_f32 v10, v10, v140
    v_add_f32 v11, v11, v141
    v_add_f32 v10, v10, v142
    v_add_f32 v11, v11, v143
    s_waitcnt lgkmcnt(5)
    v_mfma_f32_32x32x16_bf16 v[160:175], v[208:211], v[52:55], v[160:175]
    ds_read_b64_tr_b16 v[216:217], v22 offset:0
    ds_read_b64_tr_b16 v[218:219], v22 offset:2048
    s_add_u32 m0, s42, 53248
    s_add_u32 s30, s52, 4096
    buffer_load_dwordx4 v13, s[12:15], s30 offen lds
    v_cvt_pk_bf16_f32 v134, v140, v141
    v_cvt_pk_bf16_f32 v135, v142, v143
    v_exp_f32 v148, v148
    v_exp_f32 v149, v149
    s_waitcnt lgkmcnt(6)
    v_mfma_f32_32x32x16_bf16 v[176:191], v[212:215], v[52:55], v[176:191]
    ds_read_b64_tr_b16 v[220:221], v23 offset:0
    ds_read_b64_tr_b16 v[222:223], v23 offset:2048
    v_exp_f32 v150, v150
    v_exp_f32 v151, v151
    v_add_f32 v10, v10, v144
    v_add_f32 v11, v11, v145
    s_waitcnt lgkmcnt(7)
    v_mfma_f32_32x32x16_bf16 v[160:175], v[192:195], v[56:59], v[160:175]
    ds_read_b64_tr_b16 v[224:225], v24 offset:0
    ds_read_b64_tr_b16 v[226:227], v24 offset:2048
    s_add_u32 m0, s42, 57344
    s_add_u32 s30, s52, 8192
    buffer_load_dwordx4 v13, s[12:15], s30 offen lds
    v_add_f32 v10, v10, v146
    v_add_f32 v11, v11, v147
    v_cvt_pk_bf16_f32 v136, v144, v145
    v_cvt_pk_bf16_f32 v137, v146, v147
    s_waitcnt lgkmcnt(8)
    v_mfma_f32_32x32x16_bf16 v[176:191], v[196:199], v[56:59], v[176:191]
    ds_read_b64_tr_b16 v[228:229], v25 offset:0
    ds_read_b64_tr_b16 v[230:231], v25 offset:2048
    s_nop 0
    v_add_f32 v10, v10, v148
    v_add_f32 v11, v11, v149
    v_add_f32 v10, v10, v150
    s_waitcnt lgkmcnt(9)
    v_mfma_f32_32x32x16_bf16 v[160:175], v[200:203], v[60:63], v[160:175]
    ds_read_b64_tr_b16 v[232:233], v22 offset:4096
    ds_read_b64_tr_b16 v[234:235], v22 offset:6144
    s_add_u32 m0, s42, 61440
    s_add_u32 s30, s52, 12288
    buffer_load_dwordx4 v13, s[12:15], s30 offen lds
    s_add_u32 s52, s52, 32768
    v_add_f32 v11, v11, v151
    v_cvt_pk_bf16_f32 v138, v148, v149
    v_cvt_pk_bf16_f32 v139, v150, v151
    s_waitcnt lgkmcnt(10)
    v_mfma_f32_32x32x16_bf16 v[176:191], v[204:207], v[60:63], v[176:191]
    ds_read_b64_tr_b16 v[236:237], v23 offset:4096
    ds_read_b64_tr_b16 v[238:239], v23 offset:6144
    s_cmp_lg_u32 s64, 0
    s_cbranch_scc1 L_nomask_19
    s_nop 7
    s_nop 3
    v_cmp_le_i32 s[44:45], 0, v29
    v_cmp_le_i32 s[46:47], 1, v29
    v_cmp_le_i32 s[48:49], 2, v29
    v_cmp_le_i32 s[50:51], 3, v29
    s_nop 1
    v_cndmask_b32 v160, v31, v160, s[44:45]
    v_cndmask_b32 v161, v31, v161, s[46:47]
    v_cndmask_b32 v162, v31, v162, s[48:49]
    v_cndmask_b32 v163, v31, v163, s[50:51]
    v_cmp_le_i32 s[44:45], 8, v29
    v_cmp_le_i32 s[46:47], 9, v29
    v_cmp_le_i32 s[48:49], 10, v29
    v_cmp_le_i32 s[50:51], 11, v29
    s_nop 1
    v_cndmask_b32 v164, v31, v164, s[44:45]
    v_cndmask_b32 v165, v31, v165, s[46:47]
    v_cndmask_b32 v166, v31, v166, s[48:49]
    v_cndmask_b32 v167, v31, v167, s[50:51]
    v_cmp_le_i32 s[44:45], 16, v29
    v_cmp_le_i32 s[46:47], 17, v29
    v_cmp_le_i32 s[48:49], 18, v29
    v_cmp_le_i32 s[50:51], 19, v29
    s_nop 1
    v_cndmask_b32 v168, v31, v168, s[44:45]
    v_cndmask_b32 v169, v31, v169, s[46:47]
    v_cndmask_b32 v170, v31, v170, s[48:49]
    v_cndmask_b32 v171, v31, v171, s[50:51]
    v_cmp_le_i32 s[44:45], 24, v29
    v_cmp_le_i32 s[46:47], 25, v29
    v_cmp_le_i32 s[48:49], 26, v29
    v_cmp_le_i32 s[50:51], 27, v29
    s_nop 1
    v_cndmask_b32 v172, v31, v172, s[44:45]
    v_cndmask_b32 v173, v31, v173, s[46:47]
    v_cndmask_b32 v174, v31, v174, s[48:49]
    v_cndmask_b32 v175, v31, v175, s[50:51]
    v_cmp_le_i32 s[44:45], 32, v29
    v_cmp_le_i32 s[46:47], 33, v29
    v_cmp_le_i32 s[48:49], 34, v29
    v_cmp_le_i32 s[50:51], 35, v29
    s_nop 1
    v_cndmask_b32 v176, v31, v176, s[44:45]
    v_cndmask_b32 v177, v31, v177, s[46:47]
    v_cndmask_b32 v178, v31, v178, s[48:49]
    v_cndmask_b32 v179, v31, v179, s[50:51]
    v_cmp_le_i32 s[44:45], 40, v29
    v_cmp_le_i32 s[46:47], 41, v29
    v_cmp_le_i32 s[48:49], 42, v29
    v_cmp_le_i32 s[50:51], 43, v29
    s_nop 1
    v_cndmask_b32 v180, v31, v180, s[44:45]
    v_cndmask_b32 v181, v31, v181, s[46:47]
    v_cndmask_b32 v182, v31, v182, s[48:49]
    v_cndmask_b32 v183, v31, v183, s[50:51]
    v_cmp_le_i32 s[44:45], 48, v29
    v_cmp_le_i32 s[46:47], 49, v29
    v_cmp_le_i32 s[48:49], 50, v29
    v_cmp_le_i32 s[50:51], 51, v29
    s_nop 1
    v_cndmask_b32 v184, v31, v184, s[44:45]
    v_cndmask_b32 v185, v31, v185, s[46:47]
    v_cndmask_b32 v186, v31, v186, s[48:49]
    v_cndmask_b32 v187, v31, v187, s[50:51]
    v_cmp_le_i32 s[44:45], 56, v29
    v_cmp_le_i32 s[46:47], 57, v29
    v_cmp_le_i32 s[48:49], 58, v29
    v_cmp_le_i32 s[50:51], 59, v29
    s_nop 1
    v_cndmask_b32 v188, v31, v188, s[44:45]
    v_cndmask_b32 v189, v31, v189, s[46:47]
    v_cndmask_b32 v190, v31, v190, s[48:49]
    v_cndmask_b32 v191, v31, v191, s[50:51]
L_nomask_19:
    s_nop 1
    s_waitcnt lgkmcnt(10)
    v_mfma_f32_32x32x16_bf16 v[64:79], v[216:219], v[128:131], 0
    ds_read_b64_tr_b16 v[216:217], v24 offset:4096
    ds_read_b64_tr_b16 v[218:219], v24 offset:6144
    v_exp_f32 v152, v152
    v_exp_f32 v153, v153
    v_exp_f32 v154, v154
    s_waitcnt lgkmcnt(10)
    v_mfma_f32_32x32x16_bf16 v[80:95], v[220:223], v[128:131], 0
    ds_read_b64_tr_b16 v[220:221], v25 offset:4096
    ds_read_b64_tr_b16 v[222:223], v25 offset:6144
    v_exp_f32 v155, v155
    v_exp_f32 v156, v156
    v_exp_f32 v157, v157
    s_waitcnt lgkmcnt(10)
    v_mfma_f32_32x32x16_bf16 v[96:111], v[224:227], v[128:131], 0
    ds_read_b64_tr_b16 v[224:225], v22 offset:8192
    ds_read_b64_tr_b16 v[226:227], v22 offset:10240
    v_exp_f32 v158, v158
    v_exp_f32 v159, v159
    v_add_f32 v10, v10, v152
    s_waitcnt lgkmcnt(10)
    v_mfma_f32_32x32x16_bf16 v[112:127], v[228:231], v[128:131], 0
    ds_read_b64_tr_b16 v[228:229], v23 offset:8192
    ds_read_b64_tr_b16 v[230:231], v23 offset:10240
    v_add_f32 v11, v11, v153
    v_add_f32 v10, v10, v154
    v_add_f32 v11, v11, v155
    s_waitcnt lgkmcnt(10)
    v_mfma_f32_32x32x16_bf16 v[64:79], v[232:235], v[132:135], v[64:79]
    ds_read_b64_tr_b16 v[232:233], v24 offset:8192
    ds_read_b64_tr_b16 v[234:235], v24 offset:10240
    v_cvt_pk_bf16_f32 v140, v152, v153
    v_cvt_pk_bf16_f32 v141, v154, v155
    s_nop 0
    s_waitcnt lgkmcnt(10)
    v_mfma_f32_32x32x16_bf16 v[80:95], v[236:239], v[132:135], v[80:95]
    ds_read_b64_tr_b16 v[236:237], v25 offset:8192
    ds_read_b64_tr_b16 v[238:239], v25 offset:10240
    v_add_f32 v10, v10, v156
    v_add_f32 v11, v11, v157
    v_add_f32 v10, v10, v158
    v_max3_f32 v2, v160, v161, v162
    v_max3_f32 v3, v163, v164, v165
    s_waitcnt lgkmcnt(10)
    v_mfma_f32_32x32x16_bf16 v[96:111], v[216:219], v[132:135], v[96:111]
    ds_read_b64_tr_b16 v[216:217], v22 offset:12288
    ds_read_b64_tr_b16 v[218:219], v22 offset:14336
    v_add_f32 v11, v11, v159
    v_cvt_pk_bf16_f32 v142, v156, v157
    v_cvt_pk_bf16_f32 v143, v158, v159
    v_max3_f32 v2, v2, v166, v167
    v_max3_f32 v3, v3, v168, v169
    s_waitcnt lgkmcnt(10)
    v_mfma_f32_32x32x16_bf16 v[112:127], v[220:223], v[132:135], v[112:127]
    ds_read_b64_tr_b16 v[220:221], v23 offset:12288
    ds_read_b64_tr_b16 v[222:223], v23 offset:14336
    v_add_f32 v27, v27, v10
    v_add_f32 v27, v27, v11
    v_max3_f32 v2, v2, v170, v171
    v_max3_f32 v3, v3, v172, v173
    s_waitcnt lgkmcnt(10)
    v_mfma_f32_32x32x16_bf16 v[64:79], v[224:227], v[136:139], v[64:79]
    ds_read_b64_tr_b16 v[224:225], v24 offset:12288
    ds_read_b64_tr_b16 v[226:227], v24 offset:14336
    v_max3_f32 v2, v2, v174, v175
    v_max3_f32 v3, v3, v176, v177
    s_waitcnt lgkmcnt(10)
    v_mfma_f32_32x32x16_bf16 v[80:95], v[228:231], v[136:139], v[80:95]
    ds_read_b64_tr_b16 v[228:229], v25 offset:12288
    ds_read_b64_tr_b16 v[230:231], v25 offset:14336
    v_max3_f32 v2, v2, v178, v179
    v_max3_f32 v3, v3, v180, v181
    s_waitcnt lgkmcnt(10)
    v_mfma_f32_32x32x16_bf16 v[96:111], v[232:235], v[136:139], v[96:111]
    v_max3_f32 v2, v2, v182, v183
    v_max3_f32 v3, v3, v184, v185
    s_waitcnt lgkmcnt(8)
    v_mfma_f32_32x32x16_bf16 v[112:127], v[236:239], v[136:139], v[112:127]
    v_max3_f32 v2, v2, v186, v187
    v_max3_f32 v3, v3, v188, v189
    s_nop 1
    s_waitcnt vmcnt(0) lgkmcnt(0)
    s_barrier
    ds_read_b128 v[192:195], v14 offset:0
    ds_read_b128 v[196:199], v14 offset:8192
    ds_read_b128 v[200:203], v15 offset:0
    ds_read_b128 v[204:207], v15 offset:8192
    ds_read_b128 v[208:211], v16 offset:0
    ds_read_b128 v[212:215], v16 offset:8192
    s_add_u32 s40, s40, 1
    s_add_u32 s31, s40, 1
    s_cmp_lt_u32 s31, s38
    s_cselect_b32 s64, 1, 0
    v_mfma_f32_32x32x16_bf16 v[64:79], v[216:219], v[140:143], v[64:79]
    v_max3_f32 v2, v2, v190, v191
    v_max_f32 v2, v2, v3
    v_mfma_f32_32x32x16_bf16 v[80:95], v[220:223], v[140:143], v[80:95]
    v_mfma_f32_32x32x16_bf16 v[96:111], v[224:227], v[140:143], v[96:111]
    v_cmp_lt_f32 vcc, s41, v2
    v_mfma_f32_32x32x16_bf16 v[112:127], v[228:231], v[140:143], v[112:127]
    s_cbranch_vccz L_norescale_20
    s_nop 7
    s_nop 3
    v_mov_b32 v3, v2
    s_nop 1
    v_permlane32_swap_b32 v2, v3
    v_max_f32 v2, v2, v3
    v_max_f32 v2, 0, v2
    v_exp_f32 v28, -v2
    v_add_f32 v26, v26, v2
    v_sub_f32 v160, v160, v2
    v_sub_f32 v161, v161, v2
    v_sub_f32 v162, v162, v2
    v_sub_f32 v163, v163, v2
    v_sub_f32 v164, v164, v2
    v_sub_f32 v165, v165, v2
    v_sub_f32 v166, v166, v2
    v_sub_f32 v167, v167, v2
    v_sub_f32 v168, v168, v2
    v_sub_f32 v169, v169, v2
    v_sub_f32 v170, v170, v2
    v_sub_f32 v171, v171, v2
    v_sub_f32 v172, v172, v2
    v_sub_f32 v173, v173, v2
    v_sub_f32 v174, v174, v2
    v_sub_f32 v175, v175, v2
    v_sub_f32 v176, v176, v2
    v_sub_f32 v177, v177, v2
    v_sub_f32 v178, v178, v2
    v_sub_f32 v179, v179, v2
    v_sub_f32 v180, v180, v2
    v_sub_f32 v181, v181, v2
    v_sub_f32 v182, v182, v2
    v_sub_f32 v183, v183, v2
    v_sub_f32 v184, v184, v2
    v_sub_f32 v185, v185, v2
    v_sub_f32 v186, v186, v2
    v_sub_f32 v187, v187, v2
    v_sub_f32 v188, v188, v2
    v_sub_f32 v189, v189, v2
    v_sub_f32 v190, v190, v2
    v_sub_f32 v191, v191, v2
    v_sub_f32 v240, 0, v26
    v_sub_f32 v241, 0, v26
    v_sub_f32 v242, 0, v26
    v_sub_f32 v243, 0, v26
    v_sub_f32 v244, 0, v26
    v_sub_f32 v245, 0, v26
    v_sub_f32 v246, 0, v26
    v_sub_f32 v247, 0, v26
    v_sub_f32 v248, 0, v26
    v_sub_f32 v249, 0, v26
    v_sub_f32 v250, 0, v26
    v_sub_f32 v251, 0, v26
    v_sub_f32 v252, 0, v26
    v_sub_f32 v253, 0, v26
    v_sub_f32 v254, 0, v26
    v_sub_f32 v255, 0, v26
    v_mul_f32 v27, v27, v28
    v_mul_f32 v64, v64, v28
    v_mul_f32 v65, v65, v28
    v_mul_f32 v66, v66, v28
    v_mul_f32 v67, v67, v28
    v_mul_f32 v68, v68, v28
    v_mul_f32 v69, v69, v28
    v_mul_f32 v70, v70, v28
    v_mul_f32 v71, v71, v28
    v_mul_f32 v72, v72, v28
    v_mul_f32 v73, v73, v28
    v_mul_f32 v74, v74, v28
    v_mul_f32 v75, v75, v28
    v_mul_f32 v76, v76, v28
    v_mul_f32 v77, v77, v28
    v_mul_f32 v78, v78, v28
    v_mul_f32 v79, v79, v28
    v_mul_f32 v80, v80, v28
    v_mul_f32 v81, v81, v28
    v_mul_f32 v82, v82, v28
    v_mul_f32 v83, v83, v28
    v_mul_f32 v84, v84, v28
    v_mul_f32 v85, v85, v28
    v_mul_f32 v86, v86, v28
    v_mul_f32 v87, v87, v28
    v_mul_f32 v88, v88, v28
    v_mul_f32 v89, v89, v28
    v_mul_f32 v90, v90, v28
    v_mul_f32 v91, v91, v28
    v_mul_f32 v92, v92, v28
    v_mul_f32 v93, v93, v28
    v_mul_f32 v94, v94, v28
    v_mul_f32 v95, v95, v28
    v_mul_f32 v96, v96, v28
    v_mul_f32 v97, v97, v28
    v_mul_f32 v98, v98, v28
    v_mul_f32 v99, v99, v28
    v_mul_f32 v100, v100, v28
    v_mul_f32 v101, v101, v28
    v_mul_f32 v102, v102, v28
    v_mul_f32 v103, v103, v28
    v_mul_f32 v104, v104, v28
    v_mul_f32 v105, v105, v28
    v_mul_f32 v106, v106, v28
    v_mul_f32 v107, v107, v28
    v_mul_f32 v108, v108, v28
    v_mul_f32 v109, v109, v28
    v_mul_f32 v110, v110, v28
    v_mul_f32 v111, v111, v28
    v_mul_f32 v112, v112, v28
    v_mul_f32 v113, v113, v28
    v_mul_f32 v114, v114, v28
    v_mul_f32 v115, v115, v28
    v_mul_f32 v116, v116, v28
    v_mul_f32 v117, v117, v28
    v_mul_f32 v118, v118, v28
    v_mul_f32 v119, v119, v28
    v_mul_f32 v120, v120, v28
    v_mul_f32 v121, v121, v28
    v_mul_f32 v122, v122, v28
    v_mul_f32 v123, v123, v28
    v_mul_f32 v124, v124, v28
    v_mul_f32 v125, v125, v28
    v_mul_f32 v126, v126, v28
    v_mul_f32 v127, v127, v28
L_norescale_20:
    s_branch L_amid_13
L_aloop_9:
    s_cmp_ge_u32 s40, s38
    s_cbranch_scc1 L_tail1_11
    s_waitcnt lgkmcnt(5)
    v_mfma_f32_32x32x16_bf16 v[160:175], v[192:195], v[32:35], v[240:255]
    ds_read_b128 v[192:195], v17 offset:32768
    s_cmp_eq_u32 s64, 0
    s_cbranch_scc1 L_nop_21
    s_add_u32 m0, s42, 0
    s_add_u32 s30, s39, 0
    buffer_load_dwordx4 v12, s[8:11], s30 offen lds
L_nop_21:
    v_exp_f32 v128, v128
    v_exp_f32 v129, v129
    v_exp_f32 v130, v130
    v_exp_f32 v131, v131
    s_waitcnt lgkmcnt(5)
    v_mfma_f32_32x32x16_bf16 v[176:191], v[196:199], v[32:35], v[240:255]
    ds_read_b128 v[196:199], v17 offset:40960
    v_exp_f32 v132, v132
    v_exp_f32 v133, v133
    v_exp_f32 v134, v134
    v_exp_f32 v135, v135
    s_waitcnt lgkmcnt(5)
    v_mfma_f32_32x32x16_bf16 v[160:175], v[200:203], v[36:39], v[160:175]
    ds_read_b128 v[200:203], v18 offset:32768
    s_cmp_eq_u32 s64, 0
    s_cbranch_scc1 L_nop_22
    s_add_u32 m0, s42, 4096
    s_add_u32 s30, s39, 4096
    buffer_load_dwordx4 v12, s[8:11], s30 offen lds
L_nop_22:
    v_add_f32 v10, v128, v129
    v_add_f32 v11, v130, v131
    v_cvt_pk_bf16_f32 v128, v128, v129
    v_cvt_pk_bf16_f32 v129, v130, v131
    s_waitcnt lgkmcnt(5)
    v_mfma_f32_32x32x16_bf16 v[176:191], v[204:207], v[36:39], v[176:191]
    ds_read_b128 v[204:207], v18 offset:40960
    v_exp_f32 v136, v136
    v_exp_f32 v137, v137
    v_exp_f32 v138, v138
    v_exp_f32 v139, v139
    s_waitcnt lgkmcnt(5)
    v_mfma_f32_32x32x16_bf16 v[160:175], v[208:211], v[40:43], v[160:175]
    ds_read_b128 v[208:211], v19 offset:32768
    s_cmp_eq_u32 s64, 0
    s_cbranch_scc1 L_nop_23
    s_add_u32 m0, s42, 8192
    s_add_u32 s30, s39, 8192
    buffer_load_dwordx4 v12, s[8:11], s30 offen lds
L_nop_23:
    v_add_f32 v10, v10, v132
    v_add_f32 v11, v11, v133
    v_add_f32 v10, v10, v134
    v_add_f32 v11, v11, v135
    s_waitcnt lgkmcnt(5)
    v_mfma_f32_32x32x16_bf16 v[176:191], v[212:215], v[40:43], v[176:191]
    ds_read_b128 v[212:215], v19 offset:40960
    v_cvt_pk_bf16_f32 v130, v132, v133
    v_cvt_pk_bf16_f32 v131, v134, v135
    v_exp_f32 v140, v140
    v_exp_f32 v141, v141
    s_waitcnt lgkmcnt(5)
    v_mfma_f32_32x32x16_bf16 v[160:175], v[192:195], v[44:47], v[160:175]
    ds_read_b128 v[192:195], v20 offset:32768
    s_cmp_eq_u32 s64, 0
    s_cbranch_scc1 L_nop_24
    s_add_u32 m0, s42, 12288
    s_add_u32 s30, s39, 12288
    buffer_load_dwordx4 v12, s[8:11], s30 offen lds
    s_add_u32 s39, s39, 32768
L_nop_24:
    v_exp_f32 v142, v142
    v_exp_f32 v143, v143
    v_add_f32 v10, v10, v136
    v_add_f32 v11, v11, v137
    s_waitcnt lgkmcnt(5)
    v_mfma_f32_32x32x16_bf16 v[176:191], v[196:199], v[44:47], v[176:191]
    ds_read_b128 v[196:199], v20 offset:40960
    v_add_f32 v10, v10, v138
    v_add_f32 v11, v11, v139
    v_cvt_pk_bf16_f32 v132, v136, v137
    v_cvt_pk_bf16_f32 v133, v138, v139
    s_waitcnt lgkmcnt(5)
    v_mfma_f32_32x32x16_bf16 v[160:175], v[200:203], v[48:51], v[160:175]
    ds_read_b128 v[200:203], v21 offset:32768
    s_add_u32 m0, s42, 49152
    s_add_u32 s30, s52, 0
    buffer_load_dwordx4 v13, s[12:15], s30 offen lds
    v_exp_f32 v144, v144
    v_exp_f32 v145, v145
    v_exp_f32 v146, v146
    v_exp_f32 v147, v147
    s_waitcnt lgkmcnt(5)
    v_mfma_f32_32x32x16_bf16 v[176:191], v[204:207], v[48:51], v[176:191]
    ds_read_b128 v[204:207], v21 offset:40960
    v_add_f32 v10, v10, v140
    v_add_f32 v11, v11, v141
    v_add_f32 v10, v10, v142
    v_add_f32 v11, v11, v143
    s_waitcnt lgkmcnt(5)
    v_mfma_f32_32x32x16_bf16 v[160:175], v[208:211], v[52:55], v[160:175]
    ds_read_b64_tr_b16 v[216:217], v22 offset:0
    ds_read_b64_tr_b16 v[218:219], v22 offset:2048
    s_add_u32 m0, s42, 53248
    s_add_u32 s30, s52, 4096
    buffer_load_dwordx4 v13, s[12:15], s30 offen lds
    v_cvt_pk_bf16_f32 v134, v140, v141
    v_cvt_pk_bf16_f32 v135, v142, v143
    v_exp_f32 v148, v148
    v_exp_f32 v149, v149
    s_waitcnt lgkmcnt(6)
    v_mfma_f32_32x32x16_bf16 v[176:191], v[212:215], v[52:55], v[176:191]
    ds_read_b64_tr_b16 v[220:221], v23 offset:0
    ds_read_b64_tr_b16 v[222:223], v23 offset:2048
    v_exp_f32 v150, v150
    v_exp_f32 v151, v151
    v_add_f32 v10, v10, v144
    v_add_f32 v11, v11, v145
    s_waitcnt lgkmcnt(7)
    v_mfma_f32_32x32x16_bf16 v[160:175], v[192:195], v[56:59], v[160:175]
    ds_read_b64_tr_b16 v[224:225], v24 offset:0
    ds_read_b64_tr_b16 v[226:227], v24 offset:2048
    s_add_u32 m0, s42, 57344
    s_add_u32 s30, s52, 8192
    buffer_load_dwordx4 v13, s[12:15], s30 offen lds
    v_add_f32 v10, v10, v146
    v_add_f32 v11, v11, v147
    v_cvt_pk_bf16_f32 v136, v144, v145
    v_cvt_pk_bf16_f32 v137, v146, v147
    s_waitcnt lgkmcnt(8)
    v_mfma_f32_32x32x16_bf16 v[176:191], v[196:199], v[56:59], v[176:191]
    ds_read_b64_tr_b16 v[228:229], v25 offset:0
    ds_read_b64_tr_b16 v[230:231], v25 offset:2048
    s_nop 0
    v_add_f32 v10, v10, v148
    v_add_f32 v11, v11, v149
    v_add_f32 v10, v10, v150
    s_waitcnt lgkmcnt(9)
    v_mfma_f32_32x32x16_bf16 v[160:175], v[200:203], v[60:63], v[160:175]
    ds_read_b64_tr_b16 v[232:233], v22 offset:4096
    ds_read_b64_tr_b16 v[234:235], v22 offset:6144
    s_add_u32 m0, s42, 61440
    s_add_u32 s30, s52, 12288
    buffer_load_dwordx4 v13, s[12:15], s30 offen lds
    s_add_u32 s52, s52, 32768
    v_add_f32 v11, v11, v151
    v_cvt_pk_bf16_f32 v138, v148, v149
    v_cvt_pk_bf16_f32 v139, v150, v151
    s_waitcnt lgkmcnt(10)
    v_mfma_f32_32x32x16_bf16 v[176:191], v[204:207], v[60:63], v[176:191]
    ds_read_b64_tr_b16 v[236:237], v23 offset:4096
    ds_read_b64_tr_b16 v[238:239], v23 offset:6144
    s_cmp_lg_u32 s64, 0
    s_cbranch_scc1 L_nomask_25
    s_nop 7
    s_nop 3
    v_cmp_le_i32 s[44:45], 0, v29
    v_cmp_le_i32 s[46:47], 1, v29
    v_cmp_le_i32 s[48:49], 2, v29
    v_cmp_le_i32 s[50:51], 3, v29
    s_nop 1
    v_cndmask_b32 v160, v31, v160, s[44:45]
    v_cndmask_b32 v161, v31, v161, s[46:47]
    v_cndmask_b32 v162, v31, v162, s[48:49]
    v_cndmask_b32 v163, v31, v163, s[50:51]
    v_cmp_le_i32 s[44:45], 8, v29
    v_cmp_le_i32 s[46:47], 9, v29
    v_cmp_le_i32 s[48:49], 10, v29
    v_cmp_le_i32 s[50:51], 11, v29
    s_nop 1
    v_cndmask_b32 v164, v31, v164, s[44:45]
    v_cndmask_b32 v165, v31, v165, s[46:47]
    v_cndmask_b32 v166, v31, v166, s[48:49]
    v_cndmask_b32 v167, v31, v167, s[50:51]
    v_cmp_le_i32 s[44:45], 16, v29
    v_cmp_le_i32 s[46:47], 17, v29
    v_cmp_le_i32 s[48:49], 18, v29
    v_cmp_le_i32 s[50:51], 19, v29
    s_nop 1
    v_cndmask_b32 v168, v31, v168, s[44:45]
    v_cndmask_b32 v169, v31, v169, s[46:47]
    v_cndmask_b32 v170, v31, v170, s[48:49]
    v_cndmask_b32 v171, v31, v171, s[50:51]
    v_cmp_le_i32 s[44:45], 24, v29
    v_cmp_le_i32 s[46:47], 25, v29
    v_cmp_le_i32 s[48:49], 26, v29
    v_cmp_le_i32 s[50:51], 27, v29
    s_nop 1
    v_cndmask_b32 v172, v31, v172, s[44:45]
    v_cndmask_b32 v173, v31, v173, s[46:47]
    v_cndmask_b32 v174, v31, v174, s[48:49]
    v_cndmask_b32 v175, v31, v175, s[50:51]
    v_cmp_le_i32 s[44:45], 32, v29
    v_cmp_le_i32 s[46:47], 33, v29
    v_cmp_le_i32 s[48:49], 34, v29
    v_cmp_le_i32 s[50:51], 35, v29
    s_nop 1
    v_cndmask_b32 v176, v31, v176, s[44:45]
    v_cndmask_b32 v177, v31, v177, s[46:47]
    v_cndmask_b32 v178, v31, v178, s[48:49]
    v_cndmask_b32 v179, v31, v179, s[50:51]
    v_cmp_le_i32 s[44:45], 40, v29
    v_cmp_le_i32 s[46:47], 41, v29
    v_cmp_le_i32 s[48:49], 42, v29
    v_cmp_le_i32 s[50:51], 43, v29
    s_nop 1
    v_cndmask_b32 v180, v31, v180, s[44:45]
    v_cndmask_b32 v181, v31, v181, s[46:47]
    v_cndmask_b32 v182, v31, v182, s[48:49]
    v_cndmask_b32 v183, v31, v183, s[50:51]
    v_cmp_le_i32 s[44:45], 48, v29
    v_cmp_le_i32 s[46:47], 49, v29
    v_cmp_le_i32 s[48:49], 50, v29
    v_cmp_le_i32 s[50:51], 51, v29
    s_nop 1
    v_cndmask_b32 v184, v31, v184, s[44:45]
    v_cndmask_b32 v185, v31, v185, s[46:47]
    v_cndmask_b32 v186, v31, v186, s[48:49]
    v_cndmask_b32 v187, v31, v187, s[50:51]
    v_cmp_le_i32 s[44:45], 56, v29
    v_cmp_le_i32 s[46:47], 57, v29
    v_cmp_le_i32 s[48:49], 58, v29
    v_cmp_le_i32 s[50:51], 59, v29
    s_nop 1
    v_cndmask_b32 v188, v31, v188, s[44:45]
    v_cndmask_b32 v189, v31, v189, s[46:47]
    v_cndmask_b32 v190, v31, v190, s[48:49]
    v_cndmask_b32 v191, v31, v191, s[50:51]
L_nomask_25:
    s_nop 1
    s_waitcnt lgkmcnt(10)
    v_mfma_f32_32x32x16_bf16 v[64:79], v[216:219], v[128:131], v[64:79]
    ds_read_b64_tr_b16 v[216:217], v24 offset:4096
    ds_read_b64_tr_b16 v[218:219], v24 offset:6144
    v_exp_f32 v152, v152
    v_exp_f32 v153, v153
    v_exp_f32 v154, v154
    s_waitcnt lgkmcnt(10)
    v_mfma_f32_32x32x16_bf16 v[80:95], v[220:223], v[128:131], v[80:95]
    ds_read_b64_tr_b16 v[220:221], v25 offset:4096
    ds_read_b64_tr_b16 v[222:223], v25 offset:6144
    v_exp_f32 v155, v155
    v_exp_f32 v156, v156
    v_exp_f32 v157, v157
    s_waitcnt lgkmcnt(10)
    v_mfma_f32_32x32x16_bf16 v[96:111], v[224:227], v[128:131], v[96:111]
    ds_read_b64_tr_b16 v[224:225], v22 offset:8192
    ds_read_b64_tr_b16 v[226:227], v22 offset:10240
    v_exp_f32 v158, v158
    v_exp_f32 v159, v159
    v_add_f32 v10, v10, v152
    s_waitcnt lgkmcnt(10)
    v_mfma_f32_32x32x16_bf16 v[112:127], v[228:231], v[128:131], v[112:127]
    ds_read_b64_tr_b16 v[228:229], v23 offset:8192
    ds_read_b64_tr_b16 v[230:231], v23 offset:10240
    v_add_f32 v11, v11, v153
    v_add_f32 v10, v10, v154
    v_add_f32 v11, v11, v155
    s_waitcnt lgkmcnt(10)
    v_mfma_f32_32x32x16_bf16 v[64:79], v[232:235], v[132:135], v[64:79]
    ds_read_b64_tr_b16 v[232:233], v24 offset:8192
    ds_read_b64_tr_b16 v[234:235], v24 offset:10240
    v_cvt_pk_bf16_f32 v140, v152, v153
    v_cvt_pk_bf16_f32 v141, v154, v155
    s_nop 0
    s_waitcnt lgkmcnt(10)
    v_mfma_f32_32x32x16_bf16 v[80:95], v[236:239], v[132:135], v[80:95]
    ds_read_b64_tr_b16 v[236:237], v25 offset:8192
    ds_read_b64_tr_b16 v[238:239], v25 offset:10240
    v_add_f32 v10, v10, v156
    v_add_f32 v11, v11, v157
    v_add_f32 v10, v10, v158
    v_max3_f32 v2, v160, v161, v162
    v_max3_f32 v3, v163, v164, v165
    s_waitcnt lgkmcnt(10)
    v_mfma_f32_32x32x16_bf16 v[96:111], v[216:219], v[132:135], v[96:111]
    ds_read_b64_tr_b16 v[216:217], v22 offset:12288
    ds_read_b64_tr_b16 v[218:219], v22 offset:14336
    v_add_f32 v11, v11, v159
    v_cvt_pk_bf16_f32 v142, v156, v157
    v_cvt_pk_bf16_f32 v143, v158, v159
    v_max3_f32 v2, v2, v166, v167
    v_max3_f32 v3, v3, v168, v169
    s_waitcnt lgkmcnt(10)
    v_mfma_f32_32x32x16_bf16 v[112:127], v[220:223], v[132:135], v[112:127]
    ds_read_b64_tr_b16 v[220:221], v23 offset:12288
    ds_read_b64_tr_b16 v[222:223], v23 offset:14336
    v_add_f32 v27, v27, v10
    v_add_f32 v27, v27, v11
    v_max3_f32 v2, v2, v170, v171
    v_max3_f32 v3, v3, v172, v173
    s_waitcnt lgkmcnt(10)
    v_mfma_f32_32x32x16_bf16 v[64:79], v[224:227], v[136:139], v[64:79]
    ds_read_b64_tr_b16 v[224:225], v24 offset:12288
    ds_read_b64_tr_b16 v[226:227], v24 offset:14336
    v_max3_f32 v2, v2, v174, v175
    v_max3_f32 v3, v3, v176, v177
    s_waitcnt lgkmcnt(10)
    v_mfma_f32_32x32x16_bf16 v[80:95], v[228:231], v[136:139], v[80:95]
    ds_read_b64_tr_b16 v[228:229], v25 offset:12288
    ds_read_b64_tr_b16 v[230:231], v25 offset:14336
    v_max3_f32 v2, v2, v178, v179
    v_max3_f32 v3, v3, v180, v181
    s_waitcnt lgkmcnt(10)
    v_mfma_f32_32x32x16_bf16 v[96:111], v[232:235], v[136:139], v[96:111]
    v_max3_f32 v2, v2, v182, v183
    v_max3_f32 v3, v3, v184, v185
    s_waitcnt lgkmcnt(8)
    v_mfma_f32_32x32x16_bf16 v[112:127], v[236:239], v[136:139], v[112:127]
    v_max3_f32 v2, v2, v186, v187
    v_max3_f32 v3, v3, v188, v189
    s_nop 1
    s_waitcnt vmcnt(0) lgkmcnt(0)
    s_barrier
    ds_read_b128 v[192:195], v14 offset:0
    ds_read_b128 v[196:199], v14 offset:8192
    ds_read_b128 v[200:203], v15 offset:0
    ds_read_b128 v[204:207], v15 offset:8192
    ds_read_b128 v[208:211], v16 offset:0
    ds_read_b128 v[212:215], v16 offset:8192
    s_add_u32 s40, s40, 1
    s_add_u32 s31, s40, 1
    s_cmp_lt_u32 s31, s38
    s_cselect_b32 s64, 1, 0
    v_mfma_f32_32x32x16_bf16 v[64:79], v[216:219], v[140:143], v[64:79]
    v_max3_f32 v2, v2, v190, v191
    v_max_f32 v2, v2, v3
    v_mfma_f32_32x32x16_bf16 v[80:95], v[220:223], v[140:143], v[80:95]
    v_mfma_f32_32x32x16_bf16 v[96:111], v[224:227], v[140:143], v[96:111]
    v_cmp_lt_f32 vcc, s41, v2
    v_mfma_f32_32x32x16_bf16 v[112:127], v[228:231], v[140:143], v[112:127]
    s_cbranch_vccz L_norescale_26
    s_nop 7
    s_nop 3
    v_mov_b32 v3, v2
    s_nop 1
    v_permlane32_swap_b32 v2, v3
    v_max_f32 v2, v2, v3
    v_max_f32 v2, 0, v2
    v_exp_f32 v28, -v2
    v_add_f32 v26, v26, v2
    v_sub_f32 v160, v160, v2
    v_sub_f32 v161, v161, v2
    v_sub_f32 v162, v162, v2
    v_sub_f32 v163, v163, v2
    v_sub_f32 v164, v164, v2
    v_sub_f32 v165, v165, v2
    v_sub_f32 v166, v166, v2
    v_sub_f32 v167, v167, v2
    v_sub_f32 v168, v168, v2
    v_sub_f32 v169, v169, v2
    v_sub_f32 v170, v170, v2
    v_sub_f32 v171, v171, v2
    v_sub_f32 v172, v172, v2
    v_sub_f32 v173, v173, v2
    v_sub_f32 v174, v174, v2
    v_sub_f32 v175, v175, v2
    v_sub_f32 v176, v176, v2
    v_sub_f32 v177, v177, v2
    v_sub_f32 v178, v178, v2
    v_sub_f32 v179, v179, v2
    v_sub_f32 v180, v180, v2
    v_sub_f32 v181, v181, v2
    v_sub_f32 v182, v182, v2
    v_sub_f32 v183, v183, v2
    v_sub_f32 v184, v184, v2
    v_sub_f32 v185, v185, v2
    v_sub_f32 v186, v186, v2
    v_sub_f32 v187, v187, v2
    v_sub_f32 v188, v188, v2
    v_sub_f32 v189, v189, v2
    v_sub_f32 v190, v190, v2
    v_sub_f32 v191, v191, v2
    v_sub_f32 v240, 0, v26
    v_sub_f32 v241, 0, v26
    v_sub_f32 v242, 0, v26
    v_sub_f32 v243, 0, v26
    v_sub_f32 v244, 0, v26
    v_sub_f32 v245, 0, v26
    v_sub_f32 v246, 0, v26
    v_sub_f32 v247, 0, v26
    v_sub_f32 v248, 0, v26
    v_sub_f32 v249, 0, v26
    v_sub_f32 v250, 0, v26
    v_sub_f32 v251, 0, v26
    v_sub_f32 v252, 0, v26
    v_sub_f32 v253, 0, v26
    v_sub_f32 v254, 0, v26
    v_sub_f32 v255, 0, v26
    v_mul_f32 v27, v27, v28
    v_mul_f32 v64, v64, v28
    v_mul_f32 v65, v65, v28
    v_mul_f32 v66, v66, v28
    v_mul_f32 v67, v67, v28
    v_mul_f32 v68, v68, v28
    v_mul_f32 v69, v69, v28
    v_mul_f32 v70, v70, v28
    v_mul_f32 v71, v71, v28
    v_mul_f32 v72, v72, v28
    v_mul_f32 v73, v73, v28
    v_mul_f32 v74, v74, v28
    v_mul_f32 v75, v75, v28
    v_mul_f32 v76, v76, v28
    v_mul_f32 v77, v77, v28
    v_mul_f32 v78, v78, v28
    v_mul_f32 v79, v79, v28
    v_mul_f32 v80, v80, v28
    v_mul_f32 v81, v81, v28
    v_mul_f32 v82, v82, v28
    v_mul_f32 v83, v83, v28
    v_mul_f32 v84, v84, v28
    v_mul_f32 v85, v85, v28
    v_mul_f32 v86, v86, v28
    v_mul_f32 v87, v87, v28
    v_mul_f32 v88, v88, v28
    v_mul_f32 v89, v89, v28
    v_mul_f32 v90, v90, v28
    v_mul_f32 v91, v91, v28
    v_mul_f32 v92, v92, v28
    v_mul_f32 v93, v93, v28
    v_mul_f32 v94, v94, v28
    v_mul_f32 v95, v95, v28
    v_mul_f32 v96, v96, v28
    v_mul_f32 v97, v97, v28
    v_mul_f32 v98, v98, v28
    v_mul_f32 v99, v99, v28
    v_mul_f32 v100, v100, v28
    v_mul_f32 v101, v101, v28
    v_mul_f32 v102, v102, v28
    v_mul_f32 v103, v103, v28
    v_mul_f32 v104, v104, v28
    v_mul_f32 v105, v105, v28
    v_mul_f32 v106, v106, v28
    v_mul_f32 v107, v107, v28
    v_mul_f32 v108, v108, v28
    v_mul_f32 v109, v109, v28
    v_mul_f32 v110, v110, v28
    v_mul_f32 v111, v111, v28
    v_mul_f32 v112, v112, v28
    v_mul_f32 v113, v113, v28
    v_mul_f32 v114, v114, v28
    v_mul_f32 v115, v115, v28
    v_mul_f32 v116, v116, v28
    v_mul_f32 v117, v117, v28
    v_mul_f32 v118, v118, v28
    v_mul_f32 v119, v119, v28
    v_mul_f32 v120, v120, v28
    v_mul_f32 v121, v121, v28
    v_mul_f32 v122, v122, v28
    v_mul_f32 v123, v123, v28
    v_mul_f32 v124, v124, v28
    v_mul_f32 v125, v125, v28
    v_mul_f32 v126, v126, v28
    v_mul_f32 v127, v127, v28
L_norescale_26:
L_amid_13:
    s_cmp_ge_u32 s40, s38
    s_cbranch_scc1 L_tail0_10
    s_waitcnt lgkmcnt(5)
    v_mfma_f32_32x32x16_bf16 v[128:143], v[192:195], v[32:35], v[240:255]
    ds_read_b128 v[192:195], v17 offset:0
    s_cmp_eq_u32 s64, 0
    s_cbranch_scc1 L_nop_27
    s_add_u32 m0, s42, 32768
    s_add_u32 s30, s39, 0
    buffer_load_dwordx4 v12, s[8:11], s30 offen lds
L_nop_27:
    v_exp_f32 v160, v160
    v_exp_f32 v161, v161
    v_exp_f32 v162, v162
    v_exp_f32 v163, v163
    s_waitcnt lgkmcnt(5)
    v_mfma_f32_32x32x16_bf16 v[144:159], v[196:199], v[32:35], v[240:255]
    ds_read_b128 v[196:199], v17 offset:8192
    v_exp_f32 v164, v164
    v_exp_f32 v165, v165
    v_exp_f32 v166, v166
    v_exp_f32 v167, v167
    s_waitcnt lgkmcnt(5)
    v_mfma_f32_32x32x16_bf16 v[128:143], v[200:203], v[36:39], v[128:143]
    ds_read_b128 v[200:203], v18 offset:0
    s_cmp_eq_u32 s64, 0
    s_cbranch_scc1 L_nop_28
    s_add_u32 m0, s42, 36864
    s_add_u32 s30, s39, 4096
    buffer_load_dwordx4 v12, s[8:11], s30 offen lds
L_nop_28:
    v_add_f32 v10, v160, v161
    v_add_f32 v11, v162, v163
    v_cvt_pk_bf16_f32 v160, v160, v161
    v_cvt_pk_bf16_f32 v161, v162, v163
    s_waitcnt lgkmcnt(5)
    v_mfma_f32_32x32x16_bf16 v[144:159], v[204:207], v[36:39], v[144:159]
    ds_read_b128 v[204:207], v18 offset:8192
    v_exp_f32 v168, v168
    v_exp_f32 v169, v169
    v_exp_f32 v170, v170
    v_exp_f32 v171, v171
    s_waitcnt lgkmcnt(5)
    v_mfma_f32_32x32x16_bf16 v[128:143], v[208:211], v[40:43], v[128:143]
    ds_read_b128 v[208:211], v19 offset:0
    s_cmp_eq_u32 s64, 0
    s_cbranch_scc1 L_nop_29
    s_add_u32 m0, s42, 40960
    s_add_u32 s30, s39, 8192
    buffer_load_dwordx4 v12, s[8:11], s30 offen lds
L_nop_29:
    v_add_f32 v10, v10, v164
    v_add_f32 v11, v11, v165
    v_add_f32 v10, v10, v166
    v_add_f32 v11, v11, v167
    s_waitcnt lgkmcnt(5)
    v_mfma_f32_32x32x16_bf16 v[144:159], v[212:215], v[40:43], v[144:159]
    ds_read_b128 v[212:215], v19 offset:8192
    v_cvt_pk_bf16_f32 v162, v164, v165
    v_cvt_pk_bf16_f32 v163, v166, v167
    v_exp_f32 v172, v172
    v_exp_f32 v173, v173
    s_waitcnt lgkmcnt(5)
    v_mfma_f32_32x32x16_bf16 v[128:143], v[192:195], v[44:47], v[128:143]
    ds_read_b128 v[192:195], v20 offset:0
    s_cmp_eq_u32 s64, 0
    s_cbranch_scc1 L_nop_30
    s_add_u32 m0, s42, 45056
    s_add_u32 s30, s39, 12288
    buffer_load_dwordx4 v12, s[8:11], s30 offen lds
    s_add_u32 s39, s39, 32768
L_nop_30:
    v_exp_f32 v174, v174
    v_exp_f32 v175, v175
    v_add_f32 v10, v10, v168
    v_add_f32 v11, v11, v169
    s_waitcnt lgkmcnt(5)
    v_mfma_f32_32x32x16_bf16 v[144:159], v[196:199], v[44:47], v[144:159]
    ds_read_b128 v[196:199], v20 offset:8192
    v_add_f32 v10, v10, v170
    v_add_f32 v11, v11, v171
    v_cvt_pk_bf16_f32 v164, v168, v169
    v_cvt_pk_bf16_f32 v165, v170, v171
    s_waitcnt lgkmcnt(5)
    v_mfma_f32_32x32x16_bf16 v[128:143], v[200:203], v[48:51], v[128:143]
    ds_read_b128 v[200:203], v21 offset:0
    s_add_u32 m0, s42, 16384
    s_add_u32 s30, s52, 0
    buffer_load_dwordx4 v13, s[12:15], s30 offen lds
    v_exp_f32 v176, v176
    v_exp_f32 v177, v177
    v_exp_f32 v178, v178
    v_exp_f32 v179, v179
    s_waitcnt lgkmcnt(5)
    v_mfma_f32_32x32x16_bf16 v[144:159], v[204:207], v[48:51], v[144:159]
    ds_read_b128 v[204:207], v21 offset:8192
    v_add_f32 v10, v10, v172
    v_add_f32 v11, v11, v173
    v_add_f32 v10, v10, v174
    v_add_f32 v11, v11, v175
    s_waitcnt lgkmcnt(5)
    v_mfma_f32_32x32x16_bf16 v[128:143], v[208:211], v[52:55], v[128:143]
    ds_read_b64_tr_b16 v[216:217], v22 offset:32768
    ds_read_b64_tr_b16 v[218:219], v22 offset:34816
    s_add_u32 m0, s42, 20480
    s_add_u32 s30, s52, 4096
    buffer_load_dwordx4 v13, s[12:15], s30 offen lds
    v_cvt_pk_bf16_f32 v166, v172, v173
    v_cvt_pk_bf16_f32 v167, v174, v175
    v_exp_f32 v180, v180
    v_exp_f32 v181, v181
    s_waitcnt lgkmcnt(6)
    v_mfma_f32_32x32x16_bf16 v[144:159], v[212:215], v[52:55], v[144:159]
    ds_read_b64_tr_b16 v[220:221], v23 offset:32768
    ds_read_b64_tr_b16 v[222:223], v23 offset:34816
    v_exp_f32 v182, v182
    v_exp_f32 v183, v183
    v_add_f32 v10, v10, v176
    v_add_f32 v11, v11, v177
    s_waitcnt lgkmcnt(7)
    v_mfma_f32_32x32x16_bf16 v[128:143], v[192:195], v[56:59], v[128:143]
    ds_read_b64_tr_b16 v[224:225], v24 offset:32768
    ds_read_b64_tr_b16 v[226:227], v24 offset:34816
    s_add_u32 m0, s42, 24576
    s_add_u32 s30, s52, 8192
    buffer_load_dwordx4 v13, s[12:15], s30 offen lds
    v_add_f32 v10, v10, v178
    v_add_f32 v11, v11, v179
    v_cvt_pk_bf16_f32 v168, v176, v177
    v_cvt_pk_bf16_f32 v169, v178, v179
    s_waitcnt lgkmcnt(8)
    v_mfma_f32_32x32x16_bf16 v[144:159], v[196:199], v[56:59], v[144:159]
    ds_read_b64_tr_b16 v[228:229], v25 offset:32768
    ds_read_b64_tr_b16 v[230:231], v25 offset:34816
    s_nop 0
    v_add_f32 v10, v10, v180
    v_add_f32 v11, v11, v181
    v_add_f32 v10, v10, v182
    s_waitcnt lgkmcnt(9)
    v_mfma_f32_32x32x16_bf16 v[128:143], v[200:203], v[60:63], v[128:143]
    ds_read_b64_tr_b16 v[232:233], v22 offset:36864
    ds_read_b64_tr_b16 v[234:235], v22 offset:38912
    s_add_u32 m0, s42, 28672
    s_add_u32 s30, s52, 12288
    buffer_load_dwordx4 v13, s[12:15], s30 offen lds
    s_add_u32 s52, s52, 32768
    v_add_f32 v11, v11, v183
    v_cvt_pk_bf16_f32 v170, v180, v181
    v_cvt_pk_bf16_f32 v171, v182, v183
    s_waitcnt lgkmcnt(10)
    v_mfma_f32_32x32x16_bf16 v[144:159], v[204:207], v[60:63], v[144:159]
    ds_read_b64_tr_b16 v[236:237], v23 offset:36864
    ds_read_b64_tr_b16 v[238:239], v23 offset:38912
    s_cmp_lg_u32 s64, 0
    s_cbranch_scc1 L_nomask_31
    s_nop 7
    s_nop 3
    v_cmp_le_i32 s[44:45], 0, v29
    v_cmp_le_i32 s[46:47], 1, v29
    v_cmp_le_i32 s[48:49], 2, v29
    v_cmp_le_i32 s[50:51], 3, v29
    s_nop 1
    v_cndmask_b32 v128, v31, v128, s[44:45]
    v_cndmask_b32 v129, v31, v129, s[46:47]
    v_cndmask_b32 v130, v31, v130, s[48:49]
    v_cndmask_b32 v131, v31, v131, s[50:51]
    v_cmp_le_i32 s[44:45], 8, v29
    v_cmp_le_i32 s[46:47], 9, v29
    v_cmp_le_i32 s[48:49], 10, v29
    v_cmp_le_i32 s[50:51], 11, v29
    s_nop 1
    v_cndmask_b32 v132, v31, v132, s[44:45]
    v_cndmask_b32 v133, v31, v133, s[46:47]
    v_cndmask_b32 v134, v31, v134, s[48:49]
    v_cndmask_b32 v135, v31, v135, s[50:51]
    v_cmp_le_i32 s[44:45], 16, v29
    v_cmp_le_i32 s[46:47], 17, v29
    v_cmp_le_i32 s[48:49], 18, v29
    v_cmp_le_i32 s[50:51], 19, v29
    s_nop 1
    v_cndmask_b32 v136, v31, v136, s[44:45]
    v_cndmask_b32 v137, v31, v137, s[46:47]
    v_cndmask_b32 v138, v31, v138, s[48:49]
    v_cndmask_b32 v139, v31, v139, s[50:51]
    v_cmp_le_i32 s[44:45], 24, v29
    v_cmp_le_i32 s[46:47], 25, v29
    v_cmp_le_i32 s[48:49], 26, v29
    v_cmp_le_i32 s[50:51], 27, v29
    s_nop 1
    v_cndmask_b32 v140, v31, v140, s[44:45]
    v_cndmask_b32 v141, v31, v141, s[46:47]
    v_cndmask_b32 v142, v31, v142, s[48:49]
    v_cndmask_b32 v143, v31, v143, s[50:51]
    v_cmp_le_i32 s[44:45], 32, v29
    v_cmp_le_i32 s[46:47], 33, v29
    v_cmp_le_i32 s[48:49], 34, v29
    v_cmp_le_i32 s[50:51], 35, v29
    s_nop 1
    v_cndmask_b32 v144, v31, v144, s[44:45]
    v_cndmask_b32 v145, v31, v145, s[46:47]
    v_cndmask_b32 v146, v31, v146, s[48:49]
    v_cndmask_b32 v147, v31, v147, s[50:51]
    v_cmp_le_i32 s[44:45], 40, v29
    v_cmp_le_i32 s[46:47], 41, v29
    v_cmp_le_i32 s[48:49], 42, v29
    v_cmp_le_i32 s[50:51], 43, v29
    s_nop 1
    v_cndmask_b32 v148, v31, v148, s[44:45]
    v_cndmask_b32 v149, v31, v149, s[46:47]
    v_cndmask_b32 v150, v31, v150, s[48:49]
    v_cndmask_b32 v151, v31, v151, s[50:51]
    v_cmp_le_i32 s[44:45], 48, v29
    v_cmp_le_i32 s[46:47], 49, v29
    v_cmp_le_i32 s[48:49], 50, v29
    v_cmp_le_i32 s[50:51], 51, v29
    s_nop 1
    v_cndmask_b32 v152, v31, v152, s[44:45]
    v_cndmask_b32 v153, v31, v153, s[46:47]
    v_cndmask_b32 v154, v31, v154, s[48:49]
    v_cndmask_b32 v155, v31, v155, s[50:51]
    v_cmp_le_i32 s[44:45], 56, v29
    v_cmp_le_i32 s[46:47], 57, v29
    v_cmp_le_i32 s[48:49], 58, v29
    v_cmp_le_i32 s[50:51], 59, v29
    s_nop 1
    v_cndmask_b32 v156, v31, v156, s[44:45]
    v_cndmask_b32 v157, v31, v157, s[46:47]
    v_cndmask_b32 v158, v31, v158, s[48:49]
    v_cndmask_b32 v159, v31, v159, s[50:51]
L_nomask_31:
    s_nop 1
    s_waitcnt lgkmcnt(10)
    v_mfma_f32_32x32x16_bf16 v[64:79], v[216:219], v[160:163], v[64:79]
    ds_read_b64_tr_b16 v[216:217], v24 offset:36864
    ds_read_b64_tr_b16 v[218:219], v24 offset:38912
    v_exp_f32 v184, v184
    v_exp_f32 v185, v185
    v_exp_f32 v186, v186
    s_waitcnt lgkmcnt(10)
    v_mfma_f32_32x32x16_bf16 v[80:95], v[220:223], v[160:163], v[80:95]
    ds_read_b64_tr_b16 v[220:221], v25 offset:36864
    ds_read_b64_tr_b16 v[222:223], v25 offset:38912
    v_exp_f32 v187, v187
    v_exp_f32 v188, v188
    v_exp_f32 v189, v189
    s_waitcnt lgkmcnt(10)
    v_mfma_f32_32x32x16_bf16 v[96:111], v[224:227], v[160:163], v[96:111]
    ds_read_b64_tr_b16 v[224:225], v22 offset:40960
    ds_read_b64_tr_b16 v[226:227], v22 offset:43008
    v_exp_f32 v190, v190
    v_exp_f32 v191, v191
    v_add_f32 v10, v10, v184
    s_waitcnt lgkmcnt(10)
    v_mfma_f32_32x32x16_bf16 v[112:127], v[228:231], v[160:163], v[112:127]
    ds_read_b64_tr_b16 v[228:229], v23 offset:40960
    ds_read_b64_tr_b16 v[230:231], v23 offset:43008
    v_add_f32 v11, v11, v185
    v_add_f32 v10, v10, v186
    v_add_f32 v11, v11, v187
    s_waitcnt lgkmcnt(10)
    v_mfma_f32_32x32x16_bf16 v[64:79], v[232:235], v[164:167], v[64:79]
    ds_read_b64_tr_b16 v[232:233], v24 offset:40960
    ds_read_b64_tr_b16 v[234:235], v24 offset:43008
    v_cvt_pk_bf16_f32 v172, v184, v185
    v_cvt_pk_bf16_f32 v173, v186, v187
    s_nop 0
    s_waitcnt lgkmcnt(10)
    v_mfma_f32_32x32x16_bf16 v[80:95], v[236:239], v[164:167], v[80:95]
    ds_read_b64_tr_b16 v[236:237], v25 offset:40960
    ds_read_b64_tr_b16 v[238:239], v25 offset:43008
    v_add_f32 v10, v10, v188
    v_add_f32 v11, v11, v189
    v_add_f32 v10, v10, v190
    v_max3_f32 v2, v128, v129, v130
    v_max3_f32 v3, v131, v132, v133
    s_waitcnt lgkmcnt(10)
    v_mfma_f32_32x32x16_bf16 v[96:111], v[216:219], v[164:167], v[96:111]
    ds_read_b64_tr_b16 v[216:217], v22 offset:45056
    ds_read_b64_tr_b16 v[218:219], v22 offset:47104
    v_add_f32 v11, v11, v191
    v_cvt_pk_bf16_f32 v174, v188, v189
    v_cvt_pk_bf16_f32 v175, v190, v191
    v_max3_f32 v2, v2, v134, v135
    v_max3_f32 v3, v3, v136, v137
    s_waitcnt lgkmcnt(10)
    v_mfma_f32_32x32x16_bf16 v[112:127], v[220:223], v[164:167], v[112:127]
    ds_read_b64_tr_b16 v[220:221], v23 offset:45056
    ds_read_b64_tr_b16 v[222:223], v23 offset:47104
    v_add_f32 v27, v27, v10
    v_add_f32 v27, v27, v11
    v_max3_f32 v2, v2, v138, v139
    v_max3_f32 v3, v3, v140, v141
    s_waitcnt lgkmcnt(10)
    v_mfma_f32_32x32x16_bf16 v[64:79], v[224:227], v[168:171], v[64:79]
    ds_read_b64_tr_b16 v[224:225], v24 offset:45056
    ds_read_b64_tr_b16 v[226:227], v24 offset:47104
    v_max3_f32 v2, v2, v142, v143
    v_max3_f32 v3, v3, v144, v145
    s_waitcnt lgkmcnt(10)
    v_mfma_f32_32x32x16_bf16 v[80:95], v[228:231], v[168:171], v[80:95]
    ds_read_b64_tr_b16 v[228:229], v25 offset:45056
    ds_read_b64_tr_b16 v[230:231], v25 offset:47104
    v_max3_f32 v2, v2, v146, v147
    v_max3_f32 v3, v3, v148, v149
    s_waitcnt lgkmcnt(10)
    v_mfma_f32_32x32x16_bf16 v[96:111], v[232:235], v[168:171], v[96:111]
    v_max3_f32 v2, v2, v150, v151
    v_max3_f32 v3, v3, v152, v153
    s_waitcnt lgkmcnt(8)
    v_mfma_f32_32x32x16_bf16 v[112:127], v[236:239], v[168:171], v[112:127]
    v_max3_f32 v2, v2, v154, v155
    v_max3_f32 v3, v3, v156, v157
    s_nop 1
    s_waitcnt vmcnt(0) lgkmcnt(0)
    s_barrier
    ds_read_b128 v[192:195], v14 offset:32768
    ds_read_b128 v[196:199], v14 offset:40960
    ds_read_b128 v[200:203], v15 offset:32768
    ds_read_b128 v[204:207], v15 offset:40960
    ds_read_b128 v[208:211], v16 offset:32768
    ds_read_b128 v[212:215], v16 offset:40960
    s_add_u32 s40, s40, 1
    s_add_u32 s31, s40, 1
    s_cmp_lt_u32 s31, s38
    s_cselect_b32 s64, 1, 0
    v_mfma_f32_32x32x16_bf16 v[64:79], v[216:219], v[172:175], v[64:79]
    v_max3_f32 v2, v2, v158, v159
    v_max_f32 v2, v2, v3
    v_mfma_f32_32x32x16_bf16 v[80:95], v[220:223], v[172:175], v[80:95]
    v_mfma_f32_32x32x16_bf16 v[96:111], v[224:227], v[172:175], v[96:111]
    v_cmp_lt_f32 vcc, s41, v2
    v_mfma_f32_32x32x16_bf16 v[112:127], v[228:231], v[172:175], v[112:127]
    s_cbranch_vccz L_norescale_32
    s_nop 7
    s_nop 3
    v_mov_b32 v3, v2
    s_nop 1
    v_permlane32_swap_b32 v2, v3
    v_max_f32 v2, v2, v3
    v_max_f32 v2, 0, v2
    v_exp_f32 v28, -v2
    v_add_f32 v26, v26, v2
    v_sub_f32 v128, v128, v2
    v_sub_f32 v129, v129, v2
    v_sub_f32 v130, v130, v2
    v_sub_f32 v131, v131, v2
    v_sub_f32 v132, v132, v2
    v_sub_f32 v133, v133, v2
    v_sub_f32 v134, v134, v2
    v_sub_f32 v135, v135, v2
    v_sub_f32 v136, v136, v2
    v_sub_f32 v137, v137, v2
    v_sub_f32 v138, v138, v2
    v_sub_f32 v139, v139, v2
    v_sub_f32 v140, v140, v2
    v_sub_f32 v141, v141, v2
    v_sub_f32 v142, v142, v2
    v_sub_f32 v143, v143, v2
    v_sub_f32 v144, v144, v2
    v_sub_f32 v145, v145, v2
    v_sub_f32 v146, v146, v2
    v_sub_f32 v147, v147, v2
    v_sub_f32 v148, v148, v2
    v_sub_f32 v149, v149, v2
    v_sub_f32 v150, v150, v2
    v_sub_f32 v151, v151, v2
    v_sub_f32 v152, v152, v2
    v_sub_f32 v153, v153, v2
    v_sub_f32 v154, v154, v2
    v_sub_f32 v155, v155, v2
    v_sub_f32 v156, v156, v2
    v_sub_f32 v157, v157, v2
    v_sub_f32 v158, v158, v2
    v_sub_f32 v159, v159, v2
    v_sub_f32 v240, 0, v26
    v_sub_f32 v241, 0, v26
    v_sub_f32 v242, 0, v26
    v_sub_f32 v243, 0, v26
    v_sub_f32 v244, 0, v26
    v_sub_f32 v245, 0, v26
    v_sub_f32 v246, 0, v26
    v_sub_f32 v247, 0, v26
    v_sub_f32 v248, 0, v26
    v_sub_f32 v249, 0, v26
    v_sub_f32 v250, 0, v26
    v_sub_f32 v251, 0, v26
    v_sub_f32 v252, 0, v26
    v_sub_f32 v253, 0, v26
    v_sub_f32 v254, 0, v26
    v_sub_f32 v255, 0, v26
    v_mul_f32 v27, v27, v28
    v_mul_f32 v64, v64, v28
    v_mul_f32 v65, v65, v28
    v_mul_f32 v66, v66, v28
    v_mul_f32 v67, v67, v28
    v_mul_f32 v68, v68, v28
    v_mul_f32 v69, v69, v28
    v_mul_f32 v70, v70, v28
    v_mul_f32 v71, v71, v28
    v_mul_f32 v72, v72, v28
    v_mul_f32 v73, v73, v28
    v_mul_f32 v74, v74, v28
    v_mul_f32 v75, v75, v28
    v_mul_f32 v76, v76, v28
    v_mul_f32 v77, v77, v28
    v_mul_f32 v78, v78, v28
    v_mul_f32 v79, v79, v28
    v_mul_f32 v80, v80, v28
    v_mul_f32 v81, v81, v28
    v_mul_f32 v82, v82, v28
    v_mul_f32 v83, v83, v28
    v_mul_f32 v84, v84, v28
    v_mul_f32 v85, v85, v28
    v_mul_f32 v86, v86, v28
    v_mul_f32 v87, v87, v28
    v_mul_f32 v88, v88, v28
    v_mul_f32 v89, v89, v28
    v_mul_f32 v90, v90, v28
    v_mul_f32 v91, v91, v28
    v_mul_f32 v92, v92, v28
    v_mul_f32 v93, v93, v28
    v_mul_f32 v94, v94, v28
    v_mul_f32 v95, v95, v28
    v_mul_f32 v96, v96, v28
    v_mul_f32 v97, v97, v28
    v_mul_f32 v98, v98, v28
    v_mul_f32 v99, v99, v28
    v_mul_f32 v100, v100, v28
    v_mul_f32 v101, v101, v28
    v_mul_f32 v102, v102, v28
    v_mul_f32 v103, v103, v28
    v_mul_f32 v104, v104, v28
    v_mul_f32 v105, v105, v28
    v_mul_f32 v106, v106, v28
    v_mul_f32 v107, v107, v28
    v_mul_f32 v108, v108, v28
    v_mul_f32 v109, v109, v28
    v_mul_f32 v110, v110, v28
    v_mul_f32 v111, v111, v28
    v_mul_f32 v112, v112, v28
    v_mul_f32 v113, v113, v28
    v_mul_f32 v114, v114, v28
    v_mul_f32 v115, v115, v28
    v_mul_f32 v116, v116, v28
    v_mul_f32 v117, v117, v28
    v_mul_f32 v118, v118, v28
    v_mul_f32 v119, v119, v28
    v_mul_f32 v120, v120, v28
    v_mul_f32 v121, v121, v28
    v_mul_f32 v122, v122, v28
    v_mul_f32 v123, v123, v28
    v_mul_f32 v124, v124, v28
    v_mul_f32 v125, v125, v28
    v_mul_f32 v126, v126, v28
    v_mul_f32 v127, v127, v28
L_norescale_32:
    s_branch L_aloop_9
L_tail1f_12:
    ds_read_b64_tr_b16 v[216:217], v22 offset:0
    ds_read_b64_tr_b16 v[218:219], v22 offset:2048
    ds_read_b64_tr_b16 v[220:221], v23 offset:0
    ds_read_b64_tr_b16 v[222:223], v23 offset:2048
    ds_read_b64_tr_b16 v[224:225], v24 offset:0
    ds_read_b64_tr_b16 v[226:227], v24 offset:2048
    ds_read_b64_tr_b16 v[228:229], v25 offset:0
    ds_read_b64_tr_b16 v[230:231], v25 offset:2048
    ds_read_b64_tr_b16 v[232:233], v22 offset:4096
    ds_read_b64_tr_b16 v[234:235], v22 offset:6144
    ds_read_b64_tr_b16 v[236:237], v23 offset:4096
    ds_read_b64_tr_b16 v[238:239], v23 offset:6144
    s_cmp_lg_u32 s43, 0
    s_cbranch_scc1 L_nonext_33
    s_lshl_b32 s39, s34, 14
    s_add_u32 s39, s39, s36
    s_lshl_b32 s30, s35, 10
    s_add_u32 s39, s39, s30
    s_mov_b32 s52, s39
    s_add_u32 m0, s42, 0
    s_nop 0
    buffer_load_dwordx4 v12, s[8:11], s39 offen lds
    s_add_u32 m0, s42, 4096
    s_add_u32 s30, s39, 4096
    buffer_load_dwordx4 v12, s[8:11], s30 offen lds
    s_add_u32 m0, s42, 8192
    s_add_u32 s30, s39, 8192
    buffer_load_dwordx4 v12, s[8:11], s30 offen lds
    s_add_u32 m0, s42, 12288
    s_add_u32 s30, s39, 12288
    buffer_load_dwordx4 v12, s[8:11], s30 offen lds
    s_add_u32 s39, s39, 32768
    s_lshl_b32 s30, s34, 16
    s_lshl_b32 s31, s35, 13
    s_sub_u32 s30, s31, s30
    s_add_u32 s30, s30, 131072
    v_add_u32 v9, s30, v14
    ds_read_b128 v[32:35], v9
    v_add_u32 v9, s30, v15
    ds_read_b128 v[36:39], v9
    v_add_u32 v9, s30, v16
    ds_read_b128 v[40:43], v9
    v_add_u32 v9, s30, v17
    ds_read_b128 v[44:47], v9
    v_add_u32 v9, s30, v18
    ds_read_b128 v[48:51], v9
    v_add_u32 v9, s30, v19
    ds_read_b128 v[52:55], v9
    v_add_u32 v9, s30, v20
    ds_read_b128 v[56:59], v9
    v_add_u32 v9, s30, v21
    ds_read_b128 v[60:63], v9
    s_waitcnt lgkmcnt(0)
    s_branch L_hookj_34
L_nonext_33:
    v_lshlrev_b32 v63, 4, v1
    s_mov_b32 s76, s66
    s_mov_b32 s77, s67
    s_mov_b32 s78, 4194304
    s_mov_b32 s79, 0x00020000
    buffer_load_dwordx4 v[32:35], v63, s[76:79], s74 offen
    buffer_load_dwordx4 v[36:39], v63, s[76:79], s74 offen offset:1024
    s_mov_b32 s76, s68
    s_mov_b32 s77, s69
    s_mov_b32 s78, 1835008
    s_mov_b32 s79, 0x00020000
    buffer_load_dwordx4 v[40:43], v63, s[76:79], s75 offen
    s_mov_b32 s76, s70
    s_mov_b32 s77, s71
    s_mov_b32 s78, 1835008
    s_mov_b32 s79, 0x00020000
    buffer_load_dwordx4 v[44:47], v63, s[76:79], s75 offen
    s_mov_b32 s76, s72
    s_mov_b32 s77, s73
    s_mov_b32 s78, 1835008
    s_mov_b32 s79, 0x00020000
    buffer_load_dwordx4 v[48:51], v63, s[76:79], s75 offen
L_hookj_34:
    v_exp_f32 v128, v128
    v_exp_f32 v129, v129
    v_exp_f32 v130, v130
    v_exp_f32 v131, v131
    v_exp_f32 v132, v132
    v_exp_f32 v133, v133
    v_exp_f32 v134, v134
    v_exp_f32 v135, v135
    v_add_f32 v10, v128, v129
    v_add_f32 v11, v130, v131
    v_cvt_pk_bf16_f32 v128, v128, v129
    v_cvt_pk_bf16_f32 v129, v130, v131
    v_exp_f32 v136, v136
    v_exp_f32 v137, v137
    v_exp_f32 v138, v138
    v_exp_f32 v139, v139
    v_add_f32 v10, v10, v132
    v_add_f32 v11, v11, v133
    v_add_f32 v10, v10, v134
    v_add_f32 v11, v11, v135
    v_cvt_pk_bf16_f32 v130, v132, v133
    v_cvt_pk_bf16_f32 v131, v134, v135
    v_exp_f32 v140, v140
    v_exp_f32 v141, v141
    v_exp_f32 v142, v142
    v_exp_f32 v143, v143
    v_add_f32 v10, v10, v136
    v_add_f32 v11, v11, v137
    v_add_f32 v10, v10, v138
    v_add_f32 v11, v11, v139
    v_cvt_pk_bf16_f32 v132, v136, v137
    v_cvt_pk_bf16_f32 v133, v138, v139
    v_exp_f32 v144, v144
    v_exp_f32 v145, v145
    v_exp_f32 v146, v146
    v_exp_f32 v147, v147
    v_add_f32 v10, v10, v140
    v_add_f32 v11, v11, v141
    v_add_f32 v10, v10, v142
    v_add_f32 v11, v11, v143
    v_cvt_pk_bf16_f32 v134, v140, v141
    v_cvt_pk_bf16_f32 v135, v142, v143
    v_exp_f32 v148, v148
    v_exp_f32 v149, v149
    v_exp_f32 v150, v150
    v_exp_f32 v151, v151
    v_add_f32 v10, v10, v144
    v_add_f32 v11, v11, v145
    v_add_f32 v10, v10, v146
    v_add_f32 v11, v11, v147
    v_cvt_pk_bf16_f32 v136, v144, v145
    v_cvt_pk_bf16_f32 v137, v146, v147
    s_nop 0
    v_add_f32 v10, v10, v148
    v_add_f32 v11, v11, v149
    v_add_f32 v10, v10, v150
    v_add_f32 v11, v11, v151
    v_cvt_pk_bf16_f32 v138, v148, v149
    v_cvt_pk_bf16_f32 v139, v150, v151
    s_nop 1
    s_waitcnt lgkmcnt(10)
    v_mfma_f32_32x32x16_bf16 v[64:79], v[216:219], v[128:131], 0
    ds_read_b64_tr_b16 v[216:217], v24 offset:4096
    ds_read_b64_tr_b16 v[218:219], v24 offset:6144
    v_exp_f32 v152, v152
    v_exp_f32 v153, v153
    v_exp_f32 v154, v154
    s_waitcnt lgkmcnt(10)
    v_mfma_f32_32x32x16_bf16 v[80:95], v[220:223], v[128:131], 0
    ds_read_b64_tr_b16 v[220:221], v25 offset:4096
    ds_read_b64_tr_b16 v[222:223], v25 offset:6144
    v_exp_f32 v155, v155
    v_exp_f32 v156, v156
    v_exp_f32 v157, v157
    s_waitcnt lgkmcnt(10)
    v_mfma_f32_32x32x16_bf16 v[96:111], v[224:227], v[128:131], 0
    ds_read_b64_tr_b16 v[224:225], v22 offset:8192
    ds_read_b64_tr_b16 v[226:227], v22 offset:10240
    v_exp_f32 v158, v158
    v_exp_f32 v159, v159
    v_add_f32 v10, v10, v152
    s_waitcnt lgkmcnt(10)
    v_mfma_f32_32x32x16_bf16 v[112:127], v[228:231], v[128:131], 0
    ds_read_b64_tr_b16 v[228:229], v23 offset:8192
    ds_read_b64_tr_b16 v[230:231], v23 offset:10240
    v_add_f32 v11, v11, v153
    v_add_f32 v10, v10, v154
    v_add_f32 v11, v11, v155
    s_waitcnt lgkmcnt(10)
    v_mfma_f32_32x32x16_bf16 v[64:79], v[232:235], v[132:135], v[64:79]
    ds_read_b64_tr_b16 v[232:233], v24 offset:8192
    ds_read_b64_tr_b16 v[234:235], v24 offset:10240
    v_cvt_pk_bf16_f32 v140, v152, v153
    v_cvt_pk_bf16_f32 v141, v154, v155
    s_nop 0
    s_waitcnt lgkmcnt(10)
    v_mfma_f32_32x32x16_bf16 v[80:95], v[236:239], v[132:135], v[80:95]
    ds_read_b64_tr_b16 v[236:237], v25 offset:8192
    ds_read_b64_tr_b16 v[238:239], v25 offset:10240
    v_add_f32 v10, v10, v156
    v_add_f32 v11, v11, v157
    v_add_f32 v10, v10, v158
    s_waitcnt lgkmcnt(10)
    v_mfma_f32_32x32x16_bf16 v[96:111], v[216:219], v[132:135], v[96:111]
    ds_read_b64_tr_b16 v[216:217], v22 offset:12288
    ds_read_b64_tr_b16 v[218:219], v22 offset:14336
    v_add_f32 v11, v11, v159
    v_cvt_pk_bf16_f32 v142, v156, v157
    v_cvt_pk_bf16_f32 v143, v158, v159
    s_waitcnt lgkmcnt(10)
    v_mfma_f32_32x32x16_bf16 v[112:127], v[220:223], v[132:135], v[112:127]
    ds_read_b64_tr_b16 v[220:221], v23 offset:12288
    ds_read_b64_tr_b16 v[222:223], v23 offset:14336
    v_add_f32 v27, v27, v10
    v_add_f32 v27, v27, v11
    s_waitcnt lgkmcnt(10)
    v_mfma_f32_32x32x16_bf16 v[64:79], v[224:227], v[136:139], v[64:79]
    ds_read_b64_tr_b16 v[224:225], v24 offset:12288
    ds_read_b64_tr_b16 v[226:227], v24 offset:14336
    s_waitcnt lgkmcnt(10)
    v_mfma_f32_32x32x16_bf16 v[80:95], v[228:231], v[136:139], v[80:95]
    ds_read_b64_tr_b16 v[228:229], v25 offset:12288
    ds_read_b64_tr_b16 v[230:231], v25 offset:14336
    s_waitcnt lgkmcnt(10)
    v_mfma_f32_32x32x16_bf16 v[96:111], v[232:235], v[136:139], v[96:111]
    s_waitcnt lgkmcnt(8)
    v_mfma_f32_32x32x16_bf16 v[112:127], v[236:239], v[136:139], v[112:127]
    s_nop 1
    s_waitcnt lgkmcnt(6)
    v_mfma_f32_32x32x16_bf16 v[64:79], v[216:219], v[140:143], v[64:79]
    s_waitcnt lgkmcnt(4)
    v_mfma_f32_32x32x16_bf16 v[80:95], v[220:223], v[140:143], v[80:95]
    s_waitcnt lgkmcnt(2)
    v_mfma_f32_32x32x16_bf16 v[96:111], v[224:227], v[140:143], v[96:111]
    s_waitcnt lgkmcnt(0)
    v_mfma_f32_32x32x16_bf16 v[112:127], v[228:231], v[140:143], v[112:127]
    s_branch L_adone_14
L_tail1_11:
    ds_read_b64_tr_b16 v[216:217], v22 offset:0
    ds_read_b64_tr_b16 v[218:219], v22 offset:2048
    ds_read_b64_tr_b16 v[220:221], v23 offset:0
    ds_read_b64_tr_b16 v[222:223], v23 offset:2048
    ds_read_b64_tr_b16 v[224:225], v24 offset:0
    ds_read_b64_tr_b16 v[226:227], v24 offset:2048
    ds_read_b64_tr_b16 v[228:229], v25 offset:0
    ds_read_b64_tr_b16 v[230:231], v25 offset:2048
    ds_read_b64_tr_b16 v[232:233], v22 offset:4096
    ds_read_b64_tr_b16 v[234:235], v22 offset:6144
    ds_read_b64_tr_b16 v[236:237], v23 offset:4096
    ds_read_b64_tr_b16 v[238:239], v23 offset:6144
    s_cmp_lg_u32 s43, 0
    s_cbranch_scc1 L_nonext_35
    s_lshl_b32 s39, s34, 14
    s_add_u32 s39, s39, s36
    s_lshl_b32 s30, s35, 10
    s_add_u32 s39, s39, s30
    s_mov_b32 s52, s39
    s_add_u32 m0, s42, 0
    s_nop 0
    buffer_load_dwordx4 v12, s[8:11], s39 offen lds
    s_add_u32 m0, s42, 4096
    s_add_u32 s30, s39, 4096
    buffer_load_dwordx4 v12, s[8:11], s30 offen lds
    s_add_u32 m0, s42, 8192
    s_add_u32 s30, s39, 8192
    buffer_load_dwordx4 v12, s[8:11], s30 offen lds
    s_add_u32 m0, s42, 12288
    s_add_u32 s30, s39, 12288
    buffer_load_dwordx4 v12, s[8:11], s30 offen lds
    s_add_u32 s39, s39, 32768
    s_lshl_b32 s30, s34, 16
    s_lshl_b32 s31, s35, 13
    s_sub_u32 s30, s31, s30
    s_add_u32 s30, s30, 131072
    v_add_u32 v9, s30, v14
    ds_read_b128 v[32:35], v9
    v_add_u32 v9, s30, v15
    ds_read_b128 v[36:39], v9
    v_add_u32 v9, s30, v16
    ds_read_b128 v[40:43], v9
    v_add_u32 v9, s30, v17
    ds_read_b128 v[44:47], v9
    v_add_u32 v9, s30, v18
    ds_read_b128 v[48:51], v9
    v_add_u32 v9, s30, v19
    ds_read_b128 v[52:55], v9
    v_add_u32 v9, s30, v20
    ds_read_b128 v[56:59], v9
    v_add_u32 v9, s30, v21
    ds_read_b128 v[60:63], v9
    s_waitcnt lgkmcnt(0)
    s_branch L_hookj_36
L_nonext_35:
    v_lshlrev_b32 v63, 4, v1
    s_mov_b32 s76, s66
    s_mov_b32 s77, s67
    s_mov_b32 s78, 4194304
    s_mov_b32 s79, 0x00020000
    buffer_load_dwordx4 v[32:35], v63, s[76:79], s74 offen
    buffer_load_dwordx4 v[36:39], v63, s[76:79], s74 offen offset:1024
    s_mov_b32 s76, s68
    s_mov_b32 s77, s69
    s_mov_b32 s78, 1835008
    s_mov_b32 s79, 0x00020000
    buffer_load_dwordx4 v[40:43], v63, s[76:79], s75 offen
    s_mov_b32 s76, s70
    s_mov_b32 s77, s71
    s_mov_b32 s78, 1835008
    s_mov_b32 s79, 0x00020000
    buffer_load_dwordx4 v[44:47], v63, s[76:79], s75 offen
    s_mov_b32 s76, s72
    s_mov_b32 s77, s73
    s_mov_b32 s78, 1835008
    s_mov_b32 s79, 0x00020000
    buffer_load_dwordx4 v[48:51], v63, s[76:79], s75 offen
L_hookj_36:
    v_exp_f32 v128, v128
    v_exp_f32 v129, v129
    v_exp_f32 v130, v130
    v_exp_f32 v131, v131
    v_exp_f32 v132, v132
    v_exp_f32 v133, v133
    v_exp_f32 v134, v134
    v_exp_f32 v135, v135
    v_add_f32 v10, v128, v129
    v_add_f32 v11, v130, v131
    v_cvt_pk_bf16_f32 v128, v128, v129
    v_cvt_pk_bf16_f32 v129, v130, v131
    v_exp_f32 v136, v136
    v_exp_f32 v137, v137
    v_exp_f32 v138, v138
    v_exp_f32 v139, v139
    v_add_f32 v10, v10, v132
    v_add_f32 v11, v11, v133
    v_add_f32 v10, v10, v134
    v_add_f32 v11, v11, v135
    v_cvt_pk_bf16_f32 v130, v132, v133
    v_cvt_pk_bf16_f32 v131, v134, v135
    v_exp_f32 v140, v140
    v_exp_f32 v141, v141
    v_exp_f32 v142, v142
    v_exp_f32 v143, v143
    v_add_f32 v10, v10, v136
    v_add_f32 v11, v11, v137
    v_add_f32 v10, v10, v138
    v_add_f32 v11, v11, v139
    v_cvt_pk_bf16_f32 v132, v136, v137
    v_cvt_pk_bf16_f32 v133, v138, v139
    v_exp_f32 v144, v144
    v_exp_f32 v145, v145
    v_exp_f32 v146, v146
    v_exp_f32 v147, v147
    v_add_f32 v10, v10, v140
    v_add_f32 v11, v11, v141
    v_add_f32 v10, v10, v142
    v_add_f32 v11, v11, v143
    v_cvt_pk_bf16_f32 v134, v140, v141
    v_cvt_pk_bf16_f32 v135, v142, v143
    v_exp_f32 v148, v148
    v_exp_f32 v149, v149
    v_exp_f32 v150, v150
    v_exp_f32 v151, v151
    v_add_f32 v10, v10, v144
    v_add_f32 v11, v11, v145
    v_add_f32 v10, v10, v146
    v_add_f32 v11, v11, v147
    v_cvt_pk_bf16_f32 v136, v144, v145
    v_cvt_pk_bf16_f32 v137, v146, v147
    s_nop 0
    v_add_f32 v10, v10, v148
    v_add_f32 v11, v11, v149
    v_add_f32 v10, v10, v150
    v_add_f32 v11, v11, v151
    v_cvt_pk_bf16_f32 v138, v148, v149
    v_cvt_pk_bf16_f32 v139, v150, v151
    s_nop 1
    s_waitcnt lgkmcnt(10)
    v_mfma_f32_32x32x16_bf16 v[64:79], v[216:219], v[128:131], v[64:79]
    ds_read_b64_tr_b16 v[216:217], v24 offset:4096
    ds_read_b64_tr_b16 v[218:219], v24 offset:6144
    v_exp_f32 v152, v152
    v_exp_f32 v153, v153
    v_exp_f32 v154, v154
    s_waitcnt lgkmcnt(10)
    v_mfma_f32_32x32x16_bf16 v[80:95], v[220:223], v[128:131], v[80:95]
    ds_read_b64_tr_b16 v[220:221], v25 offset:4096
    ds_read_b64_tr_b16 v[222:223], v25 offset:6144
    v_exp_f32 v155, v155
    v_exp_f32 v156, v156
    v_exp_f32 v157, v157
    s_waitcnt lgkmcnt(10)
    v_mfma_f32_32x32x16_bf16 v[96:111], v[224:227], v[128:131], v[96:111]
    ds_read_b64_tr_b16 v[224:225], v22 offset:8192
    ds_read_b64_tr_b16 v[226:227], v22 offset:10240
    v_exp_f32 v158, v158
    v_exp_f32 v159, v159
    v_add_f32 v10, v10, v152
    s_waitcnt lgkmcnt(10)
    v_mfma_f32_32x32x16_bf16 v[112:127], v[228:231], v[128:131], v[112:127]
    ds_read_b64_tr_b16 v[228:229], v23 offset:8192
    ds_read_b64_tr_b16 v[230:231], v23 offset:10240
    v_add_f32 v11, v11, v153
    v_add_f32 v10, v10, v154
    v_add_f32 v11, v11, v155
    s_waitcnt lgkmcnt(10)
    v_mfma_f32_32x32x16_bf16 v[64:79], v[232:235], v[132:135], v[64:79]
    ds_read_b64_tr_b16 v[232:233], v24 offset:8192
    ds_read_b64_tr_b16 v[234:235], v24 offset:10240
    v_cvt_pk_bf16_f32 v140, v152, v153
    v_cvt_pk_bf16_f32 v141, v154, v155
    s_nop 0
    s_waitcnt lgkmcnt(10)
    v_mfma_f32_32x32x16_bf16 v[80:95], v[236:239], v[132:135], v[80:95]
    ds_read_b64_tr_b16 v[236:237], v25 offset:8192
    ds_read_b64_tr_b16 v[238:239], v25 offset:10240
    v_add_f32 v10, v10, v156
    v_add_f32 v11, v11, v157
    v_add_f32 v10, v10, v158
    s_waitcnt lgkmcnt(10)
    v_mfma_f32_32x32x16_bf16 v[96:111], v[216:219], v[132:135], v[96:111]
    ds_read_b64_tr_b16 v[216:217], v22 offset:12288
    ds_read_b64_tr_b16 v[218:219], v22 offset:14336
    v_add_f32 v11, v11, v159
    v_cvt_pk_bf16_f32 v142, v156, v157
    v_cvt_pk_bf16_f32 v143, v158, v159
    s_waitcnt lgkmcnt(10)
    v_mfma_f32_32x32x16_bf16 v[112:127], v[220:223], v[132:135], v[112:127]
    ds_read_b64_tr_b16 v[220:221], v23 offset:12288
    ds_read_b64_tr_b16 v[222:223], v23 offset:14336
    v_add_f32 v27, v27, v10
    v_add_f32 v27, v27, v11
    s_waitcnt lgkmcnt(10)
    v_mfma_f32_32x32x16_bf16 v[64:79], v[224:227], v[136:139], v[64:79]
    ds_read_b64_tr_b16 v[224:225], v24 offset:12288
    ds_read_b64_tr_b16 v[226:227], v24 offset:14336
    s_waitcnt lgkmcnt(10)
    v_mfma_f32_32x32x16_bf16 v[80:95], v[228:231], v[136:139], v[80:95]
    ds_read_b64_tr_b16 v[228:229], v25 offset:12288
    ds_read_b64_tr_b16 v[230:231], v25 offset:14336
    s_waitcnt lgkmcnt(10)
    v_mfma_f32_32x32x16_bf16 v[96:111], v[232:235], v[136:139], v[96:111]
    s_waitcnt lgkmcnt(8)
    v_mfma_f32_32x32x16_bf16 v[112:127], v[236:239], v[136:139], v[112:127]
    s_nop 1
    s_waitcnt lgkmcnt(6)
    v_mfma_f32_32x32x16_bf16 v[64:79], v[216:219], v[140:143], v[64:79]
    s_waitcnt lgkmcnt(4)
    v_mfma_f32_32x32x16_bf16 v[80:95], v[220:223], v[140:143], v[80:95]
    s_waitcnt lgkmcnt(2)
    v_mfma_f32_32x32x16_bf16 v[96:111], v[224:227], v[140:143], v[96:111]
    s_waitcnt lgkmcnt(0)
    v_mfma_f32_32x32x16_bf16 v[112:127], v[228:231], v[140:143], v[112:127]
    s_branch L_adone_14
L_tail0_10:
    ds_read_b64_tr_b16 v[216:217], v22 offset:32768
    ds_read_b64_tr_b16 v[218:219], v22 offset:34816
    ds_read_b64_tr_b16 v[220:221], v23 offset:32768
    ds_read_b64_tr_b16 v[222:223], v23 offset:34816
    ds_read_b64_tr_b16 v[224:225], v24 offset:32768
    ds_read_b64_tr_b16 v[226:227], v24 offset:34816
    ds_read_b64_tr_b16 v[228:229], v25 offset:32768
    ds_read_b64_tr_b16 v[230:231], v25 offset:34816
    ds_read_b64_tr_b16 v[232:233], v22 offset:36864
    ds_read_b64_tr_b16 v[234:235], v22 offset:38912
    ds_read_b64_tr_b16 v[236:237], v23 offset:36864
    ds_read_b64_tr_b16 v[238:239], v23 offset:38912
    s_cmp_lg_u32 s43, 0
    s_cbranch_scc1 L_nonext_37
    s_lshl_b32 s39, s34, 14
    s_add_u32 s39, s39, s36
    s_lshl_b32 s30, s35, 10
    s_add_u32 s39, s39, s30
    s_mov_b32 s52, s39
    s_add_u32 m0, s42, 0
    s_nop 0
    buffer_load_dwordx4 v12, s[8:11], s39 offen lds
    s_add_u32 m0, s42, 4096
    s_add_u32 s30, s39, 4096
    buffer_load_dwordx4 v12, s[8:11], s30 offen lds
    s_add_u32 m0, s42, 8192
    s_add_u32 s30, s39, 8192
    buffer_load_dwordx4 v12, s[8:11], s30 offen lds
    s_add_u32 m0, s42, 12288
    s_add_u32 s30, s39, 12288
    buffer_load_dwordx4 v12, s[8:11], s30 offen lds
    s_add_u32 s39, s39, 32768
    s_lshl_b32 s30, s34, 16
    s_lshl_b32 s31, s35, 13
    s_sub_u32 s30, s31, s30
    s_add_u32 s30, s30, 131072
    v_add_u32 v9, s30, v14
    ds_read_b128 v[32:35], v9
    v_add_u32 v9, s30, v15
    ds_read_b128 v[36:39], v9
    v_add_u32 v9, s30, v16
    ds_read_b128 v[40:43], v9
    v_add_u32 v9, s30, v17
    ds_read_b128 v[44:47], v9
    v_add_u32 v9, s30, v18
    ds_read_b128 v[48:51], v9
    v_add_u32 v9, s30, v19
    ds_read_b128 v[52:55], v9
    v_add_u32 v9, s30, v20
    ds_read_b128 v[56:59], v9
    v_add_u32 v9, s30, v21
    ds_read_b128 v[60:63], v9
    s_waitcnt lgkmcnt(0)
    s_branch L_hookj_38
L_nonext_37:
    v_lshlrev_b32 v63, 4, v1
    s_mov_b32 s76, s66
    s_mov_b32 s77, s67
    s_mov_b32 s78, 4194304
    s_mov_b32 s79, 0x00020000
    buffer_load_dwordx4 v[32:35], v63, s[76:79], s74 offen
    buffer_load_dwordx4 v[36:39], v63, s[76:79], s74 offen offset:1024
    s_mov_b32 s76, s68
    s_mov_b32 s77, s69
    s_mov_b32 s78, 1835008
    s_mov_b32 s79, 0x00020000
    buffer_load_dwordx4 v[40:43], v63, s[76:79], s75 offen
    s_mov_b32 s76, s70
    s_mov_b32 s77, s71
    s_mov_b32 s78, 1835008
    s_mov_b32 s79, 0x00020000
    buffer_load_dwordx4 v[44:47], v63, s[76:79], s75 offen
    s_mov_b32 s76, s72
    s_mov_b32 s77, s73
    s_mov_b32 s78, 1835008
    s_mov_b32 s79, 0x00020000
    buffer_load_dwordx4 v[48:51], v63, s[76:79], s75 offen
L_hookj_38:
    v_exp_f32 v160, v160
    v_exp_f32 v161, v161
    v_exp_f32 v162, v162
    v_exp_f32 v163, v163
    v_exp_f32 v164, v164
    v_exp_f32 v165, v165
    v_exp_f32 v166, v166
    v_exp_f32 v167, v167
    v_add_f32 v10, v160, v161
    v_add_f32 v11, v162, v163
    v_cvt_pk_bf16_f32 v160, v160, v161
    v_cvt_pk_bf16_f32 v161, v162, v163
    v_exp_f32 v168, v168
    v_exp_f32 v169, v169
    v_exp_f32 v170, v170
    v_exp_f32 v171, v171
    v_add_f32 v10, v10, v164
    v_add_f32 v11, v11, v165
    v_add_f32 v10, v10, v166
    v_add_f32 v11, v11, v167
    v_cvt_pk_bf16_f32 v162, v164, v165
    v_cvt_pk_bf16_f32 v163, v166, v167
    v_exp_f32 v172, v172
    v_exp_f32 v173, v173
    v_exp_f32 v174, v174
    v_exp_f32 v175, v175
    v_add_f32 v10, v10, v168
    v_add_f32 v11, v11, v169
    v_add_f32 v10, v10, v170
    v_add_f32 v11, v11, v171
    v_cvt_pk_bf16_f32 v164, v168, v169
    v_cvt_pk_bf16_f32 v165, v170, v171
    v_exp_f32 v176, v176
    v_exp_f32 v177, v177
    v_exp_f32 v178, v178
    v_exp_f32 v179, v179
    v_add_f32 v10, v10, v172
    v_add_f32 v11, v11, v173
    v_add_f32 v10, v10, v174
    v_add_f32 v11, v11, v175
    v_cvt_pk_bf16_f32 v166, v172, v173
    v_cvt_pk_bf16_f32 v167, v174, v175
    v_exp_f32 v180, v180
    v_exp_f32 v181, v181
    v_exp_f32 v182, v182
    v_exp_f32 v183, v183
    v_add_f32 v10, v10, v176
    v_add_f32 v11, v11, v177
    v_add_f32 v10, v10, v178
    v_add_f32 v11, v11, v179
    v_cvt_pk_bf16_f32 v168, v176, v177
    v_cvt_pk_bf16_f32 v169, v178, v179
    s_nop 0
    v_add_f32 v10, v10, v180
    v_add_f32 v11, v11, v181
    v_add_f32 v10, v10, v182
    v_add_f32 v11, v11, v183
    v_cvt_pk_bf16_f32 v170, v180, v181
    v_cvt_pk_bf16_f32 v171, v182, v183
    s_nop 1
    s_waitcnt lgkmcnt(10)
    v_mfma_f32_32x32x16_bf16 v[64:79], v[216:219], v[160:163], v[64:79]
    ds_read_b64_tr_b16 v[216:217], v24 offset:36864
    ds_read_b64_tr_b16 v[218:219], v24 offset:38912
    v_exp_f32 v184, v184
    v_exp_f32 v185, v185
    v_exp_f32 v186, v186
    s_waitcnt lgkmcnt(10)
    v_mfma_f32_32x32x16_bf16 v[80:95], v[220:223], v[160:163], v[80:95]
    ds_read_b64_tr_b16 v[220:221], v25 offset:36864
    ds_read_b64_tr_b16 v[222:223], v25 offset:38912
    v_exp_f32 v187, v187
    v_exp_f32 v188, v188
    v_exp_f32 v189, v189
    s_waitcnt lgkmcnt(10)
    v_mfma_f32_32x32x16_bf16 v[96:111], v[224:227], v[160:163], v[96:111]
    ds_read_b64_tr_b16 v[224:225], v22 offset:40960
    ds_read_b64_tr_b16 v[226:227], v22 offset:43008
    v_exp_f32 v190, v190
    v_exp_f32 v191, v191
    v_add_f32 v10, v10, v184
    s_waitcnt lgkmcnt(10)
    v_mfma_f32_32x32x16_bf16 v[112:127], v[228:231], v[160:163], v[112:127]
    ds_read_b64_tr_b16 v[228:229], v23 offset:40960
    ds_read_b64_tr_b16 v[230:231], v23 offset:43008
    v_add_f32 v11, v11, v185
    v_add_f32 v10, v10, v186
    v_add_f32 v11, v11, v187
    s_waitcnt lgkmcnt(10)
    v_mfma_f32_32x32x16_bf16 v[64:79], v[232:235], v[164:167], v[64:79]
    ds_read_b64_tr_b16 v[232:233], v24 offset:40960
    ds_read_b64_tr_b16 v[234:235], v24 offset:43008
    v_cvt_pk_bf16_f32 v172, v184, v185
    v_cvt_pk_bf16_f32 v173, v186, v187
    s_nop 0
    s_waitcnt lgkmcnt(10)
    v_mfma_f32_32x32x16_bf16 v[80:95], v[236:239], v[164:167], v[80:95]
    ds_read_b64_tr_b16 v[236:237], v25 offset:40960
    ds_read_b64_tr_b16 v[238:239], v25 offset:43008
    v_add_f32 v10, v10, v188
    v_add_f32 v11, v11, v189
    v_add_f32 v10, v10, v190
    s_waitcnt lgkmcnt(10)
    v_mfma_f32_32x32x16_bf16 v[96:111], v[216:219], v[164:167], v[96:111]
    ds_read_b64_tr_b16 v[216:217], v22 offset:45056
    ds_read_b64_tr_b16 v[218:219], v22 offset:47104
    v_add_f32 v11, v11, v191
    v_cvt_pk_bf16_f32 v174, v188, v189
    v_cvt_pk_bf16_f32 v175, v190, v191
    s_waitcnt lgkmcnt(10)
    v_mfma_f32_32x32x16_bf16 v[112:127], v[220:223], v[164:167], v[112:127]
    ds_read_b64_tr_b16 v[220:221], v23 offset:45056
    ds_read_b64_tr_b16 v[222:223], v23 offset:47104
    v_add_f32 v27, v27, v10
    v_add_f32 v27, v27, v11
    s_waitcnt lgkmcnt(10)
    v_mfma_f32_32x32x16_bf16 v[64:79], v[224:227], v[168:171], v[64:79]
    ds_read_b64_tr_b16 v[224:225], v24 offset:45056
    ds_read_b64_tr_b16 v[226:227], v24 offset:47104
    s_waitcnt lgkmcnt(10)
    v_mfma_f32_32x32x16_bf16 v[80:95], v[228:231], v[168:171], v[80:95]
    ds_read_b64_tr_b16 v[228:229], v25 offset:45056
    ds_read_b64_tr_b16 v[230:231], v25 offset:47104
    s_waitcnt lgkmcnt(10)
    v_mfma_f32_32x32x16_bf16 v[96:111], v[232:235], v[168:171], v[96:111]
    s_waitcnt lgkmcnt(8)
    v_mfma_f32_32x32x16_bf16 v[112:127], v[236:239], v[168:171], v[112:127]
    s_nop 1
    s_waitcnt lgkmcnt(6)
    v_mfma_f32_32x32x16_bf16 v[64:79], v[216:219], v[172:175], v[64:79]
    s_waitcnt lgkmcnt(4)
    v_mfma_f32_32x32x16_bf16 v[80:95], v[220:223], v[172:175], v[80:95]
    s_waitcnt lgkmcnt(2)
    v_mfma_f32_32x32x16_bf16 v[96:111], v[224:227], v[172:175], v[96:111]
    s_waitcnt lgkmcnt(0)
    v_mfma_f32_32x32x16_bf16 v[112:127], v[228:231], v[172:175], v[112:127]
L_adone_14:
    s_barrier
    v_mov_b32 v2, v27
    s_nop 1
    v_permlane32_swap_b32 v2, v27
    v_add_f32 v27, v27, v2
    v_lshlrev_b32 v2, 4, v1
    v_add_u32 v3, s53, v2
    v_add_u32 v4, s63, v2
    v_lshlrev_b32 v2, 2, v1
    v_add_u32 v5, s53, v2
    v_add_u32 v6, s63, v2
    v_and_b32 v9, 31, v1
    v_mul_u32_u24 v9, 8192, v9
    v_lshrrev_b32 v10, 5, v1
    v_lshl_add_u32 v10, v10, 4, v9
    s_lshl_b32 s30, s37, 7
    s_lshl_b32 s31, s35, 5
    s_add_u32 s30, s30, s31
    s_mul_i32 s30, s30, 8192
    s_add_u32 s30, s30, s22
    s_lshl_b32 s31, s34, 7
    s_add_u32 s65, s30, s31
    s_cmp_eq_u32 s34, 1
    s_cbranch_scc1 L_g1_39
    ds_write_b128 v3, v[96:99] offset:0
    ds_write_b128 v3, v[100:103] offset:1024
    ds_write_b128 v3, v[104:107] offset:2048
    ds_write_b128 v3, v[108:111] offset:3072
    ds_write_b128 v3, v[112:115] offset:4096
    ds_write_b128 v3, v[116:119] offset:5120
    ds_write_b128 v3, v[120:123] offset:6144
    ds_write_b128 v3, v[124:127] offset:7168
    ds_write_b32 v5, v26 offset:8192
    ds_write_b32 v5, v27 offset:8448
    s_waitcnt lgkmcnt(0)
    s_barrier
    ds_read_b32 v7, v6 offset:8192
    ds_read_b32 v8, v6 offset:8448
    ds_read_b128 v[192:195], v4 offset:0
    ds_read_b128 v[196:199], v4 offset:1024
    ds_read_b128 v[200:203], v4 offset:2048
    ds_read_b128 v[204:207], v4 offset:3072
    ds_read_b128 v[208:211], v4 offset:4096
    ds_read_b128 v[212:215], v4 offset:5120
    ds_read_b128 v[216:219], v4 offset:6144
    ds_read_b128 v[220:223], v4 offset:7168
    s_waitcnt lgkmcnt(8)
    v_max_f32 v2, v26, v7
    v_sub_f32 v3, v26, v2
    v_sub_f32 v4, v7, v2
    v_exp_f32 v3, v3
    v_exp_f32 v4, v4
    s_nop 0
    v_mul_f32 v5, v3, v27
    v_fmac_f32 v5, v4, v8
    v_rcp_f32 v5, v5
    s_nop 0
    v_mul_f32 v3, v3, v5
    v_mul_f32 v4, v4, v5
    s_waitcnt lgkmcnt(6)
    v_mul_f32 v64, v64, v3
    v_fmac_f32 v64, v192, v4
    v_mul_f32 v65, v65, v3
    v_fmac_f32 v65, v193, v4
    v_mul_f32 v66, v66, v3
    v_fmac_f32 v66, v194, v4
    v_mul_f32 v67, v67, v3
    v_fmac_f32 v67, v195, v4
    v_mul_f32 v68, v68, v3
    v_fmac_f32 v68, v196, v4
    v_mul_f32 v69, v69, v3
    v_fmac_f32 v69, v197, v4
    v_mul_f32 v70, v70, v3
    v_fmac_f32 v70, v198, v4
    v_mul_f32 v71, v71, v3
    v_fmac_f32 v71, v199, v4
    s_waitcnt lgkmcnt(4)
    v_mul_f32 v72, v72, v3
    v_fmac_f32 v72, v200, v4
    v_mul_f32 v73, v73, v3
    v_fmac_f32 v73, v201, v4
    v_mul_f32 v74, v74, v3
    v_fmac_f32 v74, v202, v4
    v_mul_f32 v75, v75, v3
    v_fmac_f32 v75, v203, v4
    v_mul_f32 v76, v76, v3
    v_fmac_f32 v76, v204, v4
    v_mul_f32 v77, v77, v3
    v_fmac_f32 v77, v205, v4
    v_mul_f32 v78, v78, v3
    v_fmac_f32 v78, v206, v4
    v_mul_f32 v79, v79, v3
    v_fmac_f32 v79, v207, v4
    s_waitcnt lgkmcnt(2)
    v_mul_f32 v80, v80, v3
    v_fmac_f32 v80, v208, v4
    v_mul_f32 v81, v81, v3
    v_fmac_f32 v81, v209, v4
    v_mul_f32 v82, v82, v3
    v_fmac_f32 v82, v210, v4
    v_mul_f32 v83, v83, v3
    v_fmac_f32 v83, v211, v4
    v_mul_f32 v84, v84, v3
    v_fmac_f32 v84, v212, v4
    v_mul_f32 v85, v85, v3
    v_fmac_f32 v85, v213, v4
    v_mul_f32 v86, v86, v3
    v_fmac_f32 v86, v214, v4
    v_mul_f32 v87, v87, v3
    v_fmac_f32 v87, v215, v4
    s_waitcnt lgkmcnt(0)
    v_mul_f32 v88, v88, v3
    v_fmac_f32 v88, v216, v4
    v_mul_f32 v89, v89, v3
    v_fmac_f32 v89, v217, v4
    v_mul_f32 v90, v90, v3
    v_fmac_f32 v90, v218, v4
    v_mul_f32 v91, v91, v3
    v_fmac_f32 v91, v219, v4
    v_mul_f32 v92, v92, v3
    v_fmac_f32 v92, v220, v4
    v_mul_f32 v93, v93, v3
    v_fmac_f32 v93, v221, v4
    v_mul_f32 v94, v94, v3
    v_fmac_f32 v94, v222, v4
    v_mul_f32 v95, v95, v3
    v_fmac_f32 v95, v223, v4
    s_barrier
    v_and_b32 v2, 31, v1
    v_lshlrev_b32 v3, 7, v2
    v_lshrrev_b32 v4, 5, v1
    v_lshl_add_u32 v3, v4, 3, v3
    v_add_u32 v3, s53, v3
    v_bfe_u32 v4, v2, 1, 3
    v_lshlrev_b32 v4, 4, v4
    v_xor_b32 v5, 0, v4
    v_add_u32 v5, v5, v3
    v_cvt_pk_bf16_f32 v160, v64, v65
    v_cvt_pk_bf16_f32 v161, v66, v67
    ds_write_b64 v5, v[160:161] offset:0
    v_xor_b32 v5, 16, v4
    v_add_u32 v5, v5, v3
    v_cvt_pk_bf16_f32 v162, v68, v69
    v_cvt_pk_bf16_f32 v163, v70, v71
    ds_write_b64 v5, v[162:163] offset:0
    v_xor_b32 v5, 32, v4
    v_add_u32 v5, v5, v3
    v_cvt_pk_bf16_f32 v164, v72, v73
    v_cvt_pk_bf16_f32 v165, v74, v75
    ds_write_b64 v5, v[164:165] offset:0
    v_xor_b32 v5, 48, v4
    v_add_u32 v5, v5, v3
    v_cvt_pk_bf16_f32 v166, v76, v77
    v_cvt_pk_bf16_f32 v167, v78, v79
    ds_write_b64 v5, v[166:167] offset:0
    v_xor_b32 v5, 64, v4
    v_add_u32 v5, v5, v3
    v_cvt_pk_bf16_f32 v168, v80, v81
    v_cvt_pk_bf16_f32 v169, v82, v83
    ds_write_b64 v5, v[168:169] offset:0
    v_xor_b32 v5, 80, v4
    v_add_u32 v5, v5, v3
    v_cvt_pk_bf16_f32 v170, v84, v85
    v_cvt_pk_bf16_f32 v171, v86, v87
    ds_write_b64 v5, v[170:171] offset:0
    v_xor_b32 v5, 96, v4
    v_add_u32 v5, v5, v3
    v_cvt_pk_bf16_f32 v172, v88, v89
    v_cvt_pk_bf16_f32 v173, v90, v91
    ds_write_b64 v5, v[172:173] offset:0
    v_xor_b32 v5, 112, v4
    v_add_u32 v5, v5, v3
    v_cvt_pk_bf16_f32 v174, v92, v93
    v_cvt_pk_bf16_f32 v175, v94, v95
    ds_write_b64 v5, v[174:175] offset:0
    v_lshrrev_b32 v2, 3, v1
    v_lshlrev_b32 v2, 7, v2
    v_add_u32 v2, s53, v2
    v_and_b32 v3, 7, v1
    v_lshrrev_b32 v4, 4, v1
    v_xor_b32 v3, v3, v4
    v_lshlrev_b32 v3, 4, v3
    v_xor_b32 v4, 0, v3
    v_add_u32 v128, v4, v2
    v_xor_b32 v4, 64, v3
    v_add_u32 v129, v4, v2
    v_lshrrev_b32 v2, 3, v1
    v_mul_u32_u24 v2, 8192, v2
    v_and_b32 v3, 7, v1
    v_lshl_add_u32 v10, v3, 4, v2
    s_waitcnt lgkmcnt(0)
    ds_read_b128 v[192:195], v128 offset:0
    ds_read_b128 v[196:199], v129 offset:1024
    ds_read_b128 v[200:203], v128 offset:2048
    ds_read_b128 v[204:207], v129 offset:3072
    s_waitcnt lgkmcnt(3)
    s_add_u32 s31, s65, 0
    buffer_store_dwordx4 v[192:195], v10, s[16:19], s31 offen
    s_waitcnt lgkmcnt(2)
    s_add_u32 s31, s65, 65536
    buffer_store_dwordx4 v[196:199], v10, s[16:19], s31 offen
    s_waitcnt lgkmcnt(1)
    s_add_u32 s31, s65, 131072
    buffer_store_dwordx4 v[200:203], v10, s[16:19], s31 offen
    s_waitcnt lgkmcnt(0)
    s_add_u32 s31, s65, 196608
    buffer_store_dwordx4 v[204:207], v10, s[16:19], s31 offen
    s_branch L_gj_40
L_g1_39:
    ds_write_b128 v3, v[64:67] offset:0
    ds_write_b128 v3, v[68:71] offset:1024
    ds_write_b128 v3, v[72:75] offset:2048
    ds_write_b128 v3, v[76:79] offset:3072
    ds_write_b128 v3, v[80:83] offset:4096
    ds_write_b128 v3, v[84:87] offset:5120
    ds_write_b128 v3, v[88:91] offset:6144
    ds_write_b128 v3, v[92:95] offset:7168
    ds_write_b32 v5, v26 offset:8192
    ds_write_b32 v5, v27 offset:8448
    s_waitcnt lgkmcnt(0)
    s_barrier
    ds_read_b32 v7, v6 offset:8192
    ds_read_b32 v8, v6 offset:8448
    ds_read_b128 v[192:195], v4 offset:0
    ds_read_b128 v[196:199], v4 offset:1024
    ds_read_b128 v[200:203], v4 offset:2048
    ds_read_b128 v[204:207], v4 offset:3072
    ds_read_b128 v[208:211], v4 offset:4096
    ds_read_b128 v[212:215], v4 offset:5120
    ds_read_b128 v[216:219], v4 offset:6144
    ds_read_b128 v[220:223], v4 offset:7168
    s_waitcnt lgkmcnt(8)
    v_max_f32 v2, v26, v7
    v_sub_f32 v3, v26, v2
    v_sub_f32 v4, v7, v2
    v_exp_f32 v3, v3
    v_exp_f32 v4, v4
    s_nop 0
    v_mul_f32 v5, v3, v27
    v_fmac_f32 v5, v4, v8
    v_rcp_f32 v5, v5
    s_nop 0
    v_mul_f32 v3, v3, v5
    v_mul_f32 v4, v4, v5
    s_waitcnt lgkmcnt(6)
    v_mul_f32 v96, v96, v3
    v_fmac_f32 v96, v192, v4
    v_mul_f32 v97, v97, v3
    v_fmac_f32 v97, v193, v4
    v_mul_f32 v98, v98, v3
    v_fmac_f32 v98, v194, v4
    v_mul_f32 v99, v99, v3
    v_fmac_f32 v99, v195, v4
    v_mul_f32 v100, v100, v3
    v_fmac_f32 v100, v196, v4
    v_mul_f32 v101, v101, v3
    v_fmac_f32 v101, v197, v4
    v_mul_f32 v102, v102, v3
    v_fmac_f32 v102, v198, v4
    v_mul_f32 v103, v103, v3
    v_fmac_f32 v103, v199, v4
    s_waitcnt lgkmcnt(4)
    v_mul_f32 v104, v104, v3
    v_fmac_f32 v104, v200, v4
    v_mul_f32 v105, v105, v3
    v_fmac_f32 v105, v201, v4
    v_mul_f32 v106, v106, v3
    v_fmac_f32 v106, v202, v4
    v_mul_f32 v107, v107, v3
    v_fmac_f32 v107, v203, v4
    v_mul_f32 v108, v108, v3
    v_fmac_f32 v108, v204, v4
    v_mul_f32 v109, v109, v3
    v_fmac_f32 v109, v205, v4
    v_mul_f32 v110, v110, v3
    v_fmac_f32 v110, v206, v4
    v_mul_f32 v111, v111, v3
    v_fmac_f32 v111, v207, v4
    s_waitcnt lgkmcnt(2)
    v_mul_f32 v112, v112, v3
    v_fmac_f32 v112, v208, v4
    v_mul_f32 v113, v113, v3
    v_fmac_f32 v113, v209, v4
    v_mul_f32 v114, v114, v3
    v_fmac_f32 v114, v210, v4
    v_mul_f32 v115, v115, v3
    v_fmac_f32 v115, v211, v4
    v_mul_f32 v116, v116, v3
    v_fmac_f32 v116, v212, v4
    v_mul_f32 v117, v117, v3
    v_fmac_f32 v117, v213, v4
    v_mul_f32 v118, v118, v3
    v_fmac_f32 v118, v214, v4
    v_mul_f32 v119, v119, v3
    v_fmac_f32 v119, v215, v4
    s_waitcnt lgkmcnt(0)
    v_mul_f32 v120, v120, v3
    v_fmac_f32 v120, v216, v4
    v_mul_f32 v121, v121, v3
    v_fmac_f32 v121, v217, v4
    v_mul_f32 v122, v122, v3
    v_fmac_f32 v122, v218, v4
    v_mul_f32 v123, v123, v3
    v_fmac_f32 v123, v219, v4
    v_mul_f32 v124, v124, v3
    v_fmac_f32 v124, v220, v4
    v_mul_f32 v125, v125, v3
    v_fmac_f32 v125, v221, v4
    v_mul_f32 v126, v126, v3
    v_fmac_f32 v126, v222, v4
    v_mul_f32 v127, v127, v3
    v_fmac_f32 v127, v223, v4
    s_barrier
    v_and_b32 v2, 31, v1
    v_lshlrev_b32 v3, 7, v2
    v_lshrrev_b32 v4, 5, v1
    v_lshl_add_u32 v3, v4, 3, v3
    v_add_u32 v3, s53, v3
    v_bfe_u32 v4, v2, 1, 3
    v_lshlrev_b32 v4, 4, v4
    v_xor_b32 v5, 0, v4
    v_add_u32 v5, v5, v3
    v_cvt_pk_bf16_f32 v160, v96, v97
    v_cvt_pk_bf16_f32 v161, v98, v99
    ds_write_b64 v5, v[160:161] offset:0
    v_xor_b32 v5, 16, v4
    v_add_u32 v5, v5, v3
    v_cvt_pk_bf16_f32 v162, v100, v101
    v_cvt_pk_bf16_f32 v163, v102, v103
    ds_write_b64 v5, v[162:163] offset:0
    v_xor_b32 v5, 32, v4
    v_add_u32 v5, v5, v3
    v_cvt_pk_bf16_f32 v164, v104, v105
    v_cvt_pk_bf16_f32 v165, v106, v107
    ds_write_b64 v5, v[164:165] offset:0
    v_xor_b32 v5, 48, v4
    v_add_u32 v5, v5, v3
    v_cvt_pk_bf16_f32 v166, v108, v109
    v_cvt_pk_bf16_f32 v167, v110, v111
    ds_write_b64 v5, v[166:167] offset:0
    v_xor_b32 v5, 64, v4
    v_add_u32 v5, v5, v3
    v_cvt_pk_bf16_f32 v168, v112, v113
    v_cvt_pk_bf16_f32 v169, v114, v115
    ds_write_b64 v5, v[168:169] offset:0
    v_xor_b32 v5, 80, v4
    v_add_u32 v5, v5, v3
    v_cvt_pk_bf16_f32 v170, v116, v117
    v_cvt_pk_bf16_f32 v171, v118, v119
    ds_write_b64 v5, v[170:171] offset:0
    v_xor_b32 v5, 96, v4
    v_add_u32 v5, v5, v3
    v_cvt_pk_bf16_f32 v172, v120, v121
    v_cvt_pk_bf16_f32 v173, v122, v123
    ds_write_b64 v5, v[172:173] offset:0
    v_xor_b32 v5, 112, v4
    v_add_u32 v5, v5, v3
    v_cvt_pk_bf16_f32 v174, v124, v125
    v_cvt_pk_bf16_f32 v175, v126, v127
    ds_write_b64 v5, v[174:175] offset:0
    v_lshrrev_b32 v2, 3, v1
    v_lshlrev_b32 v2, 7, v2
    v_add_u32 v2, s53, v2
    v_and_b32 v3, 7, v1
    v_lshrrev_b32 v4, 4, v1
    v_xor_b32 v3, v3, v4
    v_lshlrev_b32 v3, 4, v3
    v_xor_b32 v4, 0, v3
    v_add_u32 v128, v4, v2
    v_xor_b32 v4, 64, v3
    v_add_u32 v129, v4, v2
    v_lshrrev_b32 v2, 3, v1
    v_mul_u32_u24 v2, 8192, v2
    v_and_b32 v3, 7, v1
    v_lshl_add_u32 v10, v3, 4, v2
    s_waitcnt lgkmcnt(0)
    ds_read_b128 v[192:195], v128 offset:0
    ds_read_b128 v[196:199], v129 offset:1024
    ds_read_b128 v[200:203], v128 offset:2048
    ds_read_b128 v[204:207], v129 offset:3072
    s_waitcnt lgkmcnt(3)
    s_add_u32 s31, s65, 0
    buffer_store_dwordx4 v[192:195], v10, s[16:19], s31 offen
    s_waitcnt lgkmcnt(2)
    s_add_u32 s31, s65, 65536
    buffer_store_dwordx4 v[196:199], v10, s[16:19], s31 offen
    s_waitcnt lgkmcnt(1)
    s_add_u32 s31, s65, 131072
    buffer_store_dwordx4 v[200:203], v10, s[16:19], s31 offen
    s_waitcnt lgkmcnt(0)
    s_add_u32 s31, s65, 196608
    buffer_store_dwordx4 v[204:207], v10, s[16:19], s31 offen
L_gj_40:
    s_add_u32 s43, s43, 1
    s_mov_b32 s37, s23
    s_cmp_lt_u32 s43, 2
    s_cbranch_scc1 L_phase_3
L_end_2:
    s_endpgm
.globl oproj_kernel
.p2align 8
.type oproj_kernel,@function
oproj_kernel:
    s_cmp_ge_u32 s2, 256
    s_cbranch_scc1 L_end_41
    s_load_dwordx2 s[40:41], s[0:1], 40
    s_load_dwordx2 s[44:45], s[0:1], 96
    s_and_b32 s49, s2, 3
    s_bfe_u32 s46, s2, 0x10002
    s_lshl_b32 s46, s46, 3
    s_lshr_b32 s47, s2, 5
    s_add_u32 s46, s46, s47
    s_lshl_b32 s47, s46, 7
    s_bfe_u32 s48, s2, 0x20003
    s_lshl_b32 s48, s48, 7
    s_lshl_b32 s50, s49, 10
    s_waitcnt lgkmcnt(0)
    s_add_u32 s4, s44, 67108864
    s_addc_u32 s5, s45, 0
    s_mov_b32 s6, 16777216
    s_mov_b32 s7, 0x00020000
    s_mov_b32 s8, s40
    s_mov_b32 s9, s41
    s_mov_b32 s10, 4194304
    s_mov_b32 s11, 0x00020000
    s_add_u32 s16, s44, 88080384
    s_addc_u32 s17, s45, 0
    s_mov_b32 s18, 8388608
    s_mov_b32 s19, 0x00020000
    v_and_b32 v1, 63, v0
    v_lshrrev_b32 v2, 6, v0
    s_nop 0
    v_readfirstlane_b32 s24, v2
    s_nop 3
    s_lshl_b32 s29, s24, 10
    s_and_b32 s30, s24, 1
    s_and_b32 s32, s24, 1
    s_lshr_b32 s33, s24, 1
    s_lshl_b32 s31, s30, 2
    v_lshrrev_b32 v2, 4, v1
    v_add_u32 v2, s31, v2
    v_and_b32 v2, 7, v2
    v_and_b32 v3, 7, v1
    v_xor_b32 v2, v2, v3
    v_lshlrev_b32 v2, 4, v2
    v_lshrrev_b32 v3, 3, v1
    s_mov_b32 s31, 8192
    v_mul_lo_u32 v3, v3, s31
    v_add_u32 v10, v2, v3
    v_lshrrev_b32 v2, 4, v1
    v_and_b32 v3, 3, v2
    v_lshlrev_b32 v3, 2, v3
    v_and_b32 v4, 15, v1
    v_xor_b32 v3, v3, v4
    v_lshlrev_b32 v3, 4, v3
    s_mov_b32 s31, 1024
    v_mul_lo_u32 v2, v2, s31
    v_add_u32 v11, v2, v3
    s_mul_i32 s30, s24, 8
    s_add_u32 s30, s30, s47
    s_mul_i32 s25, s30, 8192
    s_lshl_b32 s30, s50, 1
    s_add_u32 s25, s25, s30
    s_mul_i32 s30, s24, 4
    s_add_u32 s30, s30, s50
    s_mul_i32 s26, s30, 1024
    s_lshl_b32 s30, s48, 1
    s_add_u32 s26, s26, s30
    s_add_u32 m0, s29, 0
    s_add_u32 s30, s25, 0
    buffer_load_dwordx4 v10, s[4:7], s30 offen lds
    s_add_u32 m0, s29, 8192
    s_add_u32 s30, s25, 524288
    buffer_load_dwordx4 v10, s[4:7], s30 offen lds
    s_add_u32 s25, s25, 128
    s_add_u32 m0, s29, 16384
    s_add_u32 s30, s26, 0
    buffer_load_dwordx4 v11, s[8:11], s30 offen lds
    s_add_u32 m0, s29, 24576
    s_add_u32 s30, s26, 32768
    buffer_load_dwordx4 v11, s[8:11], s30 offen lds
    s_add_u32 s26, s26, 65536
    s_add_u32 m0, s29, 32768
    s_add_u32 s30, s25, 0
    buffer_load_dwordx4 v10, s[4:7], s30 offen lds
    s_add_u32 m0, s29, 40960
    s_add_u32 s30, s25, 524288
    buffer_load_dwordx4 v10, s[4:7], s30 offen lds
    s_add_u32 s25, s25, 128
    s_add_u32 m0, s29, 49152
    s_add_u32 s30, s26, 0
    buffer_load_dwordx4 v11, s[8:11], s30 offen lds
    s_add_u32 m0, s29, 57344
    s_add_u32 s30, s26, 32768
    buffer_load_dwordx4 v11, s[8:11], s30 offen lds
    s_add_u32 s26, s26, 65536
    s_add_u32 m0, s29, 65536
    s_add_u32 s30, s25, 0
    buffer_load_dwordx4 v10, s[4:7], s30 offen lds
    s_add_u32 m0, s29, 73728
    s_add_u32 s30, s25, 524288
    buffer_load_dwordx4 v10, s[4:7], s30 offen lds
    s_add_u32 s25, s25, 128
    s_add_u32 m0, s29, 81920
    s_add_u32 s30, s26, 0
    buffer_load_dwordx4 v11, s[8:11], s30 offen lds
    s_add_u32 m0, s29, 90112
    s_add_u32 s30, s26, 32768
    buffer_load_dwordx4 v11, s[8:11], s30 offen lds
    s_add_u32 s26, s26, 65536
    s_add_u32 m0, s29, 98304
    s_add_u32 s30, s25, 0
    buffer_load_dwordx4 v10, s[4:7], s30 offen lds
    s_add_u32 m0, s29, 106496
    s_add_u32 s30, s25, 524288
    buffer_load_dwordx4 v10, s[4:7], s30 offen lds
    s_add_u32 s25, s25, 128
    s_add_u32 m0, s29, 114688
    s_add_u32 s30, s26, 0
    buffer_load_dwordx4 v11, s[8:11], s30 offen lds
    s_add_u32 m0, s29, 122880
    s_add_u32 s30, s26, 32768
    buffer_load_dwordx4 v11, s[8:11], s30 offen lds
    s_add_u32 s26, s26, 65536
    v_and_b32 v2, 31, v1
    s_mul_i32 s30, s32, 64
    v_add_u32 v2, s30, v2
    v_bfe_u32 v3, v2, 1, 3
    v_lshrrev_b32 v4, 5, v1
    v_xor_b32 v3, v3, v4
    v_lshlrev_b32 v2, 7, v2
    v_xor_b32 v5, 0, v3
    v_lshl_add_u32 v16, v5, 4, v2
    v_xor_b32 v5, 2, v3
    v_lshl_add_u32 v17, v5, 4, v2
    v_xor_b32 v5, 4, v3
    v_lshl_add_u32 v18, v5, 4, v2
    v_xor_b32 v5, 6, v3
    v_lshl_add_u32 v19, v5, 4, v2
    v_and_b32 v2, 15, v1
    v_lshrrev_b32 v3, 2, v2
    v_and_b32 v4, 3, v2
    v_lshrrev_b32 v5, 5, v1
    v_lshl_add_u32 v5, v5, 3, v3
    v_lshlrev_b32 v5, 8, v5
    v_and_b32 v6, 1, v4
    v_lshl_add_u32 v5, v6, 3, v5
    v_lshrrev_b32 v6, 1, v4
    v_bfe_u32 v7, v1, 4, 1
    v_lshl_add_u32 v6, v7, 1, v6
    v_lshl_add_u32 v5, v6, 4, v5
    s_mul_i32 s30, s33, 1
    s_add_u32 s30, s30, 0
    v_xor_b32 v6, s30, v3
    v_lshl_add_u32 v6, v6, 6, v5
    v_add_u32 v12, 16384, v6
    s_waitcnt vmcnt(12)
    s_barrier
    ds_read_b64_tr_b16 v[20:21], v12 offset:0
    ds_read_b64_tr_b16 v[22:23], v12 offset:1024
    ds_read_b128 v[28:31], v16 offset:0
    ds_read_b128 v[32:35], v16 offset:4096
    ds_read_b64_tr_b16 v[24:25], v12 offset:4096
    ds_read_b64_tr_b16 v[26:27], v12 offset:5120
    ds_read_b128 v[36:39], v17 offset:0
    ds_read_b128 v[40:43], v17 offset:4096
    s_waitcnt lgkmcnt(4)
    v_mfma_f32_32x32x16_bf16 v[44:59], v[20:23], v[28:31], 0
    s_add_u32 m0, s29, 131072
    s_add_u32 s30, s25, 0
    buffer_load_dwordx4 v10, s[4:7], s30 offen lds
    v_mfma_f32_32x32x16_bf16 v[60:75], v[20:23], v[32:35], 0
    s_add_u32 m0, s29, 139264
    s_add_u32 s30, s25, 524288
    buffer_load_dwordx4 v10, s[4:7], s30 offen lds
    s_add_u32 s25, s25, 128
    ds_read_b64_tr_b16 v[20:21], v12 offset:8192
    ds_read_b64_tr_b16 v[22:23], v12 offset:9216
    ds_read_b128 v[28:31], v18 offset:0
    ds_read_b128 v[32:35], v18 offset:4096
    s_waitcnt lgkmcnt(4)
    v_mfma_f32_32x32x16_bf16 v[44:59], v[24:27], v[36:39], v[44:59]
    s_add_u32 m0, s29, 147456
    s_add_u32 s30, s26, 0
    buffer_load_dwordx4 v11, s[8:11], s30 offen lds
    v_mfma_f32_32x32x16_bf16 v[60:75], v[24:27], v[40:43], v[60:75]
    s_add_u32 m0, s29, 155648
    s_add_u32 s30, s26, 32768
    buffer_load_dwordx4 v11, s[8:11], s30 offen lds
    s_add_u32 s26, s26, 65536
    ds_read_b64_tr_b16 v[24:25], v12 offset:12288
    ds_read_b64_tr_b16 v[26:27], v12 offset:13312
    ds_read_b128 v[36:39], v19 offset:0
    ds_read_b128 v[40:43], v19 offset:4096
    s_waitcnt lgkmcnt(4)
    v_mfma_f32_32x32x16_bf16 v[44:59], v[20:23], v[28:31], v[44:59]
    v_mfma_f32_32x32x16_bf16 v[60:75], v[20:23], v[32:35], v[60:75]
    s_waitcnt lgkmcnt(0)
    v_add_u32 v12, 32768, v12
    v_add_u32 v16, 32768, v16
    v_add_u32 v17, 32768, v17
    v_add_u32 v18, 32768, v18
    v_add_u32 v19, 32768, v19
    v_mfma_f32_32x32x16_bf16 v[44:59], v[24:27], v[36:39], v[44:59]
    s_waitcnt vmcnt(12)
    s_barrier
    ds_read_b64_tr_b16 v[20:21], v12 offset:0
    ds_read_b64_tr_b16 v[22:23], v12 offset:1024
    ds_read_b128 v[28:31], v16 offset:0
    ds_read_b128 v[32:35], v16 offset:4096
    v_mfma_f32_32x32x16_bf16 v[60:75], v[24:27], v[40:43], v[60:75]
    ds_read_b64_tr_b16 v[24:25], v12 offset:4096
    ds_read_b64_tr_b16 v[26:27], v12 offset:5120
    ds_read_b128 v[36:39], v17 offset:0
    ds_read_b128 v[40:43], v17 offset:4096
    s_waitcnt lgkmcnt(4)
    v_mfma_f32_32x32x16_bf16 v[44:59], v[20:23], v[28:31], v[44:59]
    s_add_u32 m0, s29, 0
    s_add_u32 s30, s25, 0
    buffer_load_dwordx4 v10, s[4:7], s30 offen lds
    v_mfma_f32_32x32x16_bf16 v[60:75], v[20:23], v[32:35], v[60:75]
    s_add_u32 m0, s29, 8192
    s_add_u32 s30, s25, 524288
    buffer_load_dwordx4 v10, s[4:7], s30 offen lds
    s_add_u32 s25, s25, 128
    ds_read_b64_tr_b16 v[20:21], v12 offset:8192
    ds_read_b64_tr_b16 v[22:23], v12 offset:9216
    ds_read_b128 v[28:31], v18 offset:0
    ds_read_b128 v[32:35], v18 offset:4096
    s_waitcnt lgkmcnt(4)
    v_mfma_f32_32x32x16_bf16 v[44:59], v[24:27], v[36:39], v[44:59]
    s_add_u32 m0, s29, 16384
    s_add_u32 s30, s26, 0
    buffer_load_dwordx4 v11, s[8:11], s30 offen lds
    v_mfma_f32_32x32x16_bf16 v[60:75], v[24:27], v[40:43], v[60:75]
    s_add_u32 m0, s29, 24576
    s_add_u32 s30, s26, 32768
    buffer_load_dwordx4 v11, s[8:11], s30 offen lds
    s_add_u32 s26, s26, 65536
    ds_read_b64_tr_b16 v[24:25], v12 offset:12288
    ds_read_b64_tr_b16 v[26:27], v12 offset:13312
    ds_read_b128 v[36:39], v19 offset:0
    ds_read_b128 v[40:43], v19 offset:4096
    s_waitcnt lgkmcnt(4)
    v_mfma_f32_32x32x16_bf16 v[44:59], v[20:23], v[28:31], v[44:59]
    v_mfma_f32_32x32x16_bf16 v[60:75], v[20:23], v[32:35], v[60:75]
    s_waitcnt lgkmcnt(0)
    v_add_u32 v12, 32768, v12
    v_add_u32 v16, 32768, v16
    v_add_u32 v17, 32768, v17
    v_add_u32 v18, 32768, v18
    v_add_u32 v19, 32768, v19
    v_mfma_f32_32x32x16_bf16 v[44:59], v[24:27], v[36:39], v[44:59]
    s_waitcnt vmcnt(12)
    s_barrier
    ds_read_b64_tr_b16 v[20:21], v12 offset:0
    ds_read_b64_tr_b16 v[22:23], v12 offset:1024
    ds_read_b128 v[28:31], v16 offset:0
    ds_read_b128 v[32:35], v16 offset:4096
    v_mfma_f32_32x32x16_bf16 v[60:75], v[24:27], v[40:43], v[60:75]
    ds_read_b64_tr_b16 v[24:25], v12 offset:4096
    ds_read_b64_tr_b16 v[26:27], v12 offset:5120
    ds_read_b128 v[36:39], v17 offset:0
    ds_read_b128 v[40:43], v17 offset:4096
    s_waitcnt lgkmcnt(4)
    v_mfma_f32_32x32x16_bf16 v[44:59], v[20:23], v[28:31], v[44:59]
    s_add_u32 m0, s29, 32768
    s_add_u32 s30, s25, 0
    buffer_load_dwordx4 v10, s[4:7], s30 offen lds
    v_mfma_f32_32x32x16_bf16 v[60:75], v[20:23], v[32:35], v[60:75]
    s_add_u32 m0, s29, 40960
    s_add_u32 s30, s25, 524288
    buffer_load_dwordx4 v10, s[4:7], s30 offen lds
    s_add_u32 s25, s25, 128
    ds_read_b64_tr_b16 v[20:21], v12 offset:8192
    ds_read_b64_tr_b16 v[22:23], v12 offset:9216
    ds_read_b128 v[28:31], v18 offset:0
    ds_read_b128 v[32:35], v18 offset:4096
    s_waitcnt lgkmcnt(4)
    v_mfma_f32_32x32x16_bf16 v[44:59], v[24:27], v[36:39], v[44:59]
    s_add_u32 m0, s29, 49152
    s_add_u32 s30, s26, 0
    buffer_load_dwordx4 v11, s[8:11], s30 offen lds
    v_mfma_f32_32x32x16_bf16 v[60:75], v[24:27], v[40:43], v[60:75]
    s_add_u32 m0, s29, 57344
    s_add_u32 s30, s26, 32768
    buffer_load_dwordx4 v11, s[8:11], s30 offen lds
    s_add_u32 s26, s26, 65536
    ds_read_b64_tr_b16 v[24:25], v12 offset:12288
    ds_read_b64_tr_b16 v[26:27], v12 offset:13312
    ds_read_b128 v[36:39], v19 offset:0
    ds_read_b128 v[40:43], v19 offset:4096
    s_waitcnt lgkmcnt(4)
    v_mfma_f32_32x32x16_bf16 v[44:59], v[20:23], v[28:31], v[44:59]
    v_mfma_f32_32x32x16_bf16 v[60:75], v[20:23], v[32:35], v[60:75]
    s_waitcnt lgkmcnt(0)
    v_add_u32 v12, 32768, v12
    v_add_u32 v16, 32768, v16
    v_add_u32 v17, 32768, v17
    v_add_u32 v18, 32768, v18
    v_add_u32 v19, 32768, v19
    v_mfma_f32_32x32x16_bf16 v[44:59], v[24:27], v[36:39], v[44:59]
    s_waitcnt vmcnt(12)
    s_barrier
    ds_read_b64_tr_b16 v[20:21], v12 offset:0
    ds_read_b64_tr_b16 v[22:23], v12 offset:1024
    ds_read_b128 v[28:31], v16 offset:0
    ds_read_b128 v[32:35], v16 offset:4096
    v_mfma_f32_32x32x16_bf16 v[60:75], v[24:27], v[40:43], v[60:75]
    ds_read_b64_tr_b16 v[24:25], v12 offset:4096
    ds_read_b64_tr_b16 v[26:27], v12 offset:5120
    ds_read_b128 v[36:39], v17 offset:0
    ds_read_b128 v[40:43], v17 offset:4096
    s_waitcnt lgkmcnt(4)
    v_mfma_f32_32x32x16_bf16 v[44:59], v[20:23], v[28:31], v[44:59]
    s_add_u32 m0, s29, 65536
    s_add_u32 s30, s25, 0
    buffer_load_dwordx4 v10, s[4:7], s30 offen lds
    v_mfma_f32_32x32x16_bf16 v[60:75], v[20:23], v[32:35], v[60:75]
    s_add_u32 m0, s29, 73728
    s_add_u32 s30, s25, 524288
    buffer_load_dwordx4 v10, s[4:7], s30 offen lds
    s_add_u32 s25, s25, 128
    ds_read_b64_tr_b16 v[20:21], v12 offset:8192
    ds_read_b64_tr_b16 v[22:23], v12 offset:9216
    ds_read_b128 v[28:31], v18 offset:0
    ds_read_b128 v[32:35], v18 offset:4096
    s_waitcnt lgkmcnt(4)
    v_mfma_f32_32x32x16_bf16 v[44:59], v[24:27], v[36:39], v[44:59]
    s_add_u32 m0, s29, 81920
    s_add_u32 s30, s26, 0
    buffer_load_dwordx4 v11, s[8:11], s30 offen lds
    v_mfma_f32_32x32x16_bf16 v[60:75], v[24:27], v[40:43], v[60:75]
    s_add_u32 m0, s29, 90112
    s_add_u32 s30, s26, 32768
    buffer_load_dwordx4 v11, s[8:11], s30 offen lds
    s_add_u32 s26, s26, 65536
    ds_read_b64_tr_b16 v[24:25], v12 offset:12288
    ds_read_b64_tr_b16 v[26:27], v12 offset:13312
    ds_read_b128 v[36:39], v19 offset:0
    ds_read_b128 v[40:43], v19 offset:4096
    s_waitcnt lgkmcnt(4)
    v_mfma_f32_32x32x16_bf16 v[44:59], v[20:23], v[28:31], v[44:59]
    v_mfma_f32_32x32x16_bf16 v[60:75], v[20:23], v[32:35], v[60:75]
    s_waitcnt lgkmcnt(0)
    v_add_u32 v12, 32768, v12
    v_add_u32 v16, 32768, v16
    v_add_u32 v17, 32768, v17
    v_add_u32 v18, 32768, v18
    v_add_u32 v19, 32768, v19
    v_mfma_f32_32x32x16_bf16 v[44:59], v[24:27], v[36:39], v[44:59]
    s_waitcnt vmcnt(12)
    s_barrier
    ds_read_b64_tr_b16 v[20:21], v12 offset:0
    ds_read_b64_tr_b16 v[22:23], v12 offset:1024
    ds_read_b128 v[28:31], v16 offset:0
    ds_read_b128 v[32:35], v16 offset:4096
    v_mfma_f32_32x32x16_bf16 v[60:75], v[24:27], v[40:43], v[60:75]
    ds_read_b64_tr_b16 v[24:25], v12 offset:4096
    ds_read_b64_tr_b16 v[26:27], v12 offset:5120
    ds_read_b128 v[36:39], v17 offset:0
    ds_read_b128 v[40:43], v17 offset:4096
    s_waitcnt lgkmcnt(4)
    v_mfma_f32_32x32x16_bf16 v[44:59], v[20:23], v[28:31], v[44:59]
    s_add_u32 m0, s29, 98304
    s_add_u32 s30, s25, 0
    buffer_load_dwordx4 v10, s[4:7], s30 offen lds
    v_mfma_f32_32x32x16_bf16 v[60:75], v[20:23], v[32:35], v[60:75]
    s_add_u32 m0, s29, 106496
    s_add_u32 s30, s25, 524288
    buffer_load_dwordx4 v10, s[4:7], s30 offen lds
    s_add_u32 s25, s25, 128
    ds_read_b64_tr_b16 v[20:21], v12 offset:8192
    ds_read_b64_tr_b16 v[22:23], v12 offset:9216
    ds_read_b128 v[28:31], v18 offset:0
    ds_read_b128 v[32:35], v18 offset:4096
    s_waitcnt lgkmcnt(4)
    v_mfma_f32_32x32x16_bf16 v[44:59], v[24:27], v[36:39], v[44:59]
    s_add_u32 m0, s29, 114688
    s_add_u32 s30, s26, 0
    buffer_load_dwordx4 v11, s[8:11], s30 offen lds
    v_mfma_f32_32x32x16_bf16 v[60:75], v[24:27], v[40:43], v[60:75]
    s_add_u32 m0, s29, 122880
    s_add_u32 s30, s26, 32768
    buffer_load_dwordx4 v11, s[8:11], s30 offen lds
    s_add_u32 s26, s26, 65536
    ds_read_b64_tr_b16 v[24:25], v12 offset:12288
    ds_read_b64_tr_b16 v[26:27], v12 offset:13312
    ds_read_b128 v[36:39], v19 offset:0
    ds_read_b128 v[40:43], v19 offset:4096
    s_waitcnt lgkmcnt(4)
    v_mfma_f32_32x32x16_bf16 v[44:59], v[20:23], v[28:31], v[44:59]
    v_mfma_f32_32x32x16_bf16 v[60:75], v[20:23], v[32:35], v[60:75]
    s_waitcnt lgkmcnt(0)
    v_add_u32 v12, 4294836224, v12
    v_add_u32 v16, 4294836224, v16
    v_add_u32 v17, 4294836224, v17
    v_add_u32 v18, 4294836224, v18
    v_add_u32 v19, 4294836224, v19
    v_mfma_f32_32x32x16_bf16 v[44:59], v[24:27], v[36:39], v[44:59]
    s_waitcnt vmcnt(12)
    s_barrier
    ds_read_b64_tr_b16 v[20:21], v12 offset:0
    ds_read_b64_tr_b16 v[22:23], v12 offset:1024
    ds_read_b128 v[28:31], v16 offset:0
    ds_read_b128 v[32:35], v16 offset:4096
    v_mfma_f32_32x32x16_bf16 v[60:75], v[24:27], v[40:43], v[60:75]
    ds_read_b64_tr_b16 v[24:25], v12 offset:4096
    ds_read_b64_tr_b16 v[26:27], v12 offset:5120
    ds_read_b128 v[36:39], v17 offset:0
    ds_read_b128 v[40:43], v17 offset:4096
    s_waitcnt lgkmcnt(4)
    v_mfma_f32_32x32x16_bf16 v[44:59], v[20:23], v[28:31], v[44:59]
    s_add_u32 m0, s29, 131072
    s_add_u32 s30, s25, 0
    buffer_load_dwordx4 v10, s[4:7], s30 offen lds
    v_mfma_f32_32x32x16_bf16 v[60:75], v[20:23], v[32:35], v[60:75]
    s_add_u32 m0, s29, 139264
    s_add_u32 s30, s25, 524288
    buffer_load_dwordx4 v10, s[4:7], s30 offen lds
    s_add_u32 s25, s25, 128
    ds_read_b64_tr_b16 v[20:21], v12 offset:8192
    ds_read_b64_tr_b16 v[22:23], v12 offset:9216
    ds_read_b128 v[28:31], v18 offset:0
    ds_read_b128 v[32:35], v18 offset:4096
    s_waitcnt lgkmcnt(4)
    v_mfma_f32_32x32x16_bf16 v[44:59], v[24:27], v[36:39], v[44:59]
    s_add_u32 m0, s29, 147456
    s_add_u32 s30, s26, 0
    buffer_load_dwordx4 v11, s[8:11], s30 offen lds
    v_mfma_f32_32x32x16_bf16 v[60:75], v[24:27], v[40:43], v[60:75]
    s_add_u32 m0, s29, 155648
    s_add_u32 s30, s26, 32768
    buffer_load_dwordx4 v11, s[8:11], s30 offen lds
    s_add_u32 s26, s26, 65536
    ds_read_b64_tr_b16 v[24:25], v12 offset:12288
    ds_read_b64_tr_b16 v[26:27], v12 offset:13312
    ds_read_b128 v[36:39], v19 offset:0
    ds_read_b128 v[40:43], v19 offset:4096
    s_waitcnt lgkmcnt(4)
    v_mfma_f32_32x32x16_bf16 v[44:59], v[20:23], v[28:31], v[44:59]
    v_mfma_f32_32x32x16_bf16 v[60:75], v[20:23], v[32:35], v[60:75]
    s_waitcnt lgkmcnt(0)
    v_add_u32 v12, 32768, v12
    v_add_u32 v16, 32768, v16
    v_add_u32 v17, 32768, v17
    v_add_u32 v18, 32768, v18
    v_add_u32 v19, 32768, v19
    v_mfma_f32_32x32x16_bf16 v[44:59], v[24:27], v[36:39], v[44:59]
    s_waitcnt vmcnt(12)
    s_barrier
    ds_read_b64_tr_b16 v[20:21], v12 offset:0
    ds_read_b64_tr_b16 v[22:23], v12 offset:1024
    ds_read_b128 v[28:31], v16 offset:0
    ds_read_b128 v[32:35], v16 offset:4096
    v_mfma_f32_32x32x16_bf16 v[60:75], v[24:27], v[40:43], v[60:75]
    ds_read_b64_tr_b16 v[24:25], v12 offset:4096
    ds_read_b64_tr_b16 v[26:27], v12 offset:5120
    ds_read_b128 v[36:39], v17 offset:0
    ds_read_b128 v[40:43], v17 offset:4096
    s_waitcnt lgkmcnt(4)
    v_mfma_f32_32x32x16_bf16 v[44:59], v[20:23], v[28:31], v[44:59]
    s_add_u32 m0, s29, 0
    s_add_u32 s30, s25, 0
    buffer_load_dwordx4 v10, s[4:7], s30 offen lds
    v_mfma_f32_32x32x16_bf16 v[60:75], v[20:23], v[32:35], v[60:75]
    s_add_u32 m0, s29, 8192
    s_add_u32 s30, s25, 524288
    buffer_load_dwordx4 v10, s[4:7], s30 offen lds
    s_add_u32 s25, s25, 128
    ds_read_b64_tr_b16 v[20:21], v12 offset:8192
    ds_read_b64_tr_b16 v[22:23], v12 offset:9216
    ds_read_b128 v[28:31], v18 offset:0
    ds_read_b128 v[32:35], v18 offset:4096
    s_waitcnt lgkmcnt(4)
    v_mfma_f32_32x32x16_bf16 v[44:59], v[24:27], v[36:39], v[44:59]
    s_add_u32 m0, s29, 16384
    s_add_u32 s30, s26, 0
    buffer_load_dwordx4 v11, s[8:11], s30 offen lds
    v_mfma_f32_32x32x16_bf16 v[60:75], v[24:27], v[40:43], v[60:75]
    s_add_u32 m0, s29, 24576
    s_add_u32 s30, s26, 32768
    buffer_load_dwordx4 v11, s[8:11], s30 offen lds
    s_add_u32 s26, s26, 65536
    ds_read_b64_tr_b16 v[24:25], v12 offset:12288
    ds_read_b64_tr_b16 v[26:27], v12 offset:13312
    ds_read_b128 v[36:39], v19 offset:0
    ds_read_b128 v[40:43], v19 offset:4096
    s_waitcnt lgkmcnt(4)
    v_mfma_f32_32x32x16_bf16 v[44:59], v[20:23], v[28:31], v[44:59]
    v_mfma_f32_32x32x16_bf16 v[60:75], v[20:23], v[32:35], v[60:75]
    s_waitcnt lgkmcnt(0)
    v_add_u32 v12, 32768, v12
    v_add_u32 v16, 32768, v16
    v_add_u32 v17, 32768, v17
    v_add_u32 v18, 32768, v18
    v_add_u32 v19, 32768, v19
    v_mfma_f32_32x32x16_bf16 v[44:59], v[24:27], v[36:39], v[44:59]
    s_waitcnt vmcnt(12)
    s_barrier
    ds_read_b64_tr_b16 v[20:21], v12 offset:0
    ds_read_b64_tr_b16 v[22:23], v12 offset:1024
    ds_read_b128 v[28:31], v16 offset:0
    ds_read_b128 v[32:35], v16 offset:4096
    v_mfma_f32_32x32x16_bf16 v[60:75], v[24:27], v[40:43], v[60:75]
    ds_read_b64_tr_b16 v[24:25], v12 offset:4096
    ds_read_b64_tr_b16 v[26:27], v12 offset:5120
    ds_read_b128 v[36:39], v17 offset:0
    ds_read_b128 v[40:43], v17 offset:4096
    s_waitcnt lgkmcnt(4)
    v_mfma_f32_32x32x16_bf16 v[44:59], v[20:23], v[28:31], v[44:59]
    s_add_u32 m0, s29, 32768
    s_add_u32 s30, s25, 0
    buffer_load_dwordx4 v10, s[4:7], s30 offen lds
    v_mfma_f32_32x32x16_bf16 v[60:75], v[20:23], v[32:35], v[60:75]
    s_add_u32 m0, s29, 40960
    s_add_u32 s30, s25, 524288
    buffer_load_dwordx4 v10, s[4:7], s30 offen lds
    s_add_u32 s25, s25, 128
    ds_read_b64_tr_b16 v[20:21], v12 offset:8192
    ds_read_b64_tr_b16 v[22:23], v12 offset:9216
    ds_read_b128 v[28:31], v18 offset:0
    ds_read_b128 v[32:35], v18 offset:4096
    s_waitcnt lgkmcnt(4)
    v_mfma_f32_32x32x16_bf16 v[44:59], v[24:27], v[36:39], v[44:59]
    s_add_u32 m0, s29, 49152
    s_add_u32 s30, s26, 0
    buffer_load_dwordx4 v11, s[8:11], s30 offen lds
    v_mfma_f32_32x32x16_bf16 v[60:75], v[24:27], v[40:43], v[60:75]
    s_add_u32 m0, s29, 57344
    s_add_u32 s30, s26, 32768
    buffer_load_dwordx4 v11, s[8:11], s30 offen lds
    s_add_u32 s26, s26, 65536
    ds_read_b64_tr_b16 v[24:25], v12 offset:12288
    ds_read_b64_tr_b16 v[26:27], v12 offset:13312
    ds_read_b128 v[36:39], v19 offset:0
    ds_read_b128 v[40:43], v19 offset:4096
    s_waitcnt lgkmcnt(4)
    v_mfma_f32_32x32x16_bf16 v[44:59], v[20:23], v[28:31], v[44:59]
    v_mfma_f32_32x32x16_bf16 v[60:75], v[20:23], v[32:35], v[60:75]
    s_waitcnt lgkmcnt(0)
    v_add_u32 v12, 32768, v12
    v_add_u32 v16, 32768, v16
    v_add_u32 v17, 32768, v17
    v_add_u32 v18, 32768, v18
    v_add_u32 v19, 32768, v19
    v_mfma_f32_32x32x16_bf16 v[44:59], v[24:27], v[36:39], v[44:59]
    s_waitcnt vmcnt(12)
    s_barrier
    ds_read_b64_tr_b16 v[20:21], v12 offset:0
    ds_read_b64_tr_b16 v[22:23], v12 offset:1024
    ds_read_b128 v[28:31], v16 offset:0
    ds_read_b128 v[32:35], v16 offset:4096
    v_mfma_f32_32x32x16_bf16 v[60:75], v[24:27], v[40:43], v[60:75]
    ds_read_b64_tr_b16 v[24:25], v12 offset:4096
    ds_read_b64_tr_b16 v[26:27], v12 offset:5120
    ds_read_b128 v[36:39], v17 offset:0
    ds_read_b128 v[40:43], v17 offset:4096
    s_waitcnt lgkmcnt(4)
    v_mfma_f32_32x32x16_bf16 v[44:59], v[20:23], v[28:31], v[44:59]
    s_add_u32 m0, s29, 65536
    s_add_u32 s30, s25, 0
    buffer_load_dwordx4 v10, s[4:7], s30 offen lds
    v_mfma_f32_32x32x16_bf16 v[60:75], v[20:23], v[32:35], v[60:75]
    s_add_u32 m0, s29, 73728
    s_add_u32 s30, s25, 524288
    buffer_load_dwordx4 v10, s[4:7], s30 offen lds
    s_add_u32 s25, s25, 128
    ds_read_b64_tr_b16 v[20:21], v12 offset:8192
    ds_read_b64_tr_b16 v[22:23], v12 offset:9216
    ds_read_b128 v[28:31], v18 offset:0
    ds_read_b128 v[32:35], v18 offset:4096
    s_waitcnt lgkmcnt(4)
    v_mfma_f32_32x32x16_bf16 v[44:59], v[24:27], v[36:39], v[44:59]
    s_add_u32 m0, s29, 81920
    s_add_u32 s30, s26, 0
    buffer_load_dwordx4 v11, s[8:11], s30 offen lds
    v_mfma_f32_32x32x16_bf16 v[60:75], v[24:27], v[40:43], v[60:75]
    s_add_u32 m0, s29, 90112
    s_add_u32 s30, s26, 32768
    buffer_load_dwordx4 v11, s[8:11], s30 offen lds
    s_add_u32 s26, s26, 65536
    ds_read_b64_tr_b16 v[24:25], v12 offset:12288
    ds_read_b64_tr_b16 v[26:27], v12 offset:13312
    ds_read_b128 v[36:39], v19 offset:0
    ds_read_b128 v[40:43], v19 offset:4096
    s_waitcnt lgkmcnt(4)
    v_mfma_f32_32x32x16_bf16 v[44:59], v[20:23], v[28:31], v[44:59]
    v_mfma_f32_32x32x16_bf16 v[60:75], v[20:23], v[32:35], v[60:75]
    s_waitcnt lgkmcnt(0)
    v_add_u32 v12, 32768, v12
    v_add_u32 v16, 32768, v16
    v_add_u32 v17, 32768, v17
    v_add_u32 v18, 32768, v18
    v_add_u32 v19, 32768, v19
    v_mfma_f32_32x32x16_bf16 v[44:59], v[24:27], v[36:39], v[44:59]
    s_waitcnt vmcnt(12)
    s_barrier
    ds_read_b64_tr_b16 v[20:21], v12 offset:0
    ds_read_b64_tr_b16 v[22:23], v12 offset:1024
    ds_read_b128 v[28:31], v16 offset:0
    ds_read_b128 v[32:35], v16 offset:4096
    v_mfma_f32_32x32x16_bf16 v[60:75], v[24:27], v[40:43], v[60:75]
    ds_read_b64_tr_b16 v[24:25], v12 offset:4096
    ds_read_b64_tr_b16 v[26:27], v12 offset:5120
    ds_read_b128 v[36:39], v17 offset:0
    ds_read_b128 v[40:43], v17 offset:4096
    s_waitcnt lgkmcnt(4)
    v_mfma_f32_32x32x16_bf16 v[44:59], v[20:23], v[28:31], v[44:59]
    s_add_u32 m0, s29, 98304
    s_add_u32 s30, s25, 0
    buffer_load_dwordx4 v10, s[4:7], s30 offen lds
    v_mfma_f32_32x32x16_bf16 v[60:75], v[20:23], v[32:35], v[60:75]
    s_add_u32 m0, s29, 106496
    s_add_u32 s30, s25, 524288
    buffer_load_dwordx4 v10, s[4:7], s30 offen lds
    s_add_u32 s25, s25, 128
    ds_read_b64_tr_b16 v[20:21], v12 offset:8192
    ds_read_b64_tr_b16 v[22:23], v12 offset:9216
    ds_read_b128 v[28:31], v18 offset:0
    ds_read_b128 v[32:35], v18 offset:4096
    s_waitcnt lgkmcnt(4)
    v_mfma_f32_32x32x16_bf16 v[44:59], v[24:27], v[36:39], v[44:59]
    s_add_u32 m0, s29, 114688
    s_add_u32 s30, s26, 0
    buffer_load_dwordx4 v11, s[8:11], s30 offen lds
    v_mfma_f32_32x32x16_bf16 v[60:75], v[24:27], v[40:43], v[60:75]
    s_add_u32 m0, s29, 122880
    s_add_u32 s30, s26, 32768
    buffer_load_dwordx4 v11, s[8:11], s30 offen lds
    s_add_u32 s26, s26, 65536
    ds_read_b64_tr_b16 v[24:25], v12 offset:12288
    ds_read_b64_tr_b16 v[26:27], v12 offset:13312
    ds_read_b128 v[36:39], v19 offset:0
    ds_read_b128 v[40:43], v19 offset:4096
    s_waitcnt lgkmcnt(4)
    v_mfma_f32_32x32x16_bf16 v[44:59], v[20:23], v[28:31], v[44:59]
    v_mfma_f32_32x32x16_bf16 v[60:75], v[20:23], v[32:35], v[60:75]
    s_waitcnt lgkmcnt(0)
    v_add_u32 v12, 4294836224, v12
    v_add_u32 v16, 4294836224, v16
    v_add_u32 v17, 4294836224, v17
    v_add_u32 v18, 4294836224, v18
    v_add_u32 v19, 4294836224, v19
    v_mfma_f32_32x32x16_bf16 v[44:59], v[24:27], v[36:39], v[44:59]
    s_waitcnt vmcnt(12)
    s_barrier
    ds_read_b64_tr_b16 v[20:21], v12 offset:0
    ds_read_b64_tr_b16 v[22:23], v12 offset:1024
    ds_read_b128 v[28:31], v16 offset:0
    ds_read_b128 v[32:35], v16 offset:4096
    v_mfma_f32_32x32x16_bf16 v[60:75], v[24:27], v[40:43], v[60:75]
    ds_read_b64_tr_b16 v[24:25], v12 offset:4096
    ds_read_b64_tr_b16 v[26:27], v12 offset:5120
    ds_read_b128 v[36:39], v17 offset:0
    ds_read_b128 v[40:43], v17 offset:4096
    s_waitcnt lgkmcnt(4)
    v_mfma_f32_32x32x16_bf16 v[44:59], v[20:23], v[28:31], v[44:59]
    s_add_u32 m0, s29, 131072
    s_add_u32 s30, s25, 0
    buffer_load_dwordx4 v10, s[4:7], s30 offen lds
    v_mfma_f32_32x32x16_bf16 v[60:75], v[20:23], v[32:35], v[60:75]
    s_add_u32 m0, s29, 139264
    s_add_u32 s30, s25, 524288
    buffer_load_dwordx4 v10, s[4:7], s30 offen lds
    s_add_u32 s25, s25, 128
    ds_read_b64_tr_b16 v[20:21], v12 offset:8192
    ds_read_b64_tr_b16 v[22:23], v12 offset:9216
    ds_read_b128 v[28:31], v18 offset:0
    ds_read_b128 v[32:35], v18 offset:4096
    s_waitcnt lgkmcnt(4)
    v_mfma_f32_32x32x16_bf16 v[44:59], v[24:27], v[36:39], v[44:59]
    s_add_u32 m0, s29, 147456
    s_add_u32 s30, s26, 0
    buffer_load_dwordx4 v11, s[8:11], s30 offen lds
    v_mfma_f32_32x32x16_bf16 v[60:75], v[24:27], v[40:43], v[60:75]
    s_add_u32 m0, s29, 155648
    s_add_u32 s30, s26, 32768
    buffer_load_dwordx4 v11, s[8:11], s30 offen lds
    s_add_u32 s26, s26, 65536
    ds_read_b64_tr_b16 v[24:25], v12 offset:12288
    ds_read_b64_tr_b16 v[26:27], v12 offset:13312
    ds_read_b128 v[36:39], v19 offset:0
    ds_read_b128 v[40:43], v19 offset:4096
    s_waitcnt lgkmcnt(4)
    v_mfma_f32_32x32x16_bf16 v[44:59], v[20:23], v[28:31], v[44:59]
    v_mfma_f32_32x32x16_bf16 v[60:75], v[20:23], v[32:35], v[60:75]
    s_waitcnt lgkmcnt(0)
    v_add_u32 v12, 32768, v12
    v_add_u32 v16, 32768, v16
    v_add_u32 v17, 32768, v17
    v_add_u32 v18, 32768, v18
    v_add_u32 v19, 32768, v19
    v_mfma_f32_32x32x16_bf16 v[44:59], v[24:27], v[36:39], v[44:59]
    s_waitcnt vmcnt(12)
    s_barrier
    ds_read_b64_tr_b16 v[20:21], v12 offset:0
    ds_read_b64_tr_b16 v[22:23], v12 offset:1024
    ds_read_b128 v[28:31], v16 offset:0
    ds_read_b128 v[32:35], v16 offset:4096
    v_mfma_f32_32x32x16_bf16 v[60:75], v[24:27], v[40:43], v[60:75]
    ds_read_b64_tr_b16 v[24:25], v12 offset:4096
    ds_read_b64_tr_b16 v[26:27], v12 offset:5120
    ds_read_b128 v[36:39], v17 offset:0
    ds_read_b128 v[40:43], v17 offset:4096
    s_waitcnt lgkmcnt(4)
    v_mfma_f32_32x32x16_bf16 v[44:59], v[20:23], v[28:31], v[44:59]
    s_add_u32 m0, s29, 0
    s_add_u32 s30, s25, 0
    buffer_load_dwordx4 v10, s[4:7], s30 offen lds
    v_mfma_f32_32x32x16_bf16 v[60:75], v[20:23], v[32:35], v[60:75]
    s_add_u32 m0, s29, 8192
    s_add_u32 s30, s25, 524288
    buffer_load_dwordx4 v10, s[4:7], s30 offen lds
    s_add_u32 s25, s25, 128
    ds_read_b64_tr_b16 v[20:21], v12 offset:8192
    ds_read_b64_tr_b16 v[22:23], v12 offset:9216
    ds_read_b128 v[28:31], v18 offset:0
    ds_read_b128 v[32:35], v18 offset:4096
    s_waitcnt lgkmcnt(4)
    v_mfma_f32_32x32x16_bf16 v[44:59], v[24:27], v[36:39], v[44:59]
    s_add_u32 m0, s29, 16384
    s_add_u32 s30, s26, 0
    buffer_load_dwordx4 v11, s[8:11], s30 offen lds
    v_mfma_f32_32x32x16_bf16 v[60:75], v[24:27], v[40:43], v[60:75]
    s_add_u32 m0, s29, 24576
    s_add_u32 s30, s26, 32768
    buffer_load_dwordx4 v11, s[8:11], s30 offen lds
    s_add_u32 s26, s26, 65536
    ds_read_b64_tr_b16 v[24:25], v12 offset:12288
    ds_read_b64_tr_b16 v[26:27], v12 offset:13312
    ds_read_b128 v[36:39], v19 offset:0
    ds_read_b128 v[40:43], v19 offset:4096
    s_waitcnt lgkmcnt(4)
    v_mfma_f32_32x32x16_bf16 v[44:59], v[20:23], v[28:31], v[44:59]
    v_mfma_f32_32x32x16_bf16 v[60:75], v[20:23], v[32:35], v[60:75]
    s_waitcnt lgkmcnt(0)
    v_add_u32 v12, 32768, v12
    v_add_u32 v16, 32768, v16
    v_add_u32 v17, 32768, v17
    v_add_u32 v18, 32768, v18
    v_add_u32 v19, 32768, v19
    v_mfma_f32_32x32x16_bf16 v[44:59], v[24:27], v[36:39], v[44:59]
    s_waitcnt vmcnt(12)
    s_barrier
    ds_read_b64_tr_b16 v[20:21], v12 offset:0
    ds_read_b64_tr_b16 v[22:23], v12 offset:1024
    ds_read_b128 v[28:31], v16 offset:0
    ds_read_b128 v[32:35], v16 offset:4096
    v_mfma_f32_32x32x16_bf16 v[60:75], v[24:27], v[40:43], v[60:75]
    ds_read_b64_tr_b16 v[24:25], v12 offset:4096
    ds_read_b64_tr_b16 v[26:27], v12 offset:5120
    ds_read_b128 v[36:39], v17 offset:0
    ds_read_b128 v[40:43], v17 offset:4096
    s_waitcnt lgkmcnt(4)
    v_mfma_f32_32x32x16_bf16 v[44:59], v[20:23], v[28:31], v[44:59]
    v_mfma_f32_32x32x16_bf16 v[60:75], v[20:23], v[32:35], v[60:75]
    ds_read_b64_tr_b16 v[20:21], v12 offset:8192
    ds_read_b64_tr_b16 v[22:23], v12 offset:9216
    ds_read_b128 v[28:31], v18 offset:0
    ds_read_b128 v[32:35], v18 offset:4096
    s_waitcnt lgkmcnt(4)
    v_mfma_f32_32x32x16_bf16 v[44:59], v[24:27], v[36:39], v[44:59]
    v_mfma_f32_32x32x16_bf16 v[60:75], v[24:27], v[40:43], v[60:75]
    ds_read_b64_tr_b16 v[24:25], v12 offset:12288
    ds_read_b64_tr_b16 v[26:27], v12 offset:13312
    ds_read_b128 v[36:39], v19 offset:0
    ds_read_b128 v[40:43], v19 offset:4096
    s_waitcnt lgkmcnt(4)
    v_mfma_f32_32x32x16_bf16 v[44:59], v[20:23], v[28:31], v[44:59]
    v_mfma_f32_32x32x16_bf16 v[60:75], v[20:23], v[32:35], v[60:75]
    s_waitcnt lgkmcnt(0)
    v_add_u32 v12, 32768, v12
    v_add_u32 v16, 32768, v16
    v_add_u32 v17, 32768, v17
    v_add_u32 v18, 32768, v18
    v_add_u32 v19, 32768, v19
    v_mfma_f32_32x32x16_bf16 v[44:59], v[24:27], v[36:39], v[44:59]
    s_waitcnt vmcnt(8)
    s_barrier
    ds_read_b64_tr_b16 v[20:21], v12 offset:0
    ds_read_b64_tr_b16 v[22:23], v12 offset:1024
    ds_read_b128 v[28:31], v16 offset:0
    ds_read_b128 v[32:35], v16 offset:4096
    v_mfma_f32_32x32x16_bf16 v[60:75], v[24:27], v[40:43], v[60:75]
    ds_read_b64_tr_b16 v[24:25], v12 offset:4096
    ds_read_b64_tr_b16 v[26:27], v12 offset:5120
    ds_read_b128 v[36:39], v17 offset:0
    ds_read_b128 v[40:43], v17 offset:4096
    s_waitcnt lgkmcnt(4)
    v_mfma_f32_32x32x16_bf16 v[44:59], v[20:23], v[28:31], v[44:59]
    v_mfma_f32_32x32x16_bf16 v[60:75], v[20:23], v[32:35], v[60:75]
    ds_read_b64_tr_b16 v[20:21], v12 offset:8192
    ds_read_b64_tr_b16 v[22:23], v12 offset:9216
    ds_read_b128 v[28:31], v18 offset:0
    ds_read_b128 v[32:35], v18 offset:4096
    s_waitcnt lgkmcnt(4)
    v_mfma_f32_32x32x16_bf16 v[44:59], v[24:27], v[36:39], v[44:59]
    v_mfma_f32_32x32x16_bf16 v[60:75], v[24:27], v[40:43], v[60:75]
    ds_read_b64_tr_b16 v[24:25], v12 offset:12288
    ds_read_b64_tr_b16 v[26:27], v12 offset:13312
    ds_read_b128 v[36:39], v19 offset:0
    ds_read_b128 v[40:43], v19 offset:4096
    s_waitcnt lgkmcnt(4)
    v_mfma_f32_32x32x16_bf16 v[44:59], v[20:23], v[28:31], v[44:59]
    v_mfma_f32_32x32x16_bf16 v[60:75], v[20:23], v[32:35], v[60:75]
    s_waitcnt lgkmcnt(0)
    v_add_u32 v12, 32768, v12
    v_add_u32 v16, 32768, v16
    v_add_u32 v17, 32768, v17
    v_add_u32 v18, 32768, v18
    v_add_u32 v19, 32768, v19
    v_mfma_f32_32x32x16_bf16 v[44:59], v[24:27], v[36:39], v[44:59]
    s_waitcnt vmcnt(4)
    s_barrier
    ds_read_b64_tr_b16 v[20:21], v12 offset:0
    ds_read_b64_tr_b16 v[22:23], v12 offset:1024
    ds_read_b128 v[28:31], v16 offset:0
    ds_read_b128 v[32:35], v16 offset:4096
    v_mfma_f32_32x32x16_bf16 v[60:75], v[24:27], v[40:43], v[60:75]
    ds_read_b64_tr_b16 v[24:25], v12 offset:4096
    ds_read_b64_tr_b16 v[26:27], v12 offset:5120
    ds_read_b128 v[36:39], v17 offset:0
    ds_read_b128 v[40:43], v17 offset:4096
    s_waitcnt lgkmcnt(4)
    v_mfma_f32_32x32x16_bf16 v[44:59], v[20:23], v[28:31], v[44:59]
    v_mfma_f32_32x32x16_bf16 v[60:75], v[20:23], v[32:35], v[60:75]
    ds_read_b64_tr_b16 v[20:21], v12 offset:8192
    ds_read_b64_tr_b16 v[22:23], v12 offset:9216
    ds_read_b128 v[28:31], v18 offset:0
    ds_read_b128 v[32:35], v18 offset:4096
    s_waitcnt lgkmcnt(4)
    v_mfma_f32_32x32x16_bf16 v[44:59], v[24:27], v[36:39], v[44:59]
    v_mfma_f32_32x32x16_bf16 v[60:75], v[24:27], v[40:43], v[60:75]
    ds_read_b64_tr_b16 v[24:25], v12 offset:12288
    ds_read_b64_tr_b16 v[26:27], v12 offset:13312
    ds_read_b128 v[36:39], v19 offset:0
    ds_read_b128 v[40:43], v19 offset:4096
    s_waitcnt lgkmcnt(4)
    v_mfma_f32_32x32x16_bf16 v[44:59], v[20:23], v[28:31], v[44:59]
    v_mfma_f32_32x32x16_bf16 v[60:75], v[20:23], v[32:35], v[60:75]
    s_waitcnt lgkmcnt(0)
    v_add_u32 v12, 4294836224, v12
    v_add_u32 v16, 4294836224, v16
    v_add_u32 v17, 4294836224, v17
    v_add_u32 v18, 4294836224, v18
    v_add_u32 v19, 4294836224, v19
    v_mfma_f32_32x32x16_bf16 v[44:59], v[24:27], v[36:39], v[44:59]
    s_waitcnt vmcnt(0)
    s_barrier
    ds_read_b64_tr_b16 v[20:21], v12 offset:0
    ds_read_b64_tr_b16 v[22:23], v12 offset:1024
    ds_read_b128 v[28:31], v16 offset:0
    ds_read_b128 v[32:35], v16 offset:4096
    v_mfma_f32_32x32x16_bf16 v[60:75], v[24:27], v[40:43], v[60:75]
    ds_read_b64_tr_b16 v[24:25], v12 offset:4096
    ds_read_b64_tr_b16 v[26:27], v12 offset:5120
    ds_read_b128 v[36:39], v17 offset:0
    ds_read_b128 v[40:43], v17 offset:4096
    s_waitcnt lgkmcnt(4)
    v_mfma_f32_32x32x16_bf16 v[44:59], v[20:23], v[28:31], v[44:59]
    v_mfma_f32_32x32x16_bf16 v[60:75], v[20:23], v[32:35], v[60:75]
    ds_read_b64_tr_b16 v[20:21], v12 offset:8192
    ds_read_b64_tr_b16 v[22:23], v12 offset:9216
    ds_read_b128 v[28:31], v18 offset:0
    ds_read_b128 v[32:35], v18 offset:4096
    s_waitcnt lgkmcnt(4)
    v_mfma_f32_32x32x16_bf16 v[44:59], v[24:27], v[36:39], v[44:59]
    v_mfma_f32_32x32x16_bf16 v[60:75], v[24:27], v[40:43], v[60:75]
    ds_read_b64_tr_b16 v[24:25], v12 offset:12288
    ds_read_b64_tr_b16 v[26:27], v12 offset:13312
    ds_read_b128 v[36:39], v19 offset:0
    ds_read_b128 v[40:43], v19 offset:4096
    s_waitcnt lgkmcnt(4)
    v_mfma_f32_32x32x16_bf16 v[44:59], v[20:23], v[28:31], v[44:59]
    v_mfma_f32_32x32x16_bf16 v[60:75], v[20:23], v[32:35], v[60:75]
    s_waitcnt lgkmcnt(0)
    v_mfma_f32_32x32x16_bf16 v[44:59], v[24:27], v[36:39], v[44:59]
    v_mfma_f32_32x32x16_bf16 v[60:75], v[24:27], v[40:43], v[60:75]
    s_lshl_b32 s50, s49, 21
    s_mul_i32 s51, s32, 64
    s_add_u32 s51, s51, s47
    s_lshl_b32 s51, s51, 10
    s_add_u32 s50, s50, s51
    s_lshl_b32 s51, s33, 5
    s_add_u32 s51, s51, s48
    s_lshl_b32 s51, s51, 1
    s_add_u32 s50, s50, s51
    s_barrier
    v_and_b32 v2, 31, v1
    v_lshlrev_b32 v3, 6, v2
    v_lshrrev_b32 v4, 5, v1
    v_lshl_add_u32 v3, v4, 3, v3
    s_mul_i32 s30, s24, 4096
    v_add_u32 v3, s30, v3
    v_bfe_u32 v4, v2, 2, 2
    v_lshlrev_b32 v4, 4, v4
    v_xor_b32 v5, 0, v4
    v_add_u32 v5, v5, v3
    v_cvt_pk_bf16_f32 v20, v44, v45
    v_cvt_pk_bf16_f32 v21, v46, v47
    ds_write_b64 v5, v[20:21] offset:0
    v_cvt_pk_bf16_f32 v22, v60, v61
    v_cvt_pk_bf16_f32 v23, v62, v63
    ds_write_b64 v5, v[22:23] offset:2048
    v_xor_b32 v5, 16, v4
    v_add_u32 v5, v5, v3
    v_cvt_pk_bf16_f32 v24, v48, v49
    v_cvt_pk_bf16_f32 v25, v50, v51
    ds_write_b64 v5, v[24:25] offset:0
    v_cvt_pk_bf16_f32 v26, v64, v65
    v_cvt_pk_bf16_f32 v27, v66, v67
    ds_write_b64 v5, v[26:27] offset:2048
    v_xor_b32 v5, 32, v4
    v_add_u32 v5, v5, v3
    v_cvt_pk_bf16_f32 v20, v52, v53
    v_cvt_pk_bf16_f32 v21, v54, v55
    ds_write_b64 v5, v[20:21] offset:0
    v_cvt_pk_bf16_f32 v22, v68, v69
    v_cvt_pk_bf16_f32 v23, v70, v71
    ds_write_b64 v5, v[22:23] offset:2048
    v_xor_b32 v5, 48, v4
    v_add_u32 v5, v5, v3
    v_cvt_pk_bf16_f32 v24, v56, v57
    v_cvt_pk_bf16_f32 v25, v58, v59
    ds_write_b64 v5, v[24:25] offset:0
    v_cvt_pk_bf16_f32 v26, v72, v73
    v_cvt_pk_bf16_f32 v27, v74, v75
    ds_write_b64 v5, v[26:27] offset:2048
    v_lshrrev_b32 v2, 2, v1
    v_lshlrev_b32 v2, 6, v2
    s_mul_i32 s30, s24, 4096
    v_add_u32 v2, s30, v2
    v_and_b32 v3, 3, v1
    v_lshrrev_b32 v4, 4, v1
    v_xor_b32 v3, v3, v4
    v_lshlrev_b32 v3, 4, v3
    v_xor_b32 v4, 0, v3
    v_add_u32 v12, v4, v2
    v_lshrrev_b32 v2, 2, v1
    s_mov_b32 s30, 1024
    v_mul_lo_u32 v2, v2, s30
    v_and_b32 v3, 3, v1
    v_lshl_add_u32 v10, v3, 4, v2
    s_waitcnt lgkmcnt(0)
    ds_read_b128 v[44:47], v12 offset:0
    ds_read_b128 v[48:51], v12 offset:1024
    ds_read_b128 v[52:55], v12 offset:2048
    ds_read_b128 v[56:59], v12 offset:3072
    s_waitcnt lgkmcnt(3)
    s_add_u32 s30, s50, 0
    buffer_store_dwordx4 v[44:47], v10, s[16:19], s30 offen
    s_waitcnt lgkmcnt(2)
    s_add_u32 s30, s50, 16384
    buffer_store_dwordx4 v[48:51], v10, s[16:19], s30 offen
    s_waitcnt lgkmcnt(1)
    s_add_u32 s30, s50, 32768
    buffer_store_dwordx4 v[52:55], v10, s[16:19], s30 offen
    s_waitcnt lgkmcnt(0)
    s_add_u32 s30, s50, 49152
    buffer_store_dwordx4 v[56:59], v10, s[16:19], s30 offen
L_end_41:
    s_endpgm
.globl redln_kernel
.p2align 8
.type redln_kernel,@function
redln_kernel:
    s_cmp_ge_u32 s2, 512
    s_cbranch_scc1 L_end_42
    s_load_dwordx2 s[36:37], s[0:1], 0
    s_load_dwordx2 s[44:45], s[0:1], 96
    v_and_b32 v1, 63, v0
    v_lshrrev_b32 v2, 6, v0
    s_nop 0
    v_readfirstlane_b32 s24, v2
    s_nop 3
    s_lshl_b32 s25, s2, 2
    s_add_u32 s25, s25, s24
    s_lshl_b32 s26, s25, 10
    s_lshl_b32 s27, s25, 11
    s_waitcnt lgkmcnt(0)
    s_mov_b32 s4, s36
    s_mov_b32 s5, s37
    s_mov_b32 s6, 2097152
    s_mov_b32 s7, 0x00020000
    s_add_u32 s8, s44, 88080384
    s_addc_u32 s9, s45, 0
    s_mov_b32 s10, 8388608
    s_mov_b32 s11, 0x00020000
    s_add_u32 s12, s44, 2097152
    s_addc_u32 s13, s45, 0
    s_mov_b32 s14, 2097152
    s_mov_b32 s15, 0x00020000
    s_add_u32 s16, s44, 4194304
    s_addc_u32 s17, s45, 0
    s_mov_b32 s18, 2097152
    s_mov_b32 s19, 0x00020000
    v_lshlrev_b32 v3, 4, v1
    buffer_load_dwordx4 v[8:11], v3, s[4:7], s26 offen
    s_add_u32 s28, s26, 0
    buffer_load_dwordx4 v[32:35], v3, s[8:11], s28 offen
    s_add_u32 s28, s26, 2097152
    buffer_load_dwordx4 v[36:39], v3, s[8:11], s28 offen
    s_add_u32 s28, s26, 4194304
    buffer_load_dwordx4 v[40:43], v3, s[8:11], s28 offen
    s_add_u32 s28, s26, 6291456
    buffer_load_dwordx4 v[44:47], v3, s[8:11], s28 offen
    s_waitcnt vmcnt(0)
    v_lshlrev_b32 v16, 16, v32
    v_and_b32 v17, 0xffff0000, v32
    v_lshlrev_b32 v18, 16, v33
    v_and_b32 v19, 0xffff0000, v33
    v_lshlrev_b32 v20, 16, v34
    v_and_b32 v21, 0xffff0000, v34
    v_lshlrev_b32 v22, 16, v35
    v_and_b32 v23, 0xffff0000, v35
    v_lshlrev_b32 v24, 16, v36
    v_and_b32 v25, 0xffff0000, v36
    v_lshlrev_b32 v26, 16, v37
    v_and_b32 v27, 0xffff0000, v37
    v_lshlrev_b32 v28, 16, v38
    v_and_b32 v29, 0xffff0000, v38
    v_lshlrev_b32 v30, 16, v39
    v_and_b32 v31, 0xffff0000, v39
    v_add_f32 v16, v16, v24
    v_add_f32 v17, v17, v25
    v_add_f32 v18, v18, v26
    v_add_f32 v19, v19, v27
    v_add_f32 v20, v20, v28
    v_add_f32 v21, v21, v29
    v_add_f32 v22, v22, v30
    v_add_f32 v23, v23, v31
    v_lshlrev_b32 v24, 16, v40
    v_and_b32 v25, 0xffff0000, v40
    v_lshlrev_b32 v26, 16, v41
    v_and_b32 v27, 0xffff0000, v41
    v_lshlrev_b32 v28, 16, v42
    v_and_b32 v29, 0xffff0000, v42
    v_lshlrev_b32 v30, 16, v43
    v_and_b32 v31, 0xffff0000, v43
    v_add_f32 v16, v16, v24
    v_add_f32 v17, v17, v25
    v_add_f32 v18, v18, v26
    v_add_f32 v19, v19, v27
    v_add_f32 v20, v20, v28
    v_add_f32 v21, v21, v29
    v_add_f32 v22, v22, v30
    v_add_f32 v23, v23, v31
    v_lshlrev_b32 v24, 16, v44
    v_and_b32 v25, 0xffff0000, v44
    v_lshlrev_b32 v26, 16, v45
    v_and_b32 v27, 0xffff0000, v45
    v_lshlrev_b32 v28, 16, v46
    v_and_b32 v29, 0xffff0000, v46
    v_lshlrev_b32 v30, 16, v47
    v_and_b32 v31, 0xffff0000, v47
    v_add_f32 v16, v16, v24
    v_add_f32 v17, v17, v25
    v_add_f32 v18, v18, v26
    v_add_f32 v19, v19, v27
    v_add_f32 v20, v20, v28
    v_add_f32 v21, v21, v29
    v_add_f32 v22, v22, v30
    v_add_f32 v23, v23, v31
    v_cvt_pk_bf16_f32 v24, v16, v17
    v_cvt_pk_bf16_f32 v25, v18, v19
    v_cvt_pk_bf16_f32 v26, v20, v21
    v_cvt_pk_bf16_f32 v27, v22, v23
    v_lshlrev_b32 v16, 16, v24
    v_and_b32 v17, 0xffff0000, v24
    v_lshlrev_b32 v32, 16, v8
    v_and_b32 v33, 0xffff0000, v8
    v_lshlrev_b32 v18, 16, v25
    v_and_b32 v19, 0xffff0000, v25
    v_lshlrev_b32 v34, 16, v9
    v_and_b32 v35, 0xffff0000, v9
    v_lshlrev_b32 v20, 16, v26
    v_and_b32 v21, 0xffff0000, v26
    v_lshlrev_b32 v36, 16, v10
    v_and_b32 v37, 0xffff0000, v10
    v_lshlrev_b32 v22, 16, v27
    v_and_b32 v23, 0xffff0000, v27
    v_lshlrev_b32 v38, 16, v11
    v_and_b32 v39, 0xffff0000, v11
    v_add_f32 v16, v16, v32
    v_add_f32 v17, v17, v33
    v_add_f32 v18, v18, v34
    v_add_f32 v19, v19, v35
    v_add_f32 v20, v20, v36
    v_add_f32 v21, v21, v37
    v_add_f32 v22, v22, v38
    v_add_f32 v23, v23, v39
    v_cvt_pk_bf16_f32 v8, v16, v17
    v_cvt_pk_bf16_f32 v9, v18, v19
    v_cvt_pk_bf16_f32 v10, v20, v21
    v_cvt_pk_bf16_f32 v11, v22, v23
    buffer_store_dwordx4 v[8:11], v3, s[12:15], s26 offen
    v_lshlrev_b32 v16, 16, v8
    v_and_b32 v17, 0xffff0000, v8
    v_lshlrev_b32 v18, 16, v9
    v_and_b32 v19, 0xffff0000, v9
    v_lshlrev_b32 v20, 16, v10
    v_and_b32 v21, 0xffff0000, v10
    v_lshlrev_b32 v22, 16, v11
    v_and_b32 v23, 0xffff0000, v11
    v_add_f32 v24, v16, v17
    v_add_f32 v24, v24, v18
    v_add_f32 v24, v24, v19
    v_add_f32 v24, v24, v20
    v_add_f32 v24, v24, v21
    v_add_f32 v24, v24, v22
    v_add_f32 v24, v24, v23
    s_nop 1
    v_add_f32_dpp v25, v24, v24 quad_perm:[1,0,3,2] row_mask:0xf bank_mask:0xf
    s_nop 1
    v_add_f32_dpp v24, v25, v25 quad_perm:[2,3,0,1] row_mask:0xf bank_mask:0xf
    s_nop 1
    v_add_f32_dpp v25, v24, v24 row_half_mirror row_mask:0xf bank_mask:0xf
    s_nop 1
    v_add_f32_dpp v24, v25, v25 row_mirror row_mask:0xf bank_mask:0xf
    s_nop 1
    v_readlane_b32 s60, v24, 0
    v_readlane_b32 s61, v24, 16
    v_readlane_b32 s62, v24, 32
    v_readlane_b32 s63, v24, 48
    s_nop 1
    v_mov_b32 v24, s60
    v_add_f32 v24, s61, v24
    v_add_f32 v24, s62, v24
    v_add_f32 v24, s63, v24
    v_mul_f32 v26, 0x3b000000, v24
    v_sub_f32 v25, v16, v26
    v_mul_f32 v24, v25, v25
    v_sub_f32 v25, v17, v26
    v_fmac_f32 v24, v25, v25
    v_sub_f32 v25, v18, v26
    v_fmac_f32 v24, v25, v25
    v_sub_f32 v25, v19, v26
    v_fmac_f32 v24, v25, v25
    v_sub_f32 v25, v20, v26
    v_fmac_f32 v24, v25, v25
    v_sub_f32 v25, v21, v26
    v_fmac_f32 v24, v25, v25
    v_sub_f32 v25, v22, v26
    v_fmac_f32 v24, v25, v25
    v_sub_f32 v25, v23, v26
    v_fmac_f32 v24, v25, v25
    s_nop 1
    v_add_f32_dpp v25, v24, v24 quad_perm:[1,0,3,2] row_mask:0xf bank_mask:0xf
    s_nop 1
    v_add_f32_dpp v24, v25, v25 quad_perm:[2,3,0,1] row_mask:0xf bank_mask:0xf
    s_nop 1
    v_add_f32_dpp v25, v24, v24 row_half_mirror row_mask:0xf bank_mask:0xf
    s_nop 1
    v_add_f32_dpp v24, v25, v25 row_mirror row_mask:0xf bank_mask:0xf
    s_nop 1
    v_readlane_b32 s60, v24, 0
    v_readlane_b32 s61, v24, 16
    v_readlane_b32 s62, v24, 32
    v_readlane_b32 s63, v24, 48
    s_nop 1
    v_mov_b32 v24, s60
    v_add_f32 v24, s61, v24
    v_add_f32 v24, s62, v24
    v_add_f32 v24, s63, v24
    v_mul_f32 v24, 0x3b000000, v24
    v_cvt_pk_bf16_f32 v25, v26, v24
    v_lshlrev_b32 v26, 16, v25
    v_and_b32 v24, 0xffff0000, v25
    v_add_f32 v24, 0x3727c5ac, v24
    v_cvt_pk_bf16_f32 v25, v24, v24
    v_lshlrev_b32 v24, 16, v25
    v_sqrt_f32 v24, v24
    s_nop 0
    v_cvt_pk_bf16_f32 v25, v24, v24
    v_lshlrev_b32 v24, 16, v25
    v_rcp_f32 v27, v24
    v_sub_f32 v16, v16, v26
    v_sub_f32 v17, v17, v26
    v_sub_f32 v18, v18, v26
    v_sub_f32 v19, v19, v26
    v_sub_f32 v20, v20, v26
    v_sub_f32 v21, v21, v26
    v_sub_f32 v22, v22, v26
    v_sub_f32 v23, v23, v26
    v_cvt_pk_bf16_f32 v25, v16, v17
    v_lshlrev_b32 v16, 16, v25
    v_and_b32 v17, 0xffff0000, v25
    v_cvt_pk_bf16_f32 v25, v18, v19
    v_lshlrev_b32 v18, 16, v25
    v_and_b32 v19, 0xffff0000, v25
    v_cvt_pk_bf16_f32 v25, v20, v21
    v_lshlrev_b32 v20, 16, v25
    v_and_b32 v21, 0xffff0000, v25
    v_cvt_pk_bf16_f32 v25, v22, v23
    v_lshlrev_b32 v22, 16, v25
    v_and_b32 v23, 0xffff0000, v25
    v_mul_f32 v16, v16, v27
    v_mul_f32 v17, v17, v27
    v_mul_f32 v18, v18, v27
    v_mul_f32 v19, v19, v27
    v_mul_f32 v20, v20, v27
    v_mul_f32 v21, v21, v27
    v_mul_f32 v22, v22, v27
    v_mul_f32 v23, v23, v27
    v_cvt_pk_bf16_f32 v40, v16, v17
    v_cvt_pk_bf16_f32 v41, v18, v19
    v_cvt_pk_bf16_f32 v42, v20, v21
    v_cvt_pk_bf16_f32 v43, v22, v23
    buffer_store_dwordx4 v[40:43], v3, s[16:19], s26 offen
L_end_42:
    s_endpgm
.globl glu_kernel
.p2align 8
.type glu_kernel,@function
glu_kernel:
    s_cmp_ge_u32 s2, 224
    s_cbranch_scc1 L_end_43
    s_load_dwordx4 s[40:43], s[0:1], 56
    s_load_dwordx2 s[44:45], s[0:1], 96
    s_and_b32 s47, s2, 3
    s_lshl_b32 s47, s47, 2
    s_bfe_u32 s46, s2, 0x20003
    s_add_u32 s47, s47, s46
    s_lshl_b32 s47, s47, 7
    s_bfe_u32 s48, s2, 0x10002
    s_mul_i32 s48, s48, 7
    s_lshr_b32 s46, s2, 5
    s_add_u32 s48, s48, s46
    s_lshl_b32 s48, s48, 7
    s_waitcnt lgkmcnt(0)
    s_add_u32 s4, s44, 4194304
    s_addc_u32 s5, s45, 0
    s_mov_b32 s6, 2097152
    s_mov_b32 s7, 0x00020000
    s_mov_b32 s8, s40
    s_mov_b32 s9, s41
    s_mov_b32 s10, 1835008
    s_mov_b32 s11, 0x00020000
    s_mov_b32 s12, s42
    s_mov_b32 s13, s43
    s_mov_b32 s14, 1835008
    s_mov_b32 s15, 0x00020000
    s_add_u32 s16, s44, 104857600
    s_addc_u32 s17, s45, 0
    s_mov_b32 s18, 7340032
    s_mov_b32 s19, 0x00020000
    v_and_b32 v1, 63, v0
    v_lshrrev_b32 v2, 6, v0
    s_nop 0
    v_readfirstlane_b32 s24, v2
    s_nop 3
    s_lshl_b32 s29, s24, 10
    s_and_b32 s30, s24, 1
    s_and_b32 s32, s24, 1
    s_lshr_b32 s33, s24, 1
    s_lshl_b32 s31, s30, 2
    v_lshrrev_b32 v2, 4, v1
    v_add_u32 v2, s31, v2
    v_and_b32 v2, 7, v2
    v_and_b32 v3, 7, v1
    v_xor_b32 v2, v2, v3
    v_lshlrev_b32 v2, 4, v2
    v_lshrrev_b32 v3, 3, v1
    s_mov_b32 s31, 1024
    v_mul_lo_u32 v3, v3, s31
    v_add_u32 v10, v2, v3
    v_lshrrev_b32 v2, 4, v1
    v_and_b32 v3, 3, v2
    v_lshlrev_b32 v3, 2, v3
    v_and_b32 v4, 15, v1
    v_xor_b32 v3, v3, v4
    v_lshlrev_b32 v3, 4, v3
    s_mov_b32 s31, 3584
    v_mul_lo_u32 v2, v2, s31
    v_add_u32 v11, v2, v3
    s_mul_i32 s30, s24, 8
    s_add_u32 s30, s30, s47
    s_mul_i32 s25, s30, 1024
    s_mul_i32 s30, s24, 4
    s_mul_i32 s26, s30, 3584
    s_lshl_b32 s30, s48, 1
    s_add_u32 s26, s26, s30
    s_mul_i32 s30, s24, 4
    s_mul_i32 s27, s30, 3584
    s_lshl_b32 s30, s48, 1
    s_add_u32 s27, s27, s30
    s_add_u32 m0, s29, 0
    s_add_u32 s30, s25, 0
    buffer_load_dwordx4 v10, s[4:7], s30 offen lds
    s_add_u32 m0, s29, 8192
    s_add_u32 s30, s25, 65536
    buffer_load_dwordx4 v10, s[4:7], s30 offen lds
    s_add_u32 s25, s25, 128
    s_add_u32 m0, s29, 16384
    s_add_u32 s30, s26, 0
    buffer_load_dwordx4 v11, s[8:11], s30 offen lds
    s_add_u32 m0, s29, 24576
    s_add_u32 s30, s26, 114688
    buffer_load_dwordx4 v11, s[8:11], s30 offen lds
    s_add_u32 s26, s26, 229376
    s_add_u32 m0, s29, 32768
    s_add_u32 s30, s27, 0
    buffer_load_dwordx4 v11, s[12:15], s30 offen lds
    s_add_u32 m0, s29, 40960
    s_add_u32 s30, s27, 114688
    buffer_load_dwordx4 v11, s[12:15], s30 offen lds
    s_add_u32 s27, s27, 229376
    s_add_u32 m0, s29, 49152
    s_add_u32 s30, s25, 0
    buffer_load_dwordx4 v10, s[4:7], s30 offen lds
    s_add_u32 m0, s29, 57344
    s_add_u32 s30, s25, 65536
    buffer_load_dwordx4 v10, s[4:7], s30 offen lds
    s_add_u32 s25, s25, 128
    s_add_u32 m0, s29, 65536
    s_add_u32 s30, s26, 0
    buffer_load_dwordx4 v11, s[8:11], s30 offen lds
    s_add_u32 m0, s29, 73728
    s_add_u32 s30, s26, 114688
    buffer_load_dwordx4 v11, s[8:11], s30 offen lds
    s_add_u32 s26, s26, 229376
    s_add_u32 m0, s29, 81920
    s_add_u32 s30, s27, 0
    buffer_load_dwordx4 v11, s[12:15], s30 offen lds
    s_add_u32 m0, s29, 90112
    s_add_u32 s30, s27, 114688
    buffer_load_dwordx4 v11, s[12:15], s30 offen lds
    s_add_u32 s27, s27, 229376
    v_and_b32 v2, 31, v1
    s_mul_i32 s30, s32, 64
    v_add_u32 v2, s30, v2
    v_bfe_u32 v3, v2, 1, 3
    v_lshrrev_b32 v4, 5, v1
    v_xor_b32 v3, v3, v4
    v_lshlrev_b32 v2, 7, v2
    v_xor_b32 v5, 0, v3
    v_lshl_add_u32 v16, v5, 4, v2
    v_xor_b32 v5, 2, v3
    v_lshl_add_u32 v17, v5, 4, v2
    v_xor_b32 v5, 4, v3
    v_lshl_add_u32 v18, v5, 4, v2
    v_xor_b32 v5, 6, v3
    v_lshl_add_u32 v19, v5, 4, v2
    v_and_b32 v2, 15, v1
    v_lshrrev_b32 v3, 2, v2
    v_and_b32 v4, 3, v2
    v_lshrrev_b32 v5, 5, v1
    v_lshl_add_u32 v5, v5, 3, v3
    v_lshlrev_b32 v5, 8, v5
    v_and_b32 v6, 1, v4
    v_lshl_add_u32 v5, v6, 3, v5
    v_lshrrev_b32 v6, 1, v4
    v_bfe_u32 v7, v1, 4, 1
    v_lshl_add_u32 v6, v7, 1, v6
    v_lshl_add_u32 v5, v6, 4, v5
    s_mul_i32 s30, s33, 1
    s_add_u32 s30, s30, 0
    v_xor_b32 v6, s30, v3
    v_lshl_add_u32 v6, v6, 6, v5
    v_add_u32 v12, 16384, v6
    s_mul_i32 s30, s33, 1
    s_add_u32 s30, s30, 0
    v_xor_b32 v6, s30, v3
    v_lshl_add_u32 v6, v6, 6, v5
    v_add_u32 v13, 32768, v6
    s_waitcnt vmcnt(6)
    s_barrier
    ds_read_b64_tr_b16 v[20:21], v12 offset:0
    ds_read_b64_tr_b16 v[22:23], v12 offset:1024
    ds_read_b64_tr_b16 v[24:25], v13 offset:0
    ds_read_b64_tr_b16 v[26:27], v13 offset:1024
    ds_read_b128 v[36:39], v16 offset:0
    ds_read_b128 v[40:43], v16 offset:4096
    ds_read_b64_tr_b16 v[28:29], v12 offset:4096
    ds_read_b64_tr_b16 v[30:31], v12 offset:5120
    ds_read_b64_tr_b16 v[32:33], v13 offset:4096
    ds_read_b64_tr_b16 v[34:35], v13 offset:5120
    ds_read_b128 v[44:47], v17 offset:0
    ds_read_b128 v[48:51], v17 offset:4096
    s_waitcnt lgkmcnt(6)
    v_mfma_f32_32x32x16_bf16 v[52:67], v[20:23], v[36:39], 0
    v_mfma_f32_32x32x16_bf16 v[68:83], v[20:23], v[40:43], 0
    s_add_u32 m0, s29, 98304
    s_add_u32 s30, s25, 0
    buffer_load_dwordx4 v10, s[4:7], s30 offen lds
    v_mfma_f32_32x32x16_bf16 v[84:99], v[24:27], v[36:39], 0
    v_mfma_f32_32x32x16_bf16 v[100:115], v[24:27], v[40:43], 0
    s_add_u32 m0, s29, 106496
    s_add_u32 s30, s25, 65536
    buffer_load_dwordx4 v10, s[4:7], s30 offen lds
    s_add_u32 s25, s25, 128
    ds_read_b64_tr_b16 v[20:21], v12 offset:8192
    ds_read_b64_tr_b16 v[22:23], v12 offset:9216
    ds_read_b64_tr_b16 v[24:25], v13 offset:8192
    ds_read_b64_tr_b16 v[26:27], v13 offset:9216
    ds_read_b128 v[36:39], v18 offset:0
    ds_read_b128 v[40:43], v18 offset:4096
    s_waitcnt lgkmcnt(6)
    v_mfma_f32_32x32x16_bf16 v[52:67], v[28:31], v[44:47], v[52:67]
    v_mfma_f32_32x32x16_bf16 v[68:83], v[28:31], v[48:51], v[68:83]
    s_add_u32 m0, s29, 114688
    s_add_u32 s30, s26, 0
    buffer_load_dwordx4 v11, s[8:11], s30 offen lds
    v_mfma_f32_32x32x16_bf16 v[84:99], v[32:35], v[44:47], v[84:99]
    v_mfma_f32_32x32x16_bf16 v[100:115], v[32:35], v[48:51], v[100:115]
    s_add_u32 m0, s29, 122880
    s_add_u32 s30, s26, 114688
    buffer_load_dwordx4 v11, s[8:11], s30 offen lds
    s_add_u32 s26, s26, 229376
    ds_read_b64_tr_b16 v[28:29], v12 offset:12288
    ds_read_b64_tr_b16 v[30:31], v12 offset:13312
    ds_read_b64_tr_b16 v[32:33], v13 offset:12288
    ds_read_b64_tr_b16 v[34:35], v13 offset:13312
    ds_read_b128 v[44:47], v19 offset:0
    ds_read_b128 v[48:51], v19 offset:4096
    s_waitcnt lgkmcnt(6)
    v_mfma_f32_32x32x16_bf16 v[52:67], v[20:23], v[36:39], v[52:67]
    v_mfma_f32_32x32x16_bf16 v[68:83], v[20:23], v[40:43], v[68:83]
    s_add_u32 m0, s29, 131072
    s_add_u32 s30, s27, 0
    buffer_load_dwordx4 v11, s[12:15], s30 offen lds
    v_mfma_f32_32x32x16_bf16 v[84:99], v[24:27], v[36:39], v[84:99]
    v_mfma_f32_32x32x16_bf16 v[100:115], v[24:27], v[40:43], v[100:115]
    s_add_u32 m0, s29, 139264
    s_add_u32 s30, s27, 114688
    buffer_load_dwordx4 v11, s[12:15], s30 offen lds
    s_add_u32 s27, s27, 229376
    s_waitcnt lgkmcnt(0)
    v_add_u32 v12, 49152, v12
    v_add_u32 v13, 49152, v13
    v_add_u32 v16, 49152, v16
    v_add_u32 v17, 49152, v17
    v_add_u32 v18, 49152, v18
    v_add_u32 v19, 49152, v19
    v_mfma_f32_32x32x16_bf16 v[52:67], v[28:31], v[44:47], v[52:67]
    v_mfma_f32_32x32x16_bf16 v[68:83], v[28:31], v[48:51], v[68:83]
    s_waitcnt vmcnt(6)
    s_barrier
    ds_read_b64_tr_b16 v[20:21], v12 offset:0
    ds_read_b64_tr_b16 v[22:23], v12 offset:1024
    ds_read_b64_tr_b16 v[24:25], v13 offset:0
    ds_read_b64_tr_b16 v[26:27], v13 offset:1024
    ds_read_b128 v[36:39], v16 offset:0
    ds_read_b128 v[40:43], v16 offset:4096
    v_mfma_f32_32x32x16_bf16 v[84:99], v[32:35], v[44:47], v[84:99]
    v_mfma_f32_32x32x16_bf16 v[100:115], v[32:35], v[48:51], v[100:115]
    ds_read_b64_tr_b16 v[28:29], v12 offset:4096
    ds_read_b64_tr_b16 v[30:31], v12 offset:5120
    ds_read_b64_tr_b16 v[32:33], v13 offset:4096
    ds_read_b64_tr_b16 v[34:35], v13 offset:5120
    ds_read_b128 v[44:47], v17 offset:0
    ds_read_b128 v[48:51], v17 offset:4096
    s_waitcnt lgkmcnt(6)
    v_mfma_f32_32x32x16_bf16 v[52:67], v[20:23], v[36:39], v[52:67]
    v_mfma_f32_32x32x16_bf16 v[68:83], v[20:23], v[40:43], v[68:83]
    s_add_u32 m0, s29, 0
    s_add_u32 s30, s25, 0
    buffer_load_dwordx4 v10, s[4:7], s30 offen lds
    v_mfma_f32_32x32x16_bf16 v[84:99], v[24:27], v[36:39], v[84:99]
    v_mfma_f32_32x32x16_bf16 v[100:115], v[24:27], v[40:43], v[100:115]
    s_add_u32 m0, s29, 8192
    s_add_u32 s30, s25, 65536
    buffer_load_dwordx4 v10, s[4:7], s30 offen lds
    s_add_u32 s25, s25, 128
    ds_read_b64_tr_b16 v[20:21], v12 offset:8192
    ds_read_b64_tr_b16 v[22:23], v12 offset:9216
    ds_read_b64_tr_b16 v[24:25], v13 offset:8192
    ds_read_b64_tr_b16 v[26:27], v13 offset:9216
    ds_read_b128 v[36:39], v18 offset:0
    ds_read_b128 v[40:43], v18 offset:4096
    s_waitcnt lgkmcnt(6)
    v_mfma_f32_32x32x16_bf16 v[52:67], v[28:31], v[44:47], v[52:67]
    v_mfma_f32_32x32x16_bf16 v[68:83], v[28:31], v[48:51], v[68:83]
    s_add_u32 m0, s29, 16384
    s_add_u32 s30, s26, 0
    buffer_load_dwordx4 v11, s[8:11], s30 offen lds
    v_mfma_f32_32x32x16_bf16 v[84:99], v[32:35], v[44:47], v[84:99]
    v_mfma_f32_32x32x16_bf16 v[100:115], v[32:35], v[48:51], v[100:115]
    s_add_u32 m0, s29, 24576
    s_add_u32 s30, s26, 114688
    buffer_load_dwordx4 v11, s[8:11], s30 offen lds
    s_add_u32 s26, s26, 229376
    ds_read_b64_tr_b16 v[28:29], v12 offset:12288
    ds_read_b64_tr_b16 v[30:31], v12 offset:13312
    ds_read_b64_tr_b16 v[32:33], v13 offset:12288
    ds_read_b64_tr_b16 v[34:35], v13 offset:13312
    ds_read_b128 v[44:47], v19 offset:0
    ds_read_b128 v[48:51], v19 offset:4096
    s_waitcnt lgkmcnt(6)
    v_mfma_f32_32x32x16_bf16 v[52:67], v[20:23], v[36:39], v[52:67]
    v_mfma_f32_32x32x16_bf16 v[68:83], v[20:23], v[40:43], v[68:83]
    s_add_u32 m0, s29, 32768
    s_add_u32 s30, s27, 0
    buffer_load_dwordx4 v11, s[12:15], s30 offen lds
    v_mfma_f32_32x32x16_bf16 v[84:99], v[24:27], v[36:39], v[84:99]
    v_mfma_f32_32x32x16_bf16 v[100:115], v[24:27], v[40:43], v[100:115]
    s_add_u32 m0, s29, 40960
    s_add_u32 s30, s27, 114688
    buffer_load_dwordx4 v11, s[12:15], s30 offen lds
    s_add_u32 s27, s27, 229376
    s_waitcnt lgkmcnt(0)
    v_add_u32 v12, 49152, v12
    v_add_u32 v13, 49152, v13
    v_add_u32 v16, 49152, v16
    v_add_u32 v17, 49152, v17
    v_add_u32 v18, 49152, v18
    v_add_u32 v19, 49152, v19
    v_mfma_f32_32x32x16_bf16 v[52:67], v[28:31], v[44:47], v[52:67]
    v_mfma_f32_32x32x16_bf16 v[68:83], v[28:31], v[48:51], v[68:83]
    s_waitcnt vmcnt(6)
    s_barrier
    ds_read_b64_tr_b16 v[20:21], v12 offset:0
    ds_read_b64_tr_b16 v[22:23], v12 offset:1024
    ds_read_b64_tr_b16 v[24:25], v13 offset:0
    ds_read_b64_tr_b16 v[26:27], v13 offset:1024
    ds_read_b128 v[36:39], v16 offset:0
    ds_read_b128 v[40:43], v16 offset:4096
    v_mfma_f32_32x32x16_bf16 v[84:99], v[32:35], v[44:47], v[84:99]
    v_mfma_f32_32x32x16_bf16 v[100:115], v[32:35], v[48:51], v[100:115]
    ds_read_b64_tr_b16 v[28:29], v12 offset:4096
    ds_read_b64_tr_b16 v[30:31], v12 offset:5120
    ds_read_b64_tr_b16 v[32:33], v13 offset:4096
    ds_read_b64_tr_b16 v[34:35], v13 offset:5120
    ds_read_b128 v[44:47], v17 offset:0
    ds_read_b128 v[48:51], v17 offset:4096
    s_waitcnt lgkmcnt(6)
    v_mfma_f32_32x32x16_bf16 v[52:67], v[20:23], v[36:39], v[52:67]
    v_mfma_f32_32x32x16_bf16 v[68:83], v[20:23], v[40:43], v[68:83]
    s_add_u32 m0, s29, 49152
    s_add_u32 s30, s25, 0
    buffer_load_dwordx4 v10, s[4:7], s30 offen lds
    v_mfma_f32_32x32x16_bf16 v[84:99], v[24:27], v[36:39], v[84:99]
    v_mfma_f32_32x32x16_bf16 v[100:115], v[24:27], v[40:43], v[100:115]
    s_add_u32 m0, s29, 57344
    s_add_u32 s30, s25, 65536
    buffer_load_dwordx4 v10, s[4:7], s30 offen lds
    s_add_u32 s25, s25, 128
    ds_read_b64_tr_b16 v[20:21], v12 offset:8192
    ds_read_b64_tr_b16 v[22:23], v12 offset:9216
    ds_read_b64_tr_b16 v[24:25], v13 offset:8192
    ds_read_b64_tr_b16 v[26:27], v13 offset:9216
    ds_read_b128 v[36:39], v18 offset:0
    ds_read_b128 v[40:43], v18 offset:4096
    s_waitcnt lgkmcnt(6)
    v_mfma_f32_32x32x16_bf16 v[52:67], v[28:31], v[44:47], v[52:67]
    v_mfma_f32_32x32x16_bf16 v[68:83], v[28:31], v[48:51], v[68:83]
    s_add_u32 m0, s29, 65536
    s_add_u32 s30, s26, 0
    buffer_load_dwordx4 v11, s[8:11], s30 offen lds
    v_mfma_f32_32x32x16_bf16 v[84:99], v[32:35], v[44:47], v[84:99]
    v_mfma_f32_32x32x16_bf16 v[100:115], v[32:35], v[48:51], v[100:115]
    s_add_u32 m0, s29, 73728
    s_add_u32 s30, s26, 114688
    buffer_load_dwordx4 v11, s[8:11], s30 offen lds
    s_add_u32 s26, s26, 229376
    ds_read_b64_tr_b16 v[28:29], v12 offset:12288
    ds_read_b64_tr_b16 v[30:31], v12 offset:13312
    ds_read_b64_tr_b16 v[32:33], v13 offset:12288
    ds_read_b64_tr_b16 v[34:35], v13 offset:13312
    ds_read_b128 v[44:47], v19 offset:0
    ds_read_b128 v[48:51], v19 offset:4096
    s_waitcnt lgkmcnt(6)
    v_mfma_f32_32x32x16_bf16 v[52:67], v[20:23], v[36:39], v[52:67]
    v_mfma_f32_32x32x16_bf16 v[68:83], v[20:23], v[40:43], v[68:83]
    s_add_u32 m0, s29, 81920
    s_add_u32 s30, s27, 0
    buffer_load_dwordx4 v11, s[12:15], s30 offen lds
    v_mfma_f32_32x32x16_bf16 v[84:99], v[24:27], v[36:39], v[84:99]
    v_mfma_f32_32x32x16_bf16 v[100:115], v[24:27], v[40:43], v[100:115]
    s_add_u32 m0, s29, 90112
    s_add_u32 s30, s27, 114688
    buffer_load_dwordx4 v11, s[12:15], s30 offen lds
    s_add_u32 s27, s27, 229376
    s_waitcnt lgkmcnt(0)
    v_add_u32 v12, 4294868992, v12
    v_add_u32 v13, 4294868992, v13
    v_add_u32 v16, 4294868992, v16
    v_add_u32 v17, 4294868992, v17
    v_add_u32 v18, 4294868992, v18
    v_add_u32 v19, 4294868992, v19
    v_mfma_f32_32x32x16_bf16 v[52:67], v[28:31], v[44:47], v[52:67]
    v_mfma_f32_32x32x16_bf16 v[68:83], v[28:31], v[48:51], v[68:83]
    s_waitcnt vmcnt(6)
    s_barrier
    ds_read_b64_tr_b16 v[20:21], v12 offset:0
    ds_read_b64_tr_b16 v[22:23], v12 offset:1024
    ds_read_b64_tr_b16 v[24:25], v13 offset:0
    ds_read_b64_tr_b16 v[26:27], v13 offset:1024
    ds_read_b128 v[36:39], v16 offset:0
    ds_read_b128 v[40:43], v16 offset:4096
    v_mfma_f32_32x32x16_bf16 v[84:99], v[32:35], v[44:47], v[84:99]
    v_mfma_f32_32x32x16_bf16 v[100:115], v[32:35], v[48:51], v[100:115]
    ds_read_b64_tr_b16 v[28:29], v12 offset:4096
    ds_read_b64_tr_b16 v[30:31], v12 offset:5120
    ds_read_b64_tr_b16 v[32:33], v13 offset:4096
    ds_read_b64_tr_b16 v[34:35], v13 offset:5120
    ds_read_b128 v[44:47], v17 offset:0
    ds_read_b128 v[48:51], v17 offset:4096
    s_waitcnt lgkmcnt(6)
    v_mfma_f32_32x32x16_bf16 v[52:67], v[20:23], v[36:39], v[52:67]
    v_mfma_f32_32x32x16_bf16 v[68:83], v[20:23], v[40:43], v[68:83]
    s_add_u32 m0, s29, 98304
    s_add_u32 s30, s25, 0
    buffer_load_dwordx4 v10, s[4:7], s30 offen lds
    v_mfma_f32_32x32x16_bf16 v[84:99], v[24:27], v[36:39], v[84:99]
    v_mfma_f32_32x32x16_bf16 v[100:115], v[24:27], v[40:43], v[100:115]
    s_add_u32 m0, s29, 106496
    s_add_u32 s30, s25, 65536
    buffer_load_dwordx4 v10, s[4:7], s30 offen lds
    s_add_u32 s25, s25, 128
    ds_read_b64_tr_b16 v[20:21], v12 offset:8192
    ds_read_b64_tr_b16 v[22:23], v12 offset:9216
    ds_read_b64_tr_b16 v[24:25], v13 offset:8192
    ds_read_b64_tr_b16 v[26:27], v13 offset:9216
    ds_read_b128 v[36:39], v18 offset:0
    ds_read_b128 v[40:43], v18 offset:4096
    s_waitcnt lgkmcnt(6)
    v_mfma_f32_32x32x16_bf16 v[52:67], v[28:31], v[44:47], v[52:67]
    v_mfma_f32_32x32x16_bf16 v[68:83], v[28:31], v[48:51], v[68:83]
    s_add_u32 m0, s29, 114688
    s_add_u32 s30, s26, 0
    buffer_load_dwordx4 v11, s[8:11], s30 offen lds
    v_mfma_f32_32x32x16_bf16 v[84:99], v[32:35], v[44:47], v[84:99]
    v_mfma_f32_32x32x16_bf16 v[100:115], v[32:35], v[48:51], v[100:115]
    s_add_u32 m0, s29, 122880
    s_add_u32 s30, s26, 114688
    buffer_load_dwordx4 v11, s[8:11], s30 offen lds
    s_add_u32 s26, s26, 229376
    ds_read_b64_tr_b16 v[28:29], v12 offset:12288
    ds_read_b64_tr_b16 v[30:31], v12 offset:13312
    ds_read_b64_tr_b16 v[32:33], v13 offset:12288
    ds_read_b64_tr_b16 v[34:35], v13 offset:13312
    ds_read_b128 v[44:47], v19 offset:0
    ds_read_b128 v[48:51], v19 offset:4096
    s_waitcnt lgkmcnt(6)
    v_mfma_f32_32x32x16_bf16 v[52:67], v[20:23], v[36:39], v[52:67]
    v_mfma_f32_32x32x16_bf16 v[68:83], v[20:23], v[40:43], v[68:83]
    s_add_u32 m0, s29, 131072
    s_add_u32 s30, s27, 0
    buffer_load_dwordx4 v11, s[12:15], s30 offen lds
    v_mfma_f32_32x32x16_bf16 v[84:99], v[24:27], v[36:39], v[84:99]
    v_mfma_f32_32x32x16_bf16 v[100:115], v[24:27], v[40:43], v[100:115]
    s_add_u32 m0, s29, 139264
    s_add_u32 s30, s27, 114688
    buffer_load_dwordx4 v11, s[12:15], s30 offen lds
    s_add_u32 s27, s27, 229376
    s_waitcnt lgkmcnt(0)
    v_add_u32 v12, 49152, v12
    v_add_u32 v13, 49152, v13
    v_add_u32 v16, 49152, v16
    v_add_u32 v17, 49152, v17
    v_add_u32 v18, 49152, v18
    v_add_u32 v19, 49152, v19
    v_mfma_f32_32x32x16_bf16 v[52:67], v[28:31], v[44:47], v[52:67]
    v_mfma_f32_32x32x16_bf16 v[68:83], v[28:31], v[48:51], v[68:83]
    s_waitcnt vmcnt(6)
    s_barrier
    ds_read_b64_tr_b16 v[20:21], v12 offset:0
    ds_read_b64_tr_b16 v[22:23], v12 offset:1024
    ds_read_b64_tr_b16 v[24:25], v13 offset:0
    ds_read_b64_tr_b16 v[26:27], v13 offset:1024
    ds_read_b128 v[36:39], v16 offset:0
    ds_read_b128 v[40:43], v16 offset:4096
    v_mfma_f32_32x32x16_bf16 v[84:99], v[32:35], v[44:47], v[84:99]
    v_mfma_f32_32x32x16_bf16 v[100:115], v[32:35], v[48:51], v[100:115]
    ds_read_b64_tr_b16 v[28:29], v12 offset:4096
    ds_read_b64_tr_b16 v[30:31], v12 offset:5120
    ds_read_b64_tr_b16 v[32:33], v13 offset:4096
    ds_read_b64_tr_b16 v[34:35], v13 offset:5120
    ds_read_b128 v[44:47], v17 offset:0
    ds_read_b128 v[48:51], v17 offset:4096
    s_waitcnt lgkmcnt(6)
    v_mfma_f32_32x32x16_bf16 v[52:67], v[20:23], v[36:39], v[52:67]
    v_mfma_f32_32x32x16_bf16 v[68:83], v[20:23], v[40:43], v[68:83]
    s_add_u32 m0, s29, 0
    s_add_u32 s30, s25, 0
    buffer_load_dwordx4 v10, s[4:7], s30 offen lds
    v_mfma_f32_32x32x16_bf16 v[84:99], v[24:27], v[36:39], v[84:99]
    v_mfma_f32_32x32x16_bf16 v[100:115], v[24:27], v[40:43], v[100:115]
    s_add_u32 m0, s29, 8192
    s_add_u32 s30, s25, 65536
    buffer_load_dwordx4 v10, s[4:7], s30 offen lds
    s_add_u32 s25, s25, 128
    ds_read_b64_tr_b16 v[20:21], v12 offset:8192
    ds_read_b64_tr_b16 v[22:23], v12 offset:9216
    ds_read_b64_tr_b16 v[24:25], v13 offset:8192
    ds_read_b64_tr_b16 v[26:27], v13 offset:9216
    ds_read_b128 v[36:39], v18 offset:0
    ds_read_b128 v[40:43], v18 offset:4096
    s_waitcnt lgkmcnt(6)
    v_mfma_f32_32x32x16_bf16 v[52:67], v[28:31], v[44:47], v[52:67]
    v_mfma_f32_32x32x16_bf16 v[68:83], v[28:31], v[48:51], v[68:83]
    s_add_u32 m0, s29, 16384
    s_add_u32 s30, s26, 0
    buffer_load_dwordx4 v11, s[8:11], s30 offen lds
    v_mfma_f32_32x32x16_bf16 v[84:99], v[32:35], v[44:47], v[84:99]
    v_mfma_f32_32x32x16_bf16 v[100:115], v[32:35], v[48:51], v[100:115]
    s_add_u32 m0, s29, 24576
    s_add_u32 s30, s26, 114688
    buffer_load_dwordx4 v11, s[8:11], s30 offen lds
    s_add_u32 s26, s26, 229376
    ds_read_b64_tr_b16 v[28:29], v12 offset:12288
    ds_read_b64_tr_b16 v[30:31], v12 offset:13312
    ds_read_b64_tr_b16 v[32:33], v13 offset:12288
    ds_read_b64_tr_b16 v[34:35], v13 offset:13312
    ds_read_b128 v[44:47], v19 offset:0
    ds_read_b128 v[48:51], v19 offset:4096
    s_waitcnt lgkmcnt(6)
    v_mfma_f32_32x32x16_bf16 v[52:67], v[20:23], v[36:39], v[52:67]
    v_mfma_f32_32x32x16_bf16 v[68:83], v[20:23], v[40:43], v[68:83]
    s_add_u32 m0, s29, 32768
    s_add_u32 s30, s27, 0
    buffer_load_dwordx4 v11, s[12:15], s30 offen lds
    v_mfma_f32_32x32x16_bf16 v[84:99], v[24:27], v[36:39], v[84:99]
    v_mfma_f32_32x32x16_bf16 v[100:115], v[24:27], v[40:43], v[100:115]
    s_add_u32 m0, s29, 40960
    s_add_u32 s30, s27, 114688
    buffer_load_dwordx4 v11, s[12:15], s30 offen lds
    s_add_u32 s27, s27, 229376
    s_waitcnt lgkmcnt(0)
    v_add_u32 v12, 49152, v12
    v_add_u32 v13, 49152, v13
    v_add_u32 v16, 49152, v16
    v_add_u32 v17, 49152, v17
    v_add_u32 v18, 49152, v18
    v_add_u32 v19, 49152, v19
    v_mfma_f32_32x32x16_bf16 v[52:67], v[28:31], v[44:47], v[52:67]
    v_mfma_f32_32x32x16_bf16 v[68:83], v[28:31], v[48:51], v[68:83]
    s_waitcnt vmcnt(6)
    s_barrier
    ds_read_b64_tr_b16 v[20:21], v12 offset:0
    ds_read_b64_tr_b16 v[22:23], v12 offset:1024
    ds_read_b64_tr_b16 v[24:25], v13 offset:0
    ds_read_b64_tr_b16 v[26:27], v13 offset:1024
    ds_read_b128 v[36:39], v16 offset:0
    ds_read_b128 v[40:43], v16 offset:4096
    v_mfma_f32_32x32x16_bf16 v[84:99], v[32:35], v[44:47], v[84:99]
    v_mfma_f32_32x32x16_bf16 v[100:115], v[32:35], v[48:51], v[100:115]
    ds_read_b64_tr_b16 v[28:29], v12 offset:4096
    ds_read_b64_tr_b16 v[30:31], v12 offset:5120
    ds_read_b64_tr_b16 v[32:33], v13 offset:4096
    ds_read_b64_tr_b16 v[34:35], v13 offset:5120
    ds_read_b128 v[44:47], v17 offset:0
    ds_read_b128 v[48:51], v17 offset:4096
    s_waitcnt lgkmcnt(6)
    v_mfma_f32_32x32x16_bf16 v[52:67], v[20:23], v[36:39], v[52:67]
    v_mfma_f32_32x32x16_bf16 v[68:83], v[20:23], v[40:43], v[68:83]
    s_add_u32 m0, s29, 49152
    s_add_u32 s30, s25, 0
    buffer_load_dwordx4 v10, s[4:7], s30 offen lds
    v_mfma_f32_32x32x16_bf16 v[84:99], v[24:27], v[36:39], v[84:99]
    v_mfma_f32_32x32x16_bf16 v[100:115], v[24:27], v[40:43], v[100:115]
    s_add_u32 m0, s29, 57344
    s_add_u32 s30, s25, 65536
    buffer_load_dwordx4 v10, s[4:7], s30 offen lds
    s_add_u32 s25, s25, 128
    ds_read_b64_tr_b16 v[20:21], v12 offset:8192
    ds_read_b64_tr_b16 v[22:23], v12 offset:9216
    ds_read_b64_tr_b16 v[24:25], v13 offset:8192
    ds_read_b64_tr_b16 v[26:27], v13 offset:9216
    ds_read_b128 v[36:39], v18 offset:0
    ds_read_b128 v[40:43], v18 offset:4096
    s_waitcnt lgkmcnt(6)
    v_mfma_f32_32x32x16_bf16 v[52:67], v[28:31], v[44:47], v[52:67]
    v_mfma_f32_32x32x16_bf16 v[68:83], v[28:31], v[48:51], v[68:83]
    s_add_u32 m0, s29, 65536
    s_add_u32 s30, s26, 0
    buffer_load_dwordx4 v11, s[8:11], s30 offen lds
    v_mfma_f32_32x32x16_bf16 v[84:99], v[32:35], v[44:47], v[84:99]
    v_mfma_f32_32x32x16_bf16 v[100:115], v[32:35], v[48:51], v[100:115]
    s_add_u32 m0, s29, 73728
    s_add_u32 s30, s26, 114688
    buffer_load_dwordx4 v11, s[8:11], s30 offen lds
    s_add_u32 s26, s26, 229376
    ds_read_b64_tr_b16 v[28:29], v12 offset:12288
    ds_read_b64_tr_b16 v[30:31], v12 offset:13312
    ds_read_b64_tr_b16 v[32:33], v13 offset:12288
    ds_read_b64_tr_b16 v[34:35], v13 offset:13312
    ds_read_b128 v[44:47], v19 offset:0
    ds_read_b128 v[48:51], v19 offset:4096
    s_waitcnt lgkmcnt(6)
    v_mfma_f32_32x32x16_bf16 v[52:67], v[20:23], v[36:39], v[52:67]
    v_mfma_f32_32x32x16_bf16 v[68:83], v[20:23], v[40:43], v[68:83]
    s_add_u32 m0, s29, 81920
    s_add_u32 s30, s27, 0
    buffer_load_dwordx4 v11, s[12:15], s30 offen lds
    v_mfma_f32_32x32x16_bf16 v[84:99], v[24:27], v[36:39], v[84:99]
    v_mfma_f32_32x32x16_bf16 v[100:115], v[24:27], v[40:43], v[100:115]
    s_add_u32 m0, s29, 90112
    s_add_u32 s30, s27, 114688
    buffer_load_dwordx4 v11, s[12:15], s30 offen lds
    s_add_u32 s27, s27, 229376
    s_waitcnt lgkmcnt(0)
    v_add_u32 v12, 4294868992, v12
    v_add_u32 v13, 4294868992, v13
    v_add_u32 v16, 4294868992, v16
    v_add_u32 v17, 4294868992, v17
    v_add_u32 v18, 4294868992, v18
    v_add_u32 v19, 4294868992, v19
    v_mfma_f32_32x32x16_bf16 v[52:67], v[28:31], v[44:47], v[52:67]
    v_mfma_f32_32x32x16_bf16 v[68:83], v[28:31], v[48:51], v[68:83]
    s_waitcnt vmcnt(6)
    s_barrier
    ds_read_b64_tr_b16 v[20:21], v12 offset:0
    ds_read_b64_tr_b16 v[22:23], v12 offset:1024
    ds_read_b64_tr_b16 v[24:25], v13 offset:0
    ds_read_b64_tr_b16 v[26:27], v13 offset:1024
    ds_read_b128 v[36:39], v16 offset:0
    ds_read_b128 v[40:43], v16 offset:4096
    v_mfma_f32_32x32x16_bf16 v[84:99], v[32:35], v[44:47], v[84:99]
    v_mfma_f32_32x32x16_bf16 v[100:115], v[32:35], v[48:51], v[100:115]
    ds_read_b64_tr_b16 v[28:29], v12 offset:4096
    ds_read_b64_tr_b16 v[30:31], v12 offset:5120
    ds_read_b64_tr_b16 v[32:33], v13 offset:4096
    ds_read_b64_tr_b16 v[34:35], v13 offset:5120
    ds_read_b128 v[44:47], v17 offset:0
    ds_read_b128 v[48:51], v17 offset:4096
    s_waitcnt lgkmcnt(6)
    v_mfma_f32_32x32x16_bf16 v[52:67], v[20:23], v[36:39], v[52:67]
    v_mfma_f32_32x32x16_bf16 v[68:83], v[20:23], v[40:43], v[68:83]
    v_mfma_f32_32x32x16_bf16 v[84:99], v[24:27], v[36:39], v[84:99]
    v_mfma_f32_32x32x16_bf16 v[100:115], v[24:27], v[40:43], v[100:115]
    ds_read_b64_tr_b16 v[20:21], v12 offset:8192
    ds_read_b64_tr_b16 v[22:23], v12 offset:9216
    ds_read_b64_tr_b16 v[24:25], v13 offset:8192
    ds_read_b64_tr_b16 v[26:27], v13 offset:9216
    ds_read_b128 v[36:39], v18 offset:0
    ds_read_b128 v[40:43], v18 offset:4096
    s_waitcnt lgkmcnt(6)
    v_mfma_f32_32x32x16_bf16 v[52:67], v[28:31], v[44:47], v[52:67]
    v_mfma_f32_32x32x16_bf16 v[68:83], v[28:31], v[48:51], v[68:83]
    v_mfma_f32_32x32x16_bf16 v[84:99], v[32:35], v[44:47], v[84:99]
    v_mfma_f32_32x32x16_bf16 v[100:115], v[32:35], v[48:51], v[100:115]
    ds_read_b64_tr_b16 v[28:29], v12 offset:12288
    ds_read_b64_tr_b16 v[30:31], v12 offset:13312
    ds_read_b64_tr_b16 v[32:33], v13 offset:12288
    ds_read_b64_tr_b16 v[34:35], v13 offset:13312
    ds_read_b128 v[44:47], v19 offset:0
    ds_read_b128 v[48:51], v19 offset:4096
    s_waitcnt lgkmcnt(6)
    v_mfma_f32_32x32x16_bf16 v[52:67], v[20:23], v[36:39], v[52:67]
    v_mfma_f32_32x32x16_bf16 v[68:83], v[20:23], v[40:43], v[68:83]
    v_mfma_f32_32x32x16_bf16 v[84:99], v[24:27], v[36:39], v[84:99]
    v_mfma_f32_32x32x16_bf16 v[100:115], v[24:27], v[40:43], v[100:115]
    s_waitcnt lgkmcnt(0)
    v_add_u32 v12, 49152, v12
    v_add_u32 v13, 49152, v13
    v_add_u32 v16, 49152, v16
    v_add_u32 v17, 49152, v17
    v_add_u32 v18, 49152, v18
    v_add_u32 v19, 49152, v19
    v_mfma_f32_32x32x16_bf16 v[52:67], v[28:31], v[44:47], v[52:67]
    v_mfma_f32_32x32x16_bf16 v[68:83], v[28:31], v[48:51], v[68:83]
    s_waitcnt vmcnt(0)
    s_barrier
    ds_read_b64_tr_b16 v[20:21], v12 offset:0
    ds_read_b64_tr_b16 v[22:23], v12 offset:1024
    ds_read_b64_tr_b16 v[24:25], v13 offset:0
    ds_read_b64_tr_b16 v[26:27], v13 offset:1024
    ds_read_b128 v[36:39], v16 offset:0
    ds_read_b128 v[40:43], v16 offset:4096
    v_mfma_f32_32x32x16_bf16 v[84:99], v[32:35], v[44:47], v[84:99]
    v_mfma_f32_32x32x16_bf16 v[100:115], v[32:35], v[48:51], v[100:115]
    ds_read_b64_tr_b16 v[28:29], v12 offset:4096
    ds_read_b64_tr_b16 v[30:31], v12 offset:5120
    ds_read_b64_tr_b16 v[32:33], v13 offset:4096
    ds_read_b64_tr_b16 v[34:35], v13 offset:5120
    ds_read_b128 v[44:47], v17 offset:0
    ds_read_b128 v[48:51], v17 offset:4096
    s_waitcnt lgkmcnt(6)
    v_mfma_f32_32x32x16_bf16 v[52:67], v[20:23], v[36:39], v[52:67]
    v_mfma_f32_32x32x16_bf16 v[68:83], v[20:23], v[40:43], v[68:83]
    v_mfma_f32_32x32x16_bf16 v[84:99], v[24:27], v[36:39], v[84:99]
    v_mfma_f32_32x32x16_bf16 v[100:115], v[24:27], v[40:43], v[100:115]
    ds_read_b64_tr_b16 v[20:21], v12 offset:8192
    ds_read_b64_tr_b16 v[22:23], v12 offset:9216
    ds_read_b64_tr_b16 v[24:25], v13 offset:8192
    ds_read_b64_tr_b16 v[26:27], v13 offset:9216
    ds_read_b128 v[36:39], v18 offset:0
    ds_read_b128 v[40:43], v18 offset:4096
    s_waitcnt lgkmcnt(6)
    v_mfma_f32_32x32x16_bf16 v[52:67], v[28:31], v[44:47], v[52:67]
    v_mfma_f32_32x32x16_bf16 v[68:83], v[28:31], v[48:51], v[68:83]
    v_mfma_f32_32x32x16_bf16 v[84:99], v[32:35], v[44:47], v[84:99]
    v_mfma_f32_32x32x16_bf16 v[100:115], v[32:35], v[48:51], v[100:115]
    ds_read_b64_tr_b16 v[28:29], v12 offset:12288
    ds_read_b64_tr_b16 v[30:31], v12 offset:13312
    ds_read_b64_tr_b16 v[32:33], v13 offset:12288
    ds_read_b64_tr_b16 v[34:35], v13 offset:13312
    ds_read_b128 v[44:47], v19 offset:0
    ds_read_b128 v[48:51], v19 offset:4096
    s_waitcnt lgkmcnt(6)
    v_mfma_f32_32x32x16_bf16 v[52:67], v[20:23], v[36:39], v[52:67]
    v_mfma_f32_32x32x16_bf16 v[68:83], v[20:23], v[40:43], v[68:83]
    v_mfma_f32_32x32x16_bf16 v[84:99], v[24:27], v[36:39], v[84:99]
    v_mfma_f32_32x32x16_bf16 v[100:115], v[24:27], v[40:43], v[100:115]
    s_waitcnt lgkmcnt(0)
    v_mfma_f32_32x32x16_bf16 v[52:67], v[28:31], v[44:47], v[52:67]
    v_mfma_f32_32x32x16_bf16 v[68:83], v[28:31], v[48:51], v[68:83]
    v_mfma_f32_32x32x16_bf16 v[84:99], v[32:35], v[44:47], v[84:99]
    v_mfma_f32_32x32x16_bf16 v[100:115], v[32:35], v[48:51], v[100:115]
    s_mul_i32 s50, s32, 64
    s_add_u32 s50, s50, s47
    s_mul_i32 s50, s50, 3584
    s_lshl_b32 s51, s33, 5
    s_add_u32 s51, s51, s48
    s_lshl_b32 s51, s51, 1
    s_add_u32 s50, s50, s51
    s_mov_b32 s52, 0xbfb8aa3b
    s_barrier
    v_and_b32 v2, 31, v1
    v_lshlrev_b32 v3, 6, v2
    v_lshrrev_b32 v4, 5, v1
    v_lshl_add_u32 v3, v4, 3, v3
    s_mul_i32 s30, s24, 4096
    v_add_u32 v3, s30, v3
    v_bfe_u32 v4, v2, 2, 2
    v_lshlrev_b32 v4, 4, v4
    v_xor_b32 v5, 0, v4
    v_add_u32 v5, v5, v3
    v_cvt_pk_bf16_f32 v28, v52, v53
    v_cvt_pk_bf16_f32 v29, v84, v85
    v_lshlrev_b32 v52, 16, v28
    v_and_b32 v53, 0xffff0000, v28
    v_mul_f32 v52, s52, v52
    v_mul_f32 v53, s52, v53
    v_exp_f32 v52, v52
    v_exp_f32 v53, v53
    v_lshlrev_b32 v84, 16, v29
    v_and_b32 v85, 0xffff0000, v29
    v_add_f32 v52, 1.0, v52
    v_add_f32 v53, 1.0, v53
    v_rcp_f32 v52, v52
    v_rcp_f32 v53, v53
    s_nop 0
    v_cvt_pk_bf16_f32 v28, v52, v53
    v_lshlrev_b32 v52, 16, v28
    v_and_b32 v53, 0xffff0000, v28
    v_mul_f32 v52, v52, v84
    v_mul_f32 v53, v53, v85
    v_cvt_pk_bf16_f32 v20, v52, v53
    v_cvt_pk_bf16_f32 v28, v54, v55
    v_cvt_pk_bf16_f32 v29, v86, v87
    v_lshlrev_b32 v54, 16, v28
    v_and_b32 v55, 0xffff0000, v28
    v_mul_f32 v54, s52, v54
    v_mul_f32 v55, s52, v55
    v_exp_f32 v54, v54
    v_exp_f32 v55, v55
    v_lshlrev_b32 v86, 16, v29
    v_and_b32 v87, 0xffff0000, v29
    v_add_f32 v54, 1.0, v54
    v_add_f32 v55, 1.0, v55
    v_rcp_f32 v54, v54
    v_rcp_f32 v55, v55
    s_nop 0
    v_cvt_pk_bf16_f32 v28, v54, v55
    v_lshlrev_b32 v54, 16, v28
    v_and_b32 v55, 0xffff0000, v28
    v_mul_f32 v54, v54, v86
    v_mul_f32 v55, v55, v87
    v_cvt_pk_bf16_f32 v21, v54, v55
    ds_write_b64 v5, v[20:21] offset:0
    v_cvt_pk_bf16_f32 v28, v68, v69
    v_cvt_pk_bf16_f32 v29, v100, v101
    v_lshlrev_b32 v68, 16, v28
    v_and_b32 v69, 0xffff0000, v28
    v_mul_f32 v68, s52, v68
    v_mul_f32 v69, s52, v69
    v_exp_f32 v68, v68
    v_exp_f32 v69, v69
    v_lshlrev_b32 v100, 16, v29
    v_and_b32 v101, 0xffff0000, v29
    v_add_f32 v68, 1.0, v68
    v_add_f32 v69, 1.0, v69
    v_rcp_f32 v68, v68
    v_rcp_f32 v69, v69
    s_nop 0
    v_cvt_pk_bf16_f32 v28, v68, v69
    v_lshlrev_b32 v68, 16, v28
    v_and_b32 v69, 0xffff0000, v28
    v_mul_f32 v68, v68, v100
    v_mul_f32 v69, v69, v101
    v_cvt_pk_bf16_f32 v22, v68, v69
    v_cvt_pk_bf16_f32 v28, v70, v71
    v_cvt_pk_bf16_f32 v29, v102, v103
    v_lshlrev_b32 v70, 16, v28
    v_and_b32 v71, 0xffff0000, v28
    v_mul_f32 v70, s52, v70
    v_mul_f32 v71, s52, v71
    v_exp_f32 v70, v70
    v_exp_f32 v71, v71
    v_lshlrev_b32 v102, 16, v29
    v_and_b32 v103, 0xffff0000, v29
    v_add_f32 v70, 1.0, v70
    v_add_f32 v71, 1.0, v71
    v_rcp_f32 v70, v70
    v_rcp_f32 v71, v71
    s_nop 0
    v_cvt_pk_bf16_f32 v28, v70, v71
    v_lshlrev_b32 v70, 16, v28
    v_and_b32 v71, 0xffff0000, v28
    v_mul_f32 v70, v70, v102
    v_mul_f32 v71, v71, v103
    v_cvt_pk_bf16_f32 v23, v70, v71
    ds_write_b64 v5, v[22:23] offset:2048
    v_xor_b32 v5, 16, v4
    v_add_u32 v5, v5, v3
    v_cvt_pk_bf16_f32 v28, v56, v57
    v_cvt_pk_bf16_f32 v29, v88, v89
    v_lshlrev_b32 v56, 16, v28
    v_and_b32 v57, 0xffff0000, v28
    v_mul_f32 v56, s52, v56
    v_mul_f32 v57, s52, v57
    v_exp_f32 v56, v56
    v_exp_f32 v57, v57
    v_lshlrev_b32 v88, 16, v29
    v_and_b32 v89, 0xffff0000, v29
    v_add_f32 v56, 1.0, v56
    v_add_f32 v57, 1.0, v57
    v_rcp_f32 v56, v56
    v_rcp_f32 v57, v57
    s_nop 0
    v_cvt_pk_bf16_f32 v28, v56, v57
    v_lshlrev_b32 v56, 16, v28
    v_and_b32 v57, 0xffff0000, v28
    v_mul_f32 v56, v56, v88
    v_mul_f32 v57, v57, v89
    v_cvt_pk_bf16_f32 v24, v56, v57
    v_cvt_pk_bf16_f32 v28, v58, v59
    v_cvt_pk_bf16_f32 v29, v90, v91
    v_lshlrev_b32 v58, 16, v28
    v_and_b32 v59, 0xffff0000, v28
    v_mul_f32 v58, s52, v58
    v_mul_f32 v59, s52, v59
    v_exp_f32 v58, v58
    v_exp_f32 v59, v59
    v_lshlrev_b32 v90, 16, v29
    v_and_b32 v91, 0xffff0000, v29
    v_add_f32 v58, 1.0, v58
    v_add_f32 v59, 1.0, v59
    v_rcp_f32 v58, v58
    v_rcp_f32 v59, v59
    s_nop 0
    v_cvt_pk_bf16_f32 v28, v58, v59
    v_lshlrev_b32 v58, 16, v28
    v_and_b32 v59, 0xffff0000, v28
    v_mul_f32 v58, v58, v90
    v_mul_f32 v59, v59, v91
    v_cvt_pk_bf16_f32 v25, v58, v59
    ds_write_b64 v5, v[24:25] offset:0
    v_cvt_pk_bf16_f32 v28, v72, v73
    v_cvt_pk_bf16_f32 v29, v104, v105
    v_lshlrev_b32 v72, 16, v28
    v_and_b32 v73, 0xffff0000, v28
    v_mul_f32 v72, s52, v72
    v_mul_f32 v73, s52, v73
    v_exp_f32 v72, v72
    v_exp_f32 v73, v73
    v_lshlrev_b32 v104, 16, v29
    v_and_b32 v105, 0xffff0000, v29
    v_add_f32 v72, 1.0, v72
    v_add_f32 v73, 1.0, v73
    v_rcp_f32 v72, v72
    v_rcp_f32 v73, v73
    s_nop 0
    v_cvt_pk_bf16_f32 v28, v72, v73
    v_lshlrev_b32 v72, 16, v28
    v_and_b32 v73, 0xffff0000, v28
    v_mul_f32 v72, v72, v104
    v_mul_f32 v73, v73, v105
    v_cvt_pk_bf16_f32 v26, v72, v73
    v_cvt_pk_bf16_f32 v28, v74, v75
    v_cvt_pk_bf16_f32 v29, v106, v107
    v_lshlrev_b32 v74, 16, v28
    v_and_b32 v75, 0xffff0000, v28
    v_mul_f32 v74, s52, v74
    v_mul_f32 v75, s52, v75
    v_exp_f32 v74, v74
    v_exp_f32 v75, v75
    v_lshlrev_b32 v106, 16, v29
    v_and_b32 v107, 0xffff0000, v29
    v_add_f32 v74, 1.0, v74
    v_add_f32 v75, 1.0, v75
    v_rcp_f32 v74, v74
    v_rcp_f32 v75, v75
    s_nop 0
    v_cvt_pk_bf16_f32 v28, v74, v75
    v_lshlrev_b32 v74, 16, v28
    v_and_b32 v75, 0xffff0000, v28
    v_mul_f32 v74, v74, v106
    v_mul_f32 v75, v75, v107
    v_cvt_pk_bf16_f32 v27, v74, v75
    ds_write_b64 v5, v[26:27] offset:2048
    v_xor_b32 v5, 32, v4
    v_add_u32 v5, v5, v3
    v_cvt_pk_bf16_f32 v28, v60, v61
    v_cvt_pk_bf16_f32 v29, v92, v93
    v_lshlrev_b32 v60, 16, v28
    v_and_b32 v61, 0xffff0000, v28
    v_mul_f32 v60, s52, v60
    v_mul_f32 v61, s52, v61
    v_exp_f32 v60, v60
    v_exp_f32 v61, v61
    v_lshlrev_b32 v92, 16, v29
    v_and_b32 v93, 0xffff0000, v29
    v_add_f32 v60, 1.0, v60
    v_add_f32 v61, 1.0, v61
    v_rcp_f32 v60, v60
    v_rcp_f32 v61, v61
    s_nop 0
    v_cvt_pk_bf16_f32 v28, v60, v61
    v_lshlrev_b32 v60, 16, v28
    v_and_b32 v61, 0xffff0000, v28
    v_mul_f32 v60, v60, v92
    v_mul_f32 v61, v61, v93
    v_cvt_pk_bf16_f32 v20, v60, v61
    v_cvt_pk_bf16_f32 v28, v62, v63
    v_cvt_pk_bf16_f32 v29, v94, v95
    v_lshlrev_b32 v62, 16, v28
    v_and_b32 v63, 0xffff0000, v28
    v_mul_f32 v62, s52, v62
    v_mul_f32 v63, s52, v63
    v_exp_f32 v62, v62
    v_exp_f32 v63, v63
    v_lshlrev_b32 v94, 16, v29
    v_and_b32 v95, 0xffff0000, v29
    v_add_f32 v62, 1.0, v62
    v_add_f32 v63, 1.0, v63
    v_rcp_f32 v62, v62
    v_rcp_f32 v63, v63
    s_nop 0
    v_cvt_pk_bf16_f32 v28, v62, v63
    v_lshlrev_b32 v62, 16, v28
    v_and_b32 v63, 0xffff0000, v28
    v_mul_f32 v62, v62, v94
    v_mul_f32 v63, v63, v95
    v_cvt_pk_bf16_f32 v21, v62, v63
    ds_write_b64 v5, v[20:21] offset:0
    v_cvt_pk_bf16_f32 v28, v76, v77
    v_cvt_pk_bf16_f32 v29, v108, v109
    v_lshlrev_b32 v76, 16, v28
    v_and_b32 v77, 0xffff0000, v28
    v_mul_f32 v76, s52, v76
    v_mul_f32 v77, s52, v77
    v_exp_f32 v76, v76
    v_exp_f32 v77, v77
    v_lshlrev_b32 v108, 16, v29
    v_and_b32 v109, 0xffff0000, v29
    v_add_f32 v76, 1.0, v76
    v_add_f32 v77, 1.0, v77
    v_rcp_f32 v76, v76
    v_rcp_f32 v77, v77
    s_nop 0
    v_cvt_pk_bf16_f32 v28, v76, v77
    v_lshlrev_b32 v76, 16, v28
    v_and_b32 v77, 0xffff0000, v28
    v_mul_f32 v76, v76, v108
    v_mul_f32 v77, v77, v109
    v_cvt_pk_bf16_f32 v22, v76, v77
    v_cvt_pk_bf16_f32 v28, v78, v79
    v_cvt_pk_bf16_f32 v29, v110, v111
    v_lshlrev_b32 v78, 16, v28
    v_and_b32 v79, 0xffff0000, v28
    v_mul_f32 v78, s52, v78
    v_mul_f32 v79, s52, v79
    v_exp_f32 v78, v78
    v_exp_f32 v79, v79
    v_lshlrev_b32 v110, 16, v29
    v_and_b32 v111, 0xffff0000, v29
    v_add_f32 v78, 1.0, v78
    v_add_f32 v79, 1.0, v79
    v_rcp_f32 v78, v78
    v_rcp_f32 v79, v79
    s_nop 0
    v_cvt_pk_bf16_f32 v28, v78, v79
    v_lshlrev_b32 v78, 16, v28
    v_and_b32 v79, 0xffff0000, v28
    v_mul_f32 v78, v78, v110
    v_mul_f32 v79, v79, v111
    v_cvt_pk_bf16_f32 v23, v78, v79
    ds_write_b64 v5, v[22:23] offset:2048
    v_xor_b32 v5, 48, v4
    v_add_u32 v5, v5, v3
    v_cvt_pk_bf16_f32 v28, v64, v65
    v_cvt_pk_bf16_f32 v29, v96, v97
    v_lshlrev_b32 v64, 16, v28
    v_and_b32 v65, 0xffff0000, v28
    v_mul_f32 v64, s52, v64
    v_mul_f32 v65, s52, v65
    v_exp_f32 v64, v64
    v_exp_f32 v65, v65
    v_lshlrev_b32 v96, 16, v29
    v_and_b32 v97, 0xffff0000, v29
    v_add_f32 v64, 1.0, v64
    v_add_f32 v65, 1.0, v65
    v_rcp_f32 v64, v64
    v_rcp_f32 v65, v65
    s_nop 0
    v_cvt_pk_bf16_f32 v28, v64, v65
    v_lshlrev_b32 v64, 16, v28
    v_and_b32 v65, 0xffff0000, v28
    v_mul_f32 v64, v64, v96
    v_mul_f32 v65, v65, v97
    v_cvt_pk_bf16_f32 v24, v64, v65
    v_cvt_pk_bf16_f32 v28, v66, v67
    v_cvt_pk_bf16_f32 v29, v98, v99
    v_lshlrev_b32 v66, 16, v28
    v_and_b32 v67, 0xffff0000, v28
    v_mul_f32 v66, s52, v66
    v_mul_f32 v67, s52, v67
    v_exp_f32 v66, v66
    v_exp_f32 v67, v67
    v_lshlrev_b32 v98, 16, v29
    v_and_b32 v99, 0xffff0000, v29
    v_add_f32 v66, 1.0, v66
    v_add_f32 v67, 1.0, v67
    v_rcp_f32 v66, v66
    v_rcp_f32 v67, v67
    s_nop 0
    v_cvt_pk_bf16_f32 v28, v66, v67
    v_lshlrev_b32 v66, 16, v28
    v_and_b32 v67, 0xffff0000, v28
    v_mul_f32 v66, v66, v98
    v_mul_f32 v67, v67, v99
    v_cvt_pk_bf16_f32 v25, v66, v67
    ds_write_b64 v5, v[24:25] offset:0
    v_cvt_pk_bf16_f32 v28, v80, v81
    v_cvt_pk_bf16_f32 v29, v112, v113
    v_lshlrev_b32 v80, 16, v28
    v_and_b32 v81, 0xffff0000, v28
    v_mul_f32 v80, s52, v80
    v_mul_f32 v81, s52, v81
    v_exp_f32 v80, v80
    v_exp_f32 v81, v81
    v_lshlrev_b32 v112, 16, v29
    v_and_b32 v113, 0xffff0000, v29
    v_add_f32 v80, 1.0, v80
    v_add_f32 v81, 1.0, v81
    v_rcp_f32 v80, v80
    v_rcp_f32 v81, v81
    s_nop 0
    v_cvt_pk_bf16_f32 v28, v80, v81
    v_lshlrev_b32 v80, 16, v28
    v_and_b32 v81, 0xffff0000, v28
    v_mul_f32 v80, v80, v112
    v_mul_f32 v81, v81, v113
    v_cvt_pk_bf16_f32 v26, v80, v81
    v_cvt_pk_bf16_f32 v28, v82, v83
    v_cvt_pk_bf16_f32 v29, v114, v115
    v_lshlrev_b32 v82, 16, v28
    v_and_b32 v83, 0xffff0000, v28
    v_mul_f32 v82, s52, v82
    v_mul_f32 v83, s52, v83
    v_exp_f32 v82, v82
    v_exp_f32 v83, v83
    v_lshlrev_b32 v114, 16, v29
    v_and_b32 v115, 0xffff0000, v29
    v_add_f32 v82, 1.0, v82
    v_add_f32 v83, 1.0, v83
    v_rcp_f32 v82, v82
    v_rcp_f32 v83, v83
    s_nop 0
    v_cvt_pk_bf16_f32 v28, v82, v83
    v_lshlrev_b32 v82, 16, v28
    v_and_b32 v83, 0xffff0000, v28
    v_mul_f32 v82, v82, v114
    v_mul_f32 v83, v83, v115
    v_cvt_pk_bf16_f32 v27, v82, v83
    ds_write_b64 v5, v[26:27] offset:2048
    v_lshrrev_b32 v2, 2, v1
    v_lshlrev_b32 v2, 6, v2
    s_mul_i32 s30, s24, 4096
    v_add_u32 v2, s30, v2
    v_and_b32 v3, 3, v1
    v_lshrrev_b32 v4, 4, v1
    v_xor_b32 v3, v3, v4
    v_lshlrev_b32 v3, 4, v3
    v_xor_b32 v4, 0, v3
    v_add_u32 v12, v4, v2
    v_lshrrev_b32 v2, 2, v1
    s_mov_b32 s30, 3584
    v_mul_lo_u32 v2, v2, s30
    v_and_b32 v3, 3, v1
    v_lshl_add_u32 v10, v3, 4, v2
    s_waitcnt lgkmcnt(0)
    ds_read_b128 v[52:55], v12 offset:0
    ds_read_b128 v[56:59], v12 offset:1024
    ds_read_b128 v[60:63], v12 offset:2048
    ds_read_b128 v[64:67], v12 offset:3072
    s_waitcnt lgkmcnt(3)
    s_add_u32 s30, s50, 0
    buffer_store_dwordx4 v[52:55], v10, s[16:19], s30 offen
    s_waitcnt lgkmcnt(2)
    s_add_u32 s30, s50, 57344
    buffer_store_dwordx4 v[56:59], v10, s[16:19], s30 offen
    s_waitcnt lgkmcnt(1)
    s_add_u32 s30, s50, 114688
    buffer_store_dwordx4 v[60:63], v10, s[16:19], s30 offen
    s_waitcnt lgkmcnt(0)
    s_add_u32 s30, s50, 172032
    buffer_store_dwordx4 v[64:67], v10, s[16:19], s30 offen
L_end_43:
    s_endpgm
.globl down_kernel
.p2align 8
.type down_kernel,@function
down_kernel:
    s_cmp_ge_u32 s2, 256
    s_cbranch_scc1 L_end_44
    s_load_dwordx4 s[40:43], s[0:1], 72
    s_load_dwordx2 s[44:45], s[0:1], 96
    s_and_b32 s46, s2, 7
    s_lshl_b32 s46, s46, 2
    s_bfe_u32 s47, s2, 0x20003
    s_add_u32 s46, s46, s47
    s_lshl_b32 s47, s46, 6
    s_lshr_b32 s48, s2, 5
    s_lshl_b32 s48, s48, 6
    s_waitcnt lgkmcnt(0)
    s_add_u32 s4, s44, 104857600
    s_addc_u32 s5, s45, 0
    s_mov_b32 s6, 7340032
    s_mov_b32 s7, 0x00020000
    s_mov_b32 s8, s40
    s_mov_b32 s9, s41
    s_mov_b32 s10, 1835008
    s_mov_b32 s11, 0x00020000
    s_mov_b32 s16, s42
    s_mov_b32 s17, s43
    s_mov_b32 s18, 2097152
    s_mov_b32 s19, 0x00020000
    s_add_u32 s20, s44, 2097152
    s_addc_u32 s21, s45, 0
    s_mov_b32 s22, 2097152
    s_mov_b32 s23, 0x00020000
    v_and_b32 v1, 63, v0
    v_lshrrev_b32 v2, 6, v0
    s_nop 0
    v_readfirstlane_b32 s24, v2
    s_nop 3
    s_lshl_b32 s29, s24, 10
    s_and_b32 s30, s24, 1
    s_and_b32 s32, s24, 1
    s_lshr_b32 s33, s24, 1
    s_lshl_b32 s31, s30, 2
    v_lshrrev_b32 v2, 4, v1
    v_add_u32 v2, s31, v2
    v_and_b32 v2, 7, v2
    v_and_b32 v3, 7, v1
    v_xor_b32 v2, v2, v3
    v_lshlrev_b32 v2, 4, v2
    v_lshrrev_b32 v3, 3, v1
    s_mov_b32 s31, 3584
    v_mul_lo_u32 v3, v3, s31
    v_add_u32 v10, v2, v3
    v_lshrrev_b32 v2, 3, v1
    v_lshrrev_b32 v3, 1, v2
    v_and_b32 v3, 1, v3
    v_lshlrev_b32 v3, 2, v3
    v_and_b32 v4, 7, v1
    v_xor_b32 v3, v3, v4
    v_lshlrev_b32 v3, 4, v3
    s_mov_b32 s31, 1024
    v_mul_lo_u32 v2, v2, s31
    v_add_u32 v11, v2, v3
    s_mul_i32 s30, s24, 8
    s_add_u32 s30, s30, s47
    s_mul_i32 s25, s30, 3584
    s_mul_i32 s30, s24, 8
    s_mul_i32 s26, s30, 1024
    s_lshl_b32 s30, s48, 1
    s_add_u32 s26, s26, s30
    s_add_u32 m0, s29, 0
    s_add_u32 s30, s25, 0
    buffer_load_dwordx4 v10, s[4:7], s30 offen lds
    s_add_u32 m0, s29, 4096
    s_add_u32 s30, s25, 114688
    buffer_load_dwordx4 v10, s[4:7], s30 offen lds
    s_add_u32 s25, s25, 128
    s_add_u32 m0, s29, 8192
    s_add_u32 s30, s26, 0
    buffer_load_dwordx4 v11, s[8:11], s30 offen lds
    s_add_u32 m0, s29, 12288
    s_add_u32 s30, s26, 32768
    buffer_load_dwordx4 v11, s[8:11], s30 offen lds
    s_add_u32 s26, s26, 65536
    s_add_u32 m0, s29, 16384
    s_add_u32 s30, s25, 0
    buffer_load_dwordx4 v10, s[4:7], s30 offen lds
    s_add_u32 m0, s29, 20480
    s_add_u32 s30, s25, 114688
    buffer_load_dwordx4 v10, s[4:7], s30 offen lds
    s_add_u32 s25, s25, 128
    s_add_u32 m0, s29, 24576
    s_add_u32 s30, s26, 0
    buffer_load_dwordx4 v11, s[8:11], s30 offen lds
    s_add_u32 m0, s29, 28672
    s_add_u32 s30, s26, 32768
    buffer_load_dwordx4 v11, s[8:11], s30 offen lds
    s_add_u32 s26, s26, 65536
    s_add_u32 m0, s29, 32768
    s_add_u32 s30, s25, 0
    buffer_load_dwordx4 v10, s[4:7], s30 offen lds
    s_add_u32 m0, s29, 36864
    s_add_u32 s30, s25, 114688
    buffer_load_dwordx4 v10, s[4:7], s30 offen lds
    s_add_u32 s25, s25, 128
    s_add_u32 m0, s29, 40960
    s_add_u32 s30, s26, 0
    buffer_load_dwordx4 v11, s[8:11], s30 offen lds
    s_add_u32 m0, s29, 45056
    s_add_u32 s30, s26, 32768
    buffer_load_dwordx4 v11, s[8:11], s30 offen lds
    s_add_u32 s26, s26, 65536
    s_add_u32 m0, s29, 49152
    s_add_u32 s30, s25, 0
    buffer_load_dwordx4 v10, s[4:7], s30 offen lds
    s_add_u32 m0, s29, 53248
    s_add_u32 s30, s25, 114688
    buffer_load_dwordx4 v10, s[4:7], s30 offen lds
    s_add_u32 s25, s25, 128
    s_add_u32 m0, s29, 57344
    s_add_u32 s30, s26, 0
    buffer_load_dwordx4 v11, s[8:11], s30 offen lds
    s_add_u32 m0, s29, 61440
    s_add_u32 s30, s26, 32768
    buffer_load_dwordx4 v11, s[8:11], s30 offen lds
    s_add_u32 s26, s26, 65536
    s_add_u32 m0, s29, 65536
    s_add_u32 s30, s25, 0
    buffer_load_dwordx4 v10, s[4:7], s30 offen lds
    s_add_u32 m0, s29, 69632
    s_add_u32 s30, s25, 114688
    buffer_load_dwordx4 v10, s[4:7], s30 offen lds
    s_add_u32 s25, s25, 128
    s_add_u32 m0, s29, 73728
    s_add_u32 s30, s26, 0
    buffer_load_dwordx4 v11, s[8:11], s30 offen lds
    s_add_u32 m0, s29, 77824
    s_add_u32 s30, s26, 32768
    buffer_load_dwordx4 v11, s[8:11], s30 offen lds
    s_add_u32 s26, s26, 65536
    s_add_u32 m0, s29, 81920
    s_add_u32 s30, s25, 0
    buffer_load_dwordx4 v10, s[4:7], s30 offen lds
    s_add_u32 m0, s29, 86016
    s_add_u32 s30, s25, 114688
    buffer_load_dwordx4 v10, s[4:7], s30 offen lds
    s_add_u32 s25, s25, 128
    s_add_u32 m0, s29, 90112
    s_add_u32 s30, s26, 0
    buffer_load_dwordx4 v11, s[8:11], s30 offen lds
    s_add_u32 m0, s29, 94208
    s_add_u32 s30, s26, 32768
    buffer_load_dwordx4 v11, s[8:11], s30 offen lds
    s_add_u32 s26, s26, 65536
    s_add_u32 m0, s29, 98304
    s_add_u32 s30, s25, 0
    buffer_load_dwordx4 v10, s[4:7], s30 offen lds
    s_add_u32 m0, s29, 102400
    s_add_u32 s30, s25, 114688
    buffer_load_dwordx4 v10, s[4:7], s30 offen lds
    s_add_u32 s25, s25, 128
    s_add_u32 m0, s29, 106496
    s_add_u32 s30, s26, 0
    buffer_load_dwordx4 v11, s[8:11], s30 offen lds
    s_add_u32 m0, s29, 110592
    s_add_u32 s30, s26, 32768
    buffer_load_dwordx4 v11, s[8:11], s30 offen lds
    s_add_u32 s26, s26, 65536
    v_and_b32 v2, 31, v1
    s_mul_i32 s30, s32, 32
    v_add_u32 v2, s30, v2
    v_bfe_u32 v3, v2, 1, 3
    v_lshrrev_b32 v4, 5, v1
    v_xor_b32 v3, v3, v4
    v_lshlrev_b32 v2, 7, v2
    v_xor_b32 v5, 0, v3
    v_lshl_add_u32 v16, v5, 4, v2
    v_xor_b32 v5, 2, v3
    v_lshl_add_u32 v17, v5, 4, v2
    v_xor_b32 v5, 4, v3
    v_lshl_add_u32 v18, v5, 4, v2
    v_xor_b32 v5, 6, v3
    v_lshl_add_u32 v19, v5, 4, v2
    v_and_b32 v2, 15, v1
    v_lshrrev_b32 v3, 2, v2
    v_and_b32 v4, 3, v2
    v_lshrrev_b32 v5, 5, v1
    v_lshl_add_u32 v5, v5, 3, v3
    v_lshlrev_b32 v5, 7, v5
    v_and_b32 v6, 1, v4
    v_lshl_add_u32 v5, v6, 3, v5
    v_lshrrev_b32 v6, 1, v4
    v_bfe_u32 v7, v1, 4, 1
    v_lshl_add_u32 v6, v7, 1, v6
    v_lshl_add_u32 v5, v6, 4, v5
    v_lshrrev_b32 v3, 1, v3
    s_mul_i32 s30, s33, 1
    s_add_u32 s30, s30, 0
    v_xor_b32 v6, s30, v3
    v_lshl_add_u32 v6, v6, 6, v5
    v_add_u32 v12, 8192, v6
    s_waitcnt vmcnt(24)
    s_barrier
    ds_read_b64_tr_b16 v[20:21], v12 offset:0
    ds_read_b64_tr_b16 v[22:23], v12 offset:512
    ds_read_b128 v[28:31], v16 offset:0
    ds_read_b64_tr_b16 v[24:25], v12 offset:2048
    ds_read_b64_tr_b16 v[26:27], v12 offset:2560
    ds_read_b128 v[32:35], v17 offset:0
    s_waitcnt lgkmcnt(3)
    v_mfma_f32_32x32x16_bf16 v[36:51], v[20:23], v[28:31], 0
    s_add_u32 m0, s29, 114688
    s_add_u32 s30, s25, 0
    buffer_load_dwordx4 v10, s[4:7], s30 offen lds
    ds_read_b64_tr_b16 v[20:21], v12 offset:4096
    ds_read_b64_tr_b16 v[22:23], v12 offset:4608
    ds_read_b128 v[28:31], v18 offset:0
    s_waitcnt lgkmcnt(3)
    v_mfma_f32_32x32x16_bf16 v[36:51], v[24:27], v[32:35], v[36:51]
    s_add_u32 m0, s29, 118784
    s_add_u32 s30, s25, 114688
    buffer_load_dwordx4 v10, s[4:7], s30 offen lds
    s_add_u32 s25, s25, 128
    ds_read_b64_tr_b16 v[24:25], v12 offset:6144
    ds_read_b64_tr_b16 v[26:27], v12 offset:6656
    ds_read_b128 v[32:35], v19 offset:0
    s_waitcnt lgkmcnt(3)
    v_mfma_f32_32x32x16_bf16 v[36:51], v[20:23], v[28:31], v[36:51]
    s_add_u32 m0, s29, 122880
    s_add_u32 s30, s26, 0
    buffer_load_dwordx4 v11, s[8:11], s30 offen lds
    s_waitcnt lgkmcnt(0)
    s_add_u32 m0, s29, 126976
    s_add_u32 s30, s26, 32768
    buffer_load_dwordx4 v11, s[8:11], s30 offen lds
    s_add_u32 s26, s26, 65536
    v_add_u32 v12, 16384, v12
    v_add_u32 v16, 16384, v16
    v_add_u32 v17, 16384, v17
    v_add_u32 v18, 16384, v18
    v_add_u32 v19, 16384, v19
    s_waitcnt vmcnt(24)
    s_barrier
    ds_read_b64_tr_b16 v[20:21], v12 offset:0
    ds_read_b64_tr_b16 v[22:23], v12 offset:512
    ds_read_b128 v[28:31], v16 offset:0
    v_mfma_f32_32x32x16_bf16 v[36:51], v[24:27], v[32:35], v[36:51]
    ds_read_b64_tr_b16 v[24:25], v12 offset:2048
    ds_read_b64_tr_b16 v[26:27], v12 offset:2560
    ds_read_b128 v[32:35], v17 offset:0
    s_waitcnt lgkmcnt(3)
    v_mfma_f32_32x32x16_bf16 v[36:51], v[20:23], v[28:31], v[36:51]
    s_add_u32 m0, s29, 0
    s_add_u32 s30, s25, 0
    buffer_load_dwordx4 v10, s[4:7], s30 offen lds
    ds_read_b64_tr_b16 v[20:21], v12 offset:4096
    ds_read_b64_tr_b16 v[22:23], v12 offset:4608
    ds_read_b128 v[28:31], v18 offset:0
    s_waitcnt lgkmcnt(3)
    v_mfma_f32_32x32x16_bf16 v[36:51], v[24:27], v[32:35], v[36:51]
    s_add_u32 m0, s29, 4096
    s_add_u32 s30, s25, 114688
    buffer_load_dwordx4 v10, s[4:7], s30 offen lds
    s_add_u32 s25, s25, 128
    ds_read_b64_tr_b16 v[24:25], v12 offset:6144
    ds_read_b64_tr_b16 v[26:27], v12 offset:6656
    ds_read_b128 v[32:35], v19 offset:0
    s_waitcnt lgkmcnt(3)
    v_mfma_f32_32x32x16_bf16 v[36:51], v[20:23], v[28:31], v[36:51]
    s_add_u32 m0, s29, 8192
    s_add_u32 s30, s26, 0
    buffer_load_dwordx4 v11, s[8:11], s30 offen lds
    s_waitcnt lgkmcnt(0)
    s_add_u32 m0, s29, 12288
    s_add_u32 s30, s26, 32768
    buffer_load_dwordx4 v11, s[8:11], s30 offen lds
    s_add_u32 s26, s26, 65536
    v_add_u32 v12, 16384, v12
    v_add_u32 v16, 16384, v16
    v_add_u32 v17, 16384, v17
    v_add_u32 v18, 16384, v18
    v_add_u32 v19, 16384, v19
    s_waitcnt vmcnt(24)
    s_barrier
    ds_read_b64_tr_b16 v[20:21], v12 offset:0
    ds_read_b64_tr_b16 v[22:23], v12 offset:512
    ds_read_b128 v[28:31], v16 offset:0
    v_mfma_f32_32x32x16_bf16 v[36:51], v[24:27], v[32:35], v[36:51]
    ds_read_b64_tr_b16 v[24:25], v12 offset:2048
    ds_read_b64_tr_b16 v[26:27], v12 offset:2560
    ds_read_b128 v[32:35], v17 offset:0
    s_waitcnt lgkmcnt(3)
    v_mfma_f32_32x32x16_bf16 v[36:51], v[20:23], v[28:31], v[36:51]
    s_add_u32 m0, s29, 16384
    s_add_u32 s30, s25, 0
    buffer_load_dwordx4 v10, s[4:7], s30 offen lds
    ds_read_b64_tr_b16 v[20:21], v12 offset:4096
    ds_read_b64_tr_b16 v[22:23], v12 offset:4608
    ds_read_b128 v[28:31], v18 offset:0
    s_waitcnt lgkmcnt(3)
    v_mfma_f32_32x32x16_bf16 v[36:51], v[24:27], v[32:35], v[36:51]
    s_add_u32 m0, s29, 20480
    s_add_u32 s30, s25, 114688
    buffer_load_dwordx4 v10, s[4:7], s30 offen lds
    s_add_u32 s25, s25, 128
    ds_read_b64_tr_b16 v[24:25], v12 offset:6144
    ds_read_b64_tr_b16 v[26:27], v12 offset:6656
    ds_read_b128 v[32:35], v19 offset:0
    s_waitcnt lgkmcnt(3)
    v_mfma_f32_32x32x16_bf16 v[36:51], v[20:23], v[28:31], v[36:51]
    s_add_u32 m0, s29, 24576
    s_add_u32 s30, s26, 0
    buffer_load_dwordx4 v11, s[8:11], s30 offen lds
    s_waitcnt lgkmcnt(0)
    s_add_u32 m0, s29, 28672
    s_add_u32 s30, s26, 32768
    buffer_load_dwordx4 v11, s[8:11], s30 offen lds
    s_add_u32 s26, s26, 65536
    v_add_u32 v12, 16384, v12
    v_add_u32 v16, 16384, v16
    v_add_u32 v17, 16384, v17
    v_add_u32 v18, 16384, v18
    v_add_u32 v19, 16384, v19
    s_waitcnt vmcnt(24)
    s_barrier
    ds_read_b64_tr_b16 v[20:21], v12 offset:0
    ds_read_b64_tr_b16 v[22:23], v12 offset:512
    ds_read_b128 v[28:31], v16 offset:0
    v_mfma_f32_32x32x16_bf16 v[36:51], v[24:27], v[32:35], v[36:51]
    ds_read_b64_tr_b16 v[24:25], v12 offset:2048
    ds_read_b64_tr_b16 v[26:27], v12 offset:2560
    ds_read_b128 v[32:35], v17 offset:0
    s_waitcnt lgkmcnt(3)
    v_mfma_f32_32x32x16_bf16 v[36:51], v[20:23], v[28:31], v[36:51]
    s_add_u32 m0, s29, 32768
    s_add_u32 s30, s25, 0
    buffer_load_dwordx4 v10, s[4:7], s30 offen lds
    ds_read_b64_tr_b16 v[20:21], v12 offset:4096
    ds_read_b64_tr_b16 v[22:23], v12 offset:4608
    ds_read_b128 v[28:31], v18 offset:0
    s_waitcnt lgkmcnt(3)
    v_mfma_f32_32x32x16_bf16 v[36:51], v[24:27], v[32:35], v[36:51]
    s_add_u32 m0, s29, 36864
    s_add_u32 s30, s25, 114688
    buffer_load_dwordx4 v10, s[4:7], s30 offen lds
    s_add_u32 s25, s25, 128
    ds_read_b64_tr_b16 v[24:25], v12 offset:6144
    ds_read_b64_tr_b16 v[26:27], v12 offset:6656
    ds_read_b128 v[32:35], v19 offset:0
    s_waitcnt lgkmcnt(3)
    v_mfma_f32_32x32x16_bf16 v[36:51], v[20:23], v[28:31], v[36:51]
    s_add_u32 m0, s29, 40960
    s_add_u32 s30, s26, 0
    buffer_load_dwordx4 v11, s[8:11], s30 offen lds
    s_waitcnt lgkmcnt(0)
    s_add_u32 m0, s29, 45056
    s_add_u32 s30, s26, 32768
    buffer_load_dwordx4 v11, s[8:11], s30 offen lds
    s_add_u32 s26, s26, 65536
    v_add_u32 v12, 16384, v12
    v_add_u32 v16, 16384, v16
    v_add_u32 v17, 16384, v17
    v_add_u32 v18, 16384, v18
    v_add_u32 v19, 16384, v19
    s_waitcnt vmcnt(24)
    s_barrier
    ds_read_b64_tr_b16 v[20:21], v12 offset:0
    ds_read_b64_tr_b16 v[22:23], v12 offset:512
    ds_read_b128 v[28:31], v16 offset:0
    v_mfma_f32_32x32x16_bf16 v[36:51], v[24:27], v[32:35], v[36:51]
    ds_read_b64_tr_b16 v[24:25], v12 offset:2048
    ds_read_b64_tr_b16 v[26:27], v12 offset:2560
    ds_read_b128 v[32:35], v17 offset:0
    s_waitcnt lgkmcnt(3)
    v_mfma_f32_32x32x16_bf16 v[36:51], v[20:23], v[28:31], v[36:51]
    s_add_u32 m0, s29, 49152
    s_add_u32 s30, s25, 0
    buffer_load_dwordx4 v10, s[4:7], s30 offen lds
    ds_read_b64_tr_b16 v[20:21], v12 offset:4096
    ds_read_b64_tr_b16 v[22:23], v12 offset:4608
    ds_read_b128 v[28:31], v18 offset:0
    s_waitcnt lgkmcnt(3)
    v_mfma_f32_32x32x16_bf16 v[36:51], v[24:27], v[32:35], v[36:51]
    s_add_u32 m0, s29, 53248
    s_add_u32 s30, s25, 114688
    buffer_load_dwordx4 v10, s[4:7], s30 offen lds
    s_add_u32 s25, s25, 128
    ds_read_b64_tr_b16 v[24:25], v12 offset:6144
    ds_read_b64_tr_b16 v[26:27], v12 offset:6656
    ds_read_b128 v[32:35], v19 offset:0
    s_waitcnt lgkmcnt(3)
    v_mfma_f32_32x32x16_bf16 v[36:51], v[20:23], v[28:31], v[36:51]
    s_add_u32 m0, s29, 57344
    s_add_u32 s30, s26, 0
    buffer_load_dwordx4 v11, s[8:11], s30 offen lds
    s_waitcnt lgkmcnt(0)
    s_add_u32 m0, s29, 61440
    s_add_u32 s30, s26, 32768
    buffer_load_dwordx4 v11, s[8:11], s30 offen lds
    s_add_u32 s26, s26, 65536
    v_add_u32 v12, 16384, v12
    v_add_u32 v16, 16384, v16
    v_add_u32 v17, 16384, v17
    v_add_u32 v18, 16384, v18
    v_add_u32 v19, 16384, v19
    s_waitcnt vmcnt(24)
    s_barrier
    ds_read_b64_tr_b16 v[20:21], v12 offset:0
    ds_read_b64_tr_b16 v[22:23], v12 offset:512
    ds_read_b128 v[28:31], v16 offset:0
    v_mfma_f32_32x32x16_bf16 v[36:51], v[24:27], v[32:35], v[36:51]
    ds_read_b64_tr_b16 v[24:25], v12 offset:2048
    ds_read_b64_tr_b16 v[26:27], v12 offset:2560
    ds_read_b128 v[32:35], v17 offset:0
    s_waitcnt lgkmcnt(3)
    v_mfma_f32_32x32x16_bf16 v[36:51], v[20:23], v[28:31], v[36:51]
    s_add_u32 m0, s29, 65536
    s_add_u32 s30, s25, 0
    buffer_load_dwordx4 v10, s[4:7], s30 offen lds
    ds_read_b64_tr_b16 v[20:21], v12 offset:4096
    ds_read_b64_tr_b16 v[22:23], v12 offset:4608
    ds_read_b128 v[28:31], v18 offset:0
    s_waitcnt lgkmcnt(3)
    v_mfma_f32_32x32x16_bf16 v[36:51], v[24:27], v[32:35], v[36:51]
    s_add_u32 m0, s29, 69632
    s_add_u32 s30, s25, 114688
    buffer_load_dwordx4 v10, s[4:7], s30 offen lds
    s_add_u32 s25, s25, 128
    ds_read_b64_tr_b16 v[24:25], v12 offset:6144
    ds_read_b64_tr_b16 v[26:27], v12 offset:6656
    ds_read_b128 v[32:35], v19 offset:0
    s_waitcnt lgkmcnt(3)
    v_mfma_f32_32x32x16_bf16 v[36:51], v[20:23], v[28:31], v[36:51]
    s_add_u32 m0, s29, 73728
    s_add_u32 s30, s26, 0
    buffer_load_dwordx4 v11, s[8:11], s30 offen lds
    s_waitcnt lgkmcnt(0)
    s_add_u32 m0, s29, 77824
    s_add_u32 s30, s26, 32768
    buffer_load_dwordx4 v11, s[8:11], s30 offen lds
    s_add_u32 s26, s26, 65536
    v_add_u32 v12, 16384, v12
    v_add_u32 v16, 16384, v16
    v_add_u32 v17, 16384, v17
    v_add_u32 v18, 16384, v18
    v_add_u32 v19, 16384, v19
    s_waitcnt vmcnt(24)
    s_barrier
    ds_read_b64_tr_b16 v[20:21], v12 offset:0
    ds_read_b64_tr_b16 v[22:23], v12 offset:512
    ds_read_b128 v[28:31], v16 offset:0
    v_mfma_f32_32x32x16_bf16 v[36:51], v[24:27], v[32:35], v[36:51]
    ds_read_b64_tr_b16 v[24:25], v12 offset:2048
    ds_read_b64_tr_b16 v[26:27], v12 offset:2560
    ds_read_b128 v[32:35], v17 offset:0
    s_waitcnt lgkmcnt(3)
    v_mfma_f32_32x32x16_bf16 v[36:51], v[20:23], v[28:31], v[36:51]
    s_add_u32 m0, s29, 81920
    s_add_u32 s30, s25, 0
    buffer_load_dwordx4 v10, s[4:7], s30 offen lds
    ds_read_b64_tr_b16 v[20:21], v12 offset:4096
    ds_read_b64_tr_b16 v[22:23], v12 offset:4608
    ds_read_b128 v[28:31], v18 offset:0
    s_waitcnt lgkmcnt(3)
    v_mfma_f32_32x32x16_bf16 v[36:51], v[24:27], v[32:35], v[36:51]
    s_add_u32 m0, s29, 86016
    s_add_u32 s30, s25, 114688
    buffer_load_dwordx4 v10, s[4:7], s30 offen lds
    s_add_u32 s25, s25, 128
    ds_read_b64_tr_b16 v[24:25], v12 offset:6144
    ds_read_b64_tr_b16 v[26:27], v12 offset:6656
    ds_read_b128 v[32:35], v19 offset:0
    s_waitcnt lgkmcnt(3)
    v_mfma_f32_32x32x16_bf16 v[36:51], v[20:23], v[28:31], v[36:51]
    s_add_u32 m0, s29, 90112
    s_add_u32 s30, s26, 0
    buffer_load_dwordx4 v11, s[8:11], s30 offen lds
    s_waitcnt lgkmcnt(0)
    s_add_u32 m0, s29, 94208
    s_add_u32 s30, s26, 32768
    buffer_load_dwordx4 v11, s[8:11], s30 offen lds
    s_add_u32 s26, s26, 65536
    v_add_u32 v12, 16384, v12
    v_add_u32 v16, 16384, v16
    v_add_u32 v17, 16384, v17
    v_add_u32 v18, 16384, v18
    v_add_u32 v19, 16384, v19
    s_waitcnt vmcnt(24)
    s_barrier
    ds_read_b64_tr_b16 v[20:21], v12 offset:0
    ds_read_b64_tr_b16 v[22:23], v12 offset:512
    ds_read_b128 v[28:31], v16 offset:0
    v_mfma_f32_32x32x16_bf16 v[36:51], v[24:27], v[32:35], v[36:51]
    ds_read_b64_tr_b16 v[24:25], v12 offset:2048
    ds_read_b64_tr_b16 v[26:27], v12 offset:2560
    ds_read_b128 v[32:35], v17 offset:0
    s_waitcnt lgkmcnt(3)
    v_mfma_f32_32x32x16_bf16 v[36:51], v[20:23], v[28:31], v[36:51]
    s_add_u32 m0, s29, 98304
    s_add_u32 s30, s25, 0
    buffer_load_dwordx4 v10, s[4:7], s30 offen lds
    ds_read_b64_tr_b16 v[20:21], v12 offset:4096
    ds_read_b64_tr_b16 v[22:23], v12 offset:4608
    ds_read_b128 v[28:31], v18 offset:0
    s_waitcnt lgkmcnt(3)
    v_mfma_f32_32x32x16_bf16 v[36:51], v[24:27], v[32:35], v[36:51]
    s_add_u32 m0, s29, 102400
    s_add_u32 s30, s25, 114688
    buffer_load_dwordx4 v10, s[4:7], s30 offen lds
    s_add_u32 s25, s25, 128
    ds_read_b64_tr_b16 v[24:25], v12 offset:6144
    ds_read_b64_tr_b16 v[26:27], v12 offset:6656
    ds_read_b128 v[32:35], v19 offset:0
    s_waitcnt lgkmcnt(3)
    v_mfma_f32_32x32x16_bf16 v[36:51], v[20:23], v[28:31], v[36:51]
    s_add_u32 m0, s29, 106496
    s_add_u32 s30, s26, 0
    buffer_load_dwordx4 v11, s[8:11], s30 offen lds
    s_waitcnt lgkmcnt(0)
    s_add_u32 m0, s29, 110592
    s_add_u32 s30, s26, 32768
    buffer_load_dwordx4 v11, s[8:11], s30 offen lds
    s_add_u32 s26, s26, 65536
    v_add_u32 v12, 4294852608, v12
    v_add_u32 v16, 4294852608, v16
    v_add_u32 v17, 4294852608, v17
    v_add_u32 v18, 4294852608, v18
    v_add_u32 v19, 4294852608, v19
    s_waitcnt vmcnt(24)
    s_barrier
    ds_read_b64_tr_b16 v[20:21], v12 offset:0
    ds_read_b64_tr_b16 v[22:23], v12 offset:512
    ds_read_b128 v[28:31], v16 offset:0
    v_mfma_f32_32x32x16_bf16 v[36:51], v[24:27], v[32:35], v[36:51]
    ds_read_b64_tr_b16 v[24:25], v12 offset:2048
    ds_read_b64_tr_b16 v[26:27], v12 offset:2560
    ds_read_b128 v[32:35], v17 offset:0
    s_waitcnt lgkmcnt(3)
    v_mfma_f32_32x32x16_bf16 v[36:51], v[20:23], v[28:31], v[36:51]
    s_add_u32 m0, s29, 114688
    s_add_u32 s30, s25, 0
    buffer_load_dwordx4 v10, s[4:7], s30 offen lds
    ds_read_b64_tr_b16 v[20:21], v12 offset:4096
    ds_read_b64_tr_b16 v[22:23], v12 offset:4608
    ds_read_b128 v[28:31], v18 offset:0
    s_waitcnt lgkmcnt(3)
    v_mfma_f32_32x32x16_bf16 v[36:51], v[24:27], v[32:35], v[36:51]
    s_add_u32 m0, s29, 118784
    s_add_u32 s30, s25, 114688
    buffer_load_dwordx4 v10, s[4:7], s30 offen lds
    s_add_u32 s25, s25, 128
    ds_read_b64_tr_b16 v[24:25], v12 offset:6144
    ds_read_b64_tr_b16 v[26:27], v12 offset:6656
    ds_read_b128 v[32:35], v19 offset:0
    s_waitcnt lgkmcnt(3)
    v_mfma_f32_32x32x16_bf16 v[36:51], v[20:23], v[28:31], v[36:51]
    s_add_u32 m0, s29, 122880
    s_add_u32 s30, s26, 0
    buffer_load_dwordx4 v11, s[8:11], s30 offen lds
    s_waitcnt lgkmcnt(0)
    s_add_u32 m0, s29, 126976
    s_add_u32 s30, s26, 32768
    buffer_load_dwordx4 v11, s[8:11], s30 offen lds
    s_add_u32 s26, s26, 65536
    v_add_u32 v12, 16384, v12
    v_add_u32 v16, 16384, v16
    v_add_u32 v17, 16384, v17
    v_add_u32 v18, 16384, v18
    v_add_u32 v19, 16384, v19
    s_waitcnt vmcnt(24)
    s_barrier
    ds_read_b64_tr_b16 v[20:21], v12 offset:0
    ds_read_b64_tr_b16 v[22:23], v12 offset:512
    ds_read_b128 v[28:31], v16 offset:0
    v_mfma_f32_32x32x16_bf16 v[36:51], v[24:27], v[32:35], v[36:51]
    ds_read_b64_tr_b16 v[24:25], v12 offset:2048
    ds_read_b64_tr_b16 v[26:27], v12 offset:2560
    ds_read_b128 v[32:35], v17 offset:0
    s_waitcnt lgkmcnt(3)
    v_mfma_f32_32x32x16_bf16 v[36:51], v[20:23], v[28:31], v[36:51]
    s_add_u32 m0, s29, 0
    s_add_u32 s30, s25, 0
    buffer_load_dwordx4 v10, s[4:7], s30 offen lds
    ds_read_b64_tr_b16 v[20:21], v12 offset:4096
    ds_read_b64_tr_b16 v[22:23], v12 offset:4608
    ds_read_b128 v[28:31], v18 offset:0
    s_waitcnt lgkmcnt(3)
    v_mfma_f32_32x32x16_bf16 v[36:51], v[24:27], v[32:35], v[36:51]
    s_add_u32 m0, s29, 4096
    s_add_u32 s30, s25, 114688
    buffer_load_dwordx4 v10, s[4:7], s30 offen lds
    s_add_u32 s25, s25, 128
    ds_read_b64_tr_b16 v[24:25], v12 offset:6144
    ds_read_b64_tr_b16 v[26:27], v12 offset:6656
    ds_read_b128 v[32:35], v19 offset:0
    s_waitcnt lgkmcnt(3)
    v_mfma_f32_32x32x16_bf16 v[36:51], v[20:23], v[28:31], v[36:51]
    s_add_u32 m0, s29, 8192
    s_add_u32 s30, s26, 0
    buffer_load_dwordx4 v11, s[8:11], s30 offen lds
    s_waitcnt lgkmcnt(0)
    s_add_u32 m0, s29, 12288
    s_add_u32 s30, s26, 32768
    buffer_load_dwordx4 v11, s[8:11], s30 offen lds
    s_add_u32 s26, s26, 65536
    v_add_u32 v12, 16384, v12
    v_add_u32 v16, 16384, v16
    v_add_u32 v17, 16384, v17
    v_add_u32 v18, 16384, v18
    v_add_u32 v19, 16384, v19
    s_waitcnt vmcnt(24)
    s_barrier
    ds_read_b64_tr_b16 v[20:21], v12 offset:0
    ds_read_b64_tr_b16 v[22:23], v12 offset:512
    ds_read_b128 v[28:31], v16 offset:0
    v_mfma_f32_32x32x16_bf16 v[36:51], v[24:27], v[32:35], v[36:51]
    ds_read_b64_tr_b16 v[24:25], v12 offset:2048
    ds_read_b64_tr_b16 v[26:27], v12 offset:2560
    ds_read_b128 v[32:35], v17 offset:0
    s_waitcnt lgkmcnt(3)
    v_mfma_f32_32x32x16_bf16 v[36:51], v[20:23], v[28:31], v[36:51]
    s_add_u32 m0, s29, 16384
    s_add_u32 s30, s25, 0
    buffer_load_dwordx4 v10, s[4:7], s30 offen lds
    ds_read_b64_tr_b16 v[20:21], v12 offset:4096
    ds_read_b64_tr_b16 v[22:23], v12 offset:4608
    ds_read_b128 v[28:31], v18 offset:0
    s_waitcnt lgkmcnt(3)
    v_mfma_f32_32x32x16_bf16 v[36:51], v[24:27], v[32:35], v[36:51]
    s_add_u32 m0, s29, 20480
    s_add_u32 s30, s25, 114688
    buffer_load_dwordx4 v10, s[4:7], s30 offen lds
    s_add_u32 s25, s25, 128
    ds_read_b64_tr_b16 v[24:25], v12 offset:6144
    ds_read_b64_tr_b16 v[26:27], v12 offset:6656
    ds_read_b128 v[32:35], v19 offset:0
    s_waitcnt lgkmcnt(3)
    v_mfma_f32_32x32x16_bf16 v[36:51], v[20:23], v[28:31], v[36:51]
    s_add_u32 m0, s29, 24576
    s_add_u32 s30, s26, 0
    buffer_load_dwordx4 v11, s[8:11], s30 offen lds
    s_waitcnt lgkmcnt(0)
    s_add_u32 m0, s29, 28672
    s_add_u32 s30, s26, 32768
    buffer_load_dwordx4 v11, s[8:11], s30 offen lds
    s_add_u32 s26, s26, 65536
    v_add_u32 v12, 16384, v12
    v_add_u32 v16, 16384, v16
    v_add_u32 v17, 16384, v17
    v_add_u32 v18, 16384, v18
    v_add_u32 v19, 16384, v19
    s_waitcnt vmcnt(24)
    s_barrier
    ds_read_b64_tr_b16 v[20:21], v12 offset:0
    ds_read_b64_tr_b16 v[22:23], v12 offset:512
    ds_read_b128 v[28:31], v16 offset:0
    v_mfma_f32_32x32x16_bf16 v[36:51], v[24:27], v[32:35], v[36:51]
    ds_read_b64_tr_b16 v[24:25], v12 offset:2048
    ds_read_b64_tr_b16 v[26:27], v12 offset:2560
    ds_read_b128 v[32:35], v17 offset:0
    s_waitcnt lgkmcnt(3)
    v_mfma_f32_32x32x16_bf16 v[36:51], v[20:23], v[28:31], v[36:51]
    s_add_u32 m0, s29, 32768
    s_add_u32 s30, s25, 0
    buffer_load_dwordx4 v10, s[4:7], s30 offen lds
    ds_read_b64_tr_b16 v[20:21], v12 offset:4096
    ds_read_b64_tr_b16 v[22:23], v12 offset:4608
    ds_read_b128 v[28:31], v18 offset:0
    s_waitcnt lgkmcnt(3)
    v_mfma_f32_32x32x16_bf16 v[36:51], v[24:27], v[32:35], v[36:51]
    s_add_u32 m0, s29, 36864
    s_add_u32 s30, s25, 114688
    buffer_load_dwordx4 v10, s[4:7], s30 offen lds
    s_add_u32 s25, s25, 128
    ds_read_b64_tr_b16 v[24:25], v12 offset:6144
    ds_read_b64_tr_b16 v[26:27], v12 offset:6656
    ds_read_b128 v[32:35], v19 offset:0
    s_waitcnt lgkmcnt(3)
    v_mfma_f32_32x32x16_bf16 v[36:51], v[20:23], v[28:31], v[36:51]
    s_add_u32 m0, s29, 40960
    s_add_u32 s30, s26, 0
    buffer_load_dwordx4 v11, s[8:11], s30 offen lds
    s_waitcnt lgkmcnt(0)
    s_add_u32 m0, s29, 45056
    s_add_u32 s30, s26, 32768
    buffer_load_dwordx4 v11, s[8:11], s30 offen lds
    s_add_u32 s26, s26, 65536
    v_add_u32 v12, 16384, v12
    v_add_u32 v16, 16384, v16
    v_add_u32 v17, 16384, v17
    v_add_u32 v18, 16384, v18
    v_add_u32 v19, 16384, v19
    s_waitcnt vmcnt(24)
    s_barrier
    ds_read_b64_tr_b16 v[20:21], v12 offset:0
    ds_read_b64_tr_b16 v[22:23], v12 offset:512
    ds_read_b128 v[28:31], v16 offset:0
    v_mfma_f32_32x32x16_bf16 v[36:51], v[24:27], v[32:35], v[36:51]
    ds_read_b64_tr_b16 v[24:25], v12 offset:2048
    ds_read_b64_tr_b16 v[26:27], v12 offset:2560
    ds_read_b128 v[32:35], v17 offset:0
    s_waitcnt lgkmcnt(3)
    v_mfma_f32_32x32x16_bf16 v[36:51], v[20:23], v[28:31], v[36:51]
    s_add_u32 m0, s29, 49152
    s_add_u32 s30, s25, 0
    buffer_load_dwordx4 v10, s[4:7], s30 offen lds
    ds_read_b64_tr_b16 v[20:21], v12 offset:4096
    ds_read_b64_tr_b16 v[22:23], v12 offset:4608
    ds_read_b128 v[28:31], v18 offset:0
    s_waitcnt lgkmcnt(3)
    v_mfma_f32_32x32x16_bf16 v[36:51], v[24:27], v[32:35], v[36:51]
    s_add_u32 m0, s29, 53248
    s_add_u32 s30, s25, 114688
    buffer_load_dwordx4 v10, s[4:7], s30 offen lds
    s_add_u32 s25, s25, 128
    ds_read_b64_tr_b16 v[24:25], v12 offset:6144
    ds_read_b64_tr_b16 v[26:27], v12 offset:6656
    ds_read_b128 v[32:35], v19 offset:0
    s_waitcnt lgkmcnt(3)
    v_mfma_f32_32x32x16_bf16 v[36:51], v[20:23], v[28:31], v[36:51]
    s_add_u32 m0, s29, 57344
    s_add_u32 s30, s26, 0
    buffer_load_dwordx4 v11, s[8:11], s30 offen lds
    s_waitcnt lgkmcnt(0)
    s_add_u32 m0, s29, 61440
    s_add_u32 s30, s26, 32768
    buffer_load_dwordx4 v11, s[8:11], s30 offen lds
    s_add_u32 s26, s26, 65536
    v_add_u32 v12, 16384, v12
    v_add_u32 v16, 16384, v16
    v_add_u32 v17, 16384, v17
    v_add_u32 v18, 16384, v18
    v_add_u32 v19, 16384, v19
    s_waitcnt vmcnt(24)
    s_barrier
    ds_read_b64_tr_b16 v[20:21], v12 offset:0
    ds_read_b64_tr_b16 v[22:23], v12 offset:512
    ds_read_b128 v[28:31], v16 offset:0
    v_mfma_f32_32x32x16_bf16 v[36:51], v[24:27], v[32:35], v[36:51]
    ds_read_b64_tr_b16 v[24:25], v12 offset:2048
    ds_read_b64_tr_b16 v[26:27], v12 offset:2560
    ds_read_b128 v[32:35], v17 offset:0
    s_waitcnt lgkmcnt(3)
    v_mfma_f32_32x32x16_bf16 v[36:51], v[20:23], v[28:31], v[36:51]
    s_add_u32 m0, s29, 65536
    s_add_u32 s30, s25, 0
    buffer_load_dwordx4 v10, s[4:7], s30 offen lds
    ds_read_b64_tr_b16 v[20:21], v12 offset:4096
    ds_read_b64_tr_b16 v[22:23], v12 offset:4608
    ds_read_b128 v[28:31], v18 offset:0
    s_waitcnt lgkmcnt(3)
    v_mfma_f32_32x32x16_bf16 v[36:51], v[24:27], v[32:35], v[36:51]
    s_add_u32 m0, s29, 69632
    s_add_u32 s30, s25, 114688
    buffer_load_dwordx4 v10, s[4:7], s30 offen lds
    s_add_u32 s25, s25, 128
    ds_read_b64_tr_b16 v[24:25], v12 offset:6144
    ds_read_b64_tr_b16 v[26:27], v12 offset:6656
    ds_read_b128 v[32:35], v19 offset:0
    s_waitcnt lgkmcnt(3)
    v_mfma_f32_32x32x16_bf16 v[36:51], v[20:23], v[28:31], v[36:51]
    s_add_u32 m0, s29, 73728
    s_add_u32 s30, s26, 0
    buffer_load_dwordx4 v11, s[8:11], s30 offen lds
    s_waitcnt lgkmcnt(0)
    s_add_u32 m0, s29, 77824
    s_add_u32 s30, s26, 32768
    buffer_load_dwordx4 v11, s[8:11], s30 offen lds
    s_add_u32 s26, s26, 65536
    v_add_u32 v12, 16384, v12
    v_add_u32 v16, 16384, v16
    v_add_u32 v17, 16384, v17
    v_add_u32 v18, 16384, v18
    v_add_u32 v19, 16384, v19
    s_waitcnt vmcnt(24)
    s_barrier
    ds_read_b64_tr_b16 v[20:21], v12 offset:0
    ds_read_b64_tr_b16 v[22:23], v12 offset:512
    ds_read_b128 v[28:31], v16 offset:0
    v_mfma_f32_32x32x16_bf16 v[36:51], v[24:27], v[32:35], v[36:51]
    ds_read_b64_tr_b16 v[24:25], v12 offset:2048
    ds_read_b64_tr_b16 v[26:27], v12 offset:2560
    ds_read_b128 v[32:35], v17 offset:0
    s_waitcnt lgkmcnt(3)
    v_mfma_f32_32x32x16_bf16 v[36:51], v[20:23], v[28:31], v[36:51]
    s_add_u32 m0, s29, 81920
    s_add_u32 s30, s25, 0
    buffer_load_dwordx4 v10, s[4:7], s30 offen lds
    ds_read_b64_tr_b16 v[20:21], v12 offset:4096
    ds_read_b64_tr_b16 v[22:23], v12 offset:4608
    ds_read_b128 v[28:31], v18 offset:0
    s_waitcnt lgkmcnt(3)
    v_mfma_f32_32x32x16_bf16 v[36:51], v[24:27], v[32:35], v[36:51]
    s_add_u32 m0, s29, 86016
    s_add_u32 s30, s25, 114688
    buffer_load_dwordx4 v10, s[4:7], s30 offen lds
    s_add_u32 s25, s25, 128
    ds_read_b64_tr_b16 v[24:25], v12 offset:6144
    ds_read_b64_tr_b16 v[26:27], v12 offset:6656
    ds_read_b128 v[32:35], v19 offset:0
    s_waitcnt lgkmcnt(3)
    v_mfma_f32_32x32x16_bf16 v[36:51], v[20:23], v[28:31], v[36:51]
    s_add_u32 m0, s29, 90112
    s_add_u32 s30, s26, 0
    buffer_load_dwordx4 v11, s[8:11], s30 offen lds
    s_waitcnt lgkmcnt(0)
    s_add_u32 m0, s29, 94208
    s_add_u32 s30, s26, 32768
    buffer_load_dwordx4 v11, s[8:11], s30 offen lds
    s_add_u32 s26, s26, 65536
    v_add_u32 v12, 16384, v12
    v_add_u32 v16, 16384, v16
    v_add_u32 v17, 16384, v17
    v_add_u32 v18, 16384, v18
    v_add_u32 v19, 16384, v19
    s_waitcnt vmcnt(24)
    s_barrier
    ds_read_b64_tr_b16 v[20:21], v12 offset:0
    ds_read_b64_tr_b16 v[22:23], v12 offset:512
    ds_read_b128 v[28:31], v16 offset:0
    v_mfma_f32_32x32x16_bf16 v[36:51], v[24:27], v[32:35], v[36:51]
    ds_read_b64_tr_b16 v[24:25], v12 offset:2048
    ds_read_b64_tr_b16 v[26:27], v12 offset:2560
    ds_read_b128 v[32:35], v17 offset:0
    s_waitcnt lgkmcnt(3)
    v_mfma_f32_32x32x16_bf16 v[36:51], v[20:23], v[28:31], v[36:51]
    s_add_u32 m0, s29, 98304
    s_add_u32 s30, s25, 0
    buffer_load_dwordx4 v10, s[4:7], s30 offen lds
    ds_read_b64_tr_b16 v[20:21], v12 offset:4096
    ds_read_b64_tr_b16 v[22:23], v12 offset:4608
    ds_read_b128 v[28:31], v18 offset:0
    s_waitcnt lgkmcnt(3)
    v_mfma_f32_32x32x16_bf16 v[36:51], v[24:27], v[32:35], v[36:51]
    s_add_u32 m0, s29, 102400
    s_add_u32 s30, s25, 114688
    buffer_load_dwordx4 v10, s[4:7], s30 offen lds
    s_add_u32 s25, s25, 128
    ds_read_b64_tr_b16 v[24:25], v12 offset:6144
    ds_read_b64_tr_b16 v[26:27], v12 offset:6656
    ds_read_b128 v[32:35], v19 offset:0
    s_waitcnt lgkmcnt(3)
    v_mfma_f32_32x32x16_bf16 v[36:51], v[20:23], v[28:31], v[36:51]
    s_add_u32 m0, s29, 106496
    s_add_u32 s30, s26, 0
    buffer_load_dwordx4 v11, s[8:11], s30 offen lds
    s_waitcnt lgkmcnt(0)
    s_add_u32 m0, s29, 110592
    s_add_u32 s30, s26, 32768
    buffer_load_dwordx4 v11, s[8:11], s30 offen lds
    s_add_u32 s26, s26, 65536
    v_add_u32 v12, 4294852608, v12
    v_add_u32 v16, 4294852608, v16
    v_add_u32 v17, 4294852608, v17
    v_add_u32 v18, 4294852608, v18
    v_add_u32 v19, 4294852608, v19
    s_waitcnt vmcnt(24)
    s_barrier
    ds_read_b64_tr_b16 v[20:21], v12 offset:0
    ds_read_b64_tr_b16 v[22:23], v12 offset:512
    ds_read_b128 v[28:31], v16 offset:0
    v_mfma_f32_32x32x16_bf16 v[36:51], v[24:27], v[32:35], v[36:51]
    ds_read_b64_tr_b16 v[24:25], v12 offset:2048
    ds_read_b64_tr_b16 v[26:27], v12 offset:2560
    ds_read_b128 v[32:35], v17 offset:0
    s_waitcnt lgkmcnt(3)
    v_mfma_f32_32x32x16_bf16 v[36:51], v[20:23], v[28:31], v[36:51]
    s_add_u32 m0, s29, 114688
    s_add_u32 s30, s25, 0
    buffer_load_dwordx4 v10, s[4:7], s30 offen lds
    ds_read_b64_tr_b16 v[20:21], v12 offset:4096
    ds_read_b64_tr_b16 v[22:23], v12 offset:4608
    ds_read_b128 v[28:31], v18 offset:0
    s_waitcnt lgkmcnt(3)
    v_mfma_f32_32x32x16_bf16 v[36:51], v[24:27], v[32:35], v[36:51]
    s_add_u32 m0, s29, 118784
    s_add_u32 s30, s25, 114688
    buffer_load_dwordx4 v10, s[4:7], s30 offen lds
    s_add_u32 s25, s25, 128
    ds_read_b64_tr_b16 v[24:25], v12 offset:6144
    ds_read_b64_tr_b16 v[26:27], v12 offset:6656
    ds_read_b128 v[32:35], v19 offset:0
    s_waitcnt lgkmcnt(3)
    v_mfma_f32_32x32x16_bf16 v[36:51], v[20:23], v[28:31], v[36:51]
    s_add_u32 m0, s29, 122880
    s_add_u32 s30, s26, 0
    buffer_load_dwordx4 v11, s[8:11], s30 offen lds
    s_waitcnt lgkmcnt(0)
    s_add_u32 m0, s29, 126976
    s_add_u32 s30, s26, 32768
    buffer_load_dwordx4 v11, s[8:11], s30 offen lds
    s_add_u32 s26, s26, 65536
    v_add_u32 v12, 16384, v12
    v_add_u32 v16, 16384, v16
    v_add_u32 v17, 16384, v17
    v_add_u32 v18, 16384, v18
    v_add_u32 v19, 16384, v19
    s_waitcnt vmcnt(24)
    s_barrier
    ds_read_b64_tr_b16 v[20:21], v12 offset:0
    ds_read_b64_tr_b16 v[22:23], v12 offset:512
    ds_read_b128 v[28:31], v16 offset:0
    v_mfma_f32_32x32x16_bf16 v[36:51], v[24:27], v[32:35], v[36:51]
    ds_read_b64_tr_b16 v[24:25], v12 offset:2048
    ds_read_b64_tr_b16 v[26:27], v12 offset:2560
    ds_read_b128 v[32:35], v17 offset:0
    s_waitcnt lgkmcnt(3)
    v_mfma_f32_32x32x16_bf16 v[36:51], v[20:23], v[28:31], v[36:51]
    s_add_u32 m0, s29, 0
    s_add_u32 s30, s25, 0
    buffer_load_dwordx4 v10, s[4:7], s30 offen lds
    ds_read_b64_tr_b16 v[20:21], v12 offset:4096
    ds_read_b64_tr_b16 v[22:23], v12 offset:4608
    ds_read_b128 v[28:31], v18 offset:0
    s_waitcnt lgkmcnt(3)
    v_mfma_f32_32x32x16_bf16 v[36:51], v[24:27], v[32:35], v[36:51]
    s_add_u32 m0, s29, 4096
    s_add_u32 s30, s25, 114688
    buffer_load_dwordx4 v10, s[4:7], s30 offen lds
    s_add_u32 s25, s25, 128
    ds_read_b64_tr_b16 v[24:25], v12 offset:6144
    ds_read_b64_tr_b16 v[26:27], v12 offset:6656
    ds_read_b128 v[32:35], v19 offset:0
    s_waitcnt lgkmcnt(3)
    v_mfma_f32_32x32x16_bf16 v[36:51], v[20:23], v[28:31], v[36:51]
    s_add_u32 m0, s29, 8192
    s_add_u32 s30, s26, 0
    buffer_load_dwordx4 v11, s[8:11], s30 offen lds
    s_waitcnt lgkmcnt(0)
    s_add_u32 m0, s29, 12288
    s_add_u32 s30, s26, 32768
    buffer_load_dwordx4 v11, s[8:11], s30 offen lds
    s_add_u32 s26, s26, 65536
    v_add_u32 v12, 16384, v12
    v_add_u32 v16, 16384, v16
    v_add_u32 v17, 16384, v17
    v_add_u32 v18, 16384, v18
    v_add_u32 v19, 16384, v19
    s_waitcnt vmcnt(24)
    s_barrier
    ds_read_b64_tr_b16 v[20:21], v12 offset:0
    ds_read_b64_tr_b16 v[22:23], v12 offset:512
    ds_read_b128 v[28:31], v16 offset:0
    v_mfma_f32_32x32x16_bf16 v[36:51], v[24:27], v[32:35], v[36:51]
    ds_read_b64_tr_b16 v[24:25], v12 offset:2048
    ds_read_b64_tr_b16 v[26:27], v12 offset:2560
    ds_read_b128 v[32:35], v17 offset:0
    s_waitcnt lgkmcnt(3)
    v_mfma_f32_32x32x16_bf16 v[36:51], v[20:23], v[28:31], v[36:51]
    s_add_u32 m0, s29, 16384
    s_add_u32 s30, s25, 0
    buffer_load_dwordx4 v10, s[4:7], s30 offen lds
    ds_read_b64_tr_b16 v[20:21], v12 offset:4096
    ds_read_b64_tr_b16 v[22:23], v12 offset:4608
    ds_read_b128 v[28:31], v18 offset:0
    s_waitcnt lgkmcnt(3)
    v_mfma_f32_32x32x16_bf16 v[36:51], v[24:27], v[32:35], v[36:51]
    s_add_u32 m0, s29, 20480
    s_add_u32 s30, s25, 114688
    buffer_load_dwordx4 v10, s[4:7], s30 offen lds
    s_add_u32 s25, s25, 128
    ds_read_b64_tr_b16 v[24:25], v12 offset:6144
    ds_read_b64_tr_b16 v[26:27], v12 offset:6656
    ds_read_b128 v[32:35], v19 offset:0
    s_waitcnt lgkmcnt(3)
    v_mfma_f32_32x32x16_bf16 v[36:51], v[20:23], v[28:31], v[36:51]
    s_add_u32 m0, s29, 24576
    s_add_u32 s30, s26, 0
    buffer_load_dwordx4 v11, s[8:11], s30 offen lds
    s_waitcnt lgkmcnt(0)
    s_add_u32 m0, s29, 28672
    s_add_u32 s30, s26, 32768
    buffer_load_dwordx4 v11, s[8:11], s30 offen lds
    s_add_u32 s26, s26, 65536
    v_add_u32 v12, 16384, v12
    v_add_u32 v16, 16384, v16
    v_add_u32 v17, 16384, v17
    v_add_u32 v18, 16384, v18
    v_add_u32 v19, 16384, v19
    s_waitcnt vmcnt(24)
    s_barrier
    ds_read_b64_tr_b16 v[20:21], v12 offset:0
    ds_read_b64_tr_b16 v[22:23], v12 offset:512
    ds_read_b128 v[28:31], v16 offset:0
    v_mfma_f32_32x32x16_bf16 v[36:51], v[24:27], v[32:35], v[36:51]
    ds_read_b64_tr_b16 v[24:25], v12 offset:2048
    ds_read_b64_tr_b16 v[26:27], v12 offset:2560
    ds_read_b128 v[32:35], v17 offset:0
    s_waitcnt lgkmcnt(3)
    v_mfma_f32_32x32x16_bf16 v[36:51], v[20:23], v[28:31], v[36:51]
    s_add_u32 m0, s29, 32768
    s_add_u32 s30, s25, 0
    buffer_load_dwordx4 v10, s[4:7], s30 offen lds
    ds_read_b64_tr_b16 v[20:21], v12 offset:4096
    ds_read_b64_tr_b16 v[22:23], v12 offset:4608
    ds_read_b128 v[28:31], v18 offset:0
    s_waitcnt lgkmcnt(3)
    v_mfma_f32_32x32x16_bf16 v[36:51], v[24:27], v[32:35], v[36:51]
    s_add_u32 m0, s29, 36864
    s_add_u32 s30, s25, 114688
    buffer_load_dwordx4 v10, s[4:7], s30 offen lds
    s_add_u32 s25, s25, 128
    ds_read_b64_tr_b16 v[24:25], v12 offset:6144
    ds_read_b64_tr_b16 v[26:27], v12 offset:6656
    ds_read_b128 v[32:35], v19 offset:0
    s_waitcnt lgkmcnt(3)
    v_mfma_f32_32x32x16_bf16 v[36:51], v[20:23], v[28:31], v[36:51]
    s_add_u32 m0, s29, 40960
    s_add_u32 s30, s26, 0
    buffer_load_dwordx4 v11, s[8:11], s30 offen lds
    s_waitcnt lgkmcnt(0)
    s_add_u32 m0, s29, 45056
    s_add_u32 s30, s26, 32768
    buffer_load_dwordx4 v11, s[8:11], s30 offen lds
    s_add_u32 s26, s26, 65536
    v_add_u32 v12, 16384, v12
    v_add_u32 v16, 16384, v16
    v_add_u32 v17, 16384, v17
    v_add_u32 v18, 16384, v18
    v_add_u32 v19, 16384, v19
    s_waitcnt vmcnt(24)
    s_barrier
    ds_read_b64_tr_b16 v[20:21], v12 offset:0
    ds_read_b64_tr_b16 v[22:23], v12 offset:512
    ds_read_b128 v[28:31], v16 offset:0
    v_mfma_f32_32x32x16_bf16 v[36:51], v[24:27], v[32:35], v[36:51]
    ds_read_b64_tr_b16 v[24:25], v12 offset:2048
    ds_read_b64_tr_b16 v[26:27], v12 offset:2560
    ds_read_b128 v[32:35], v17 offset:0
    s_waitcnt lgkmcnt(3)
    v_mfma_f32_32x32x16_bf16 v[36:51], v[20:23], v[28:31], v[36:51]
    s_add_u32 m0, s29, 49152
    s_add_u32 s30, s25, 0
    buffer_load_dwordx4 v10, s[4:7], s30 offen lds
    ds_read_b64_tr_b16 v[20:21], v12 offset:4096
    ds_read_b64_tr_b16 v[22:23], v12 offset:4608
    ds_read_b128 v[28:31], v18 offset:0
    s_waitcnt lgkmcnt(3)
    v_mfma_f32_32x32x16_bf16 v[36:51], v[24:27], v[32:35], v[36:51]
    s_add_u32 m0, s29, 53248
    s_add_u32 s30, s25, 114688
    buffer_load_dwordx4 v10, s[4:7], s30 offen lds
    s_add_u32 s25, s25, 128
    ds_read_b64_tr_b16 v[24:25], v12 offset:6144
    ds_read_b64_tr_b16 v[26:27], v12 offset:6656
    ds_read_b128 v[32:35], v19 offset:0
    s_waitcnt lgkmcnt(3)
    v_mfma_f32_32x32x16_bf16 v[36:51], v[20:23], v[28:31], v[36:51]
    s_add_u32 m0, s29, 57344
    s_add_u32 s30, s26, 0
    buffer_load_dwordx4 v11, s[8:11], s30 offen lds
    s_waitcnt lgkmcnt(0)
    s_add_u32 m0, s29, 61440
    s_add_u32 s30, s26, 32768
    buffer_load_dwordx4 v11, s[8:11], s30 offen lds
    s_add_u32 s26, s26, 65536
    v_add_u32 v12, 16384, v12
    v_add_u32 v16, 16384, v16
    v_add_u32 v17, 16384, v17
    v_add_u32 v18, 16384, v18
    v_add_u32 v19, 16384, v19
    s_waitcnt vmcnt(24)
    s_barrier
    ds_read_b64_tr_b16 v[20:21], v12 offset:0
    ds_read_b64_tr_b16 v[22:23], v12 offset:512
    ds_read_b128 v[28:31], v16 offset:0
    v_mfma_f32_32x32x16_bf16 v[36:51], v[24:27], v[32:35], v[36:51]
    ds_read_b64_tr_b16 v[24:25], v12 offset:2048
    ds_read_b64_tr_b16 v[26:27], v12 offset:2560
    ds_read_b128 v[32:35], v17 offset:0
    s_waitcnt lgkmcnt(3)
    v_mfma_f32_32x32x16_bf16 v[36:51], v[20:23], v[28:31], v[36:51]
    ds_read_b64_tr_b16 v[20:21], v12 offset:4096
    ds_read_b64_tr_b16 v[22:23], v12 offset:4608
    ds_read_b128 v[28:31], v18 offset:0
    s_waitcnt lgkmcnt(3)
    v_mfma_f32_32x32x16_bf16 v[36:51], v[24:27], v[32:35], v[36:51]
    ds_read_b64_tr_b16 v[24:25], v12 offset:6144
    ds_read_b64_tr_b16 v[26:27], v12 offset:6656
    ds_read_b128 v[32:35], v19 offset:0
    s_waitcnt lgkmcnt(3)
    v_mfma_f32_32x32x16_bf16 v[36:51], v[20:23], v[28:31], v[36:51]
    s_waitcnt lgkmcnt(0)
    v_add_u32 v12, 16384, v12
    v_add_u32 v16, 16384, v16
    v_add_u32 v17, 16384, v17
    v_add_u32 v18, 16384, v18
    v_add_u32 v19, 16384, v19
    s_waitcnt vmcnt(20)
    s_barrier
    ds_read_b64_tr_b16 v[20:21], v12 offset:0
    ds_read_b64_tr_b16 v[22:23], v12 offset:512
    ds_read_b128 v[28:31], v16 offset:0
    v_mfma_f32_32x32x16_bf16 v[36:51], v[24:27], v[32:35], v[36:51]
    ds_read_b64_tr_b16 v[24:25], v12 offset:2048
    ds_read_b64_tr_b16 v[26:27], v12 offset:2560
    ds_read_b128 v[32:35], v17 offset:0
    s_waitcnt lgkmcnt(3)
    v_mfma_f32_32x32x16_bf16 v[36:51], v[20:23], v[28:31], v[36:51]
    ds_read_b64_tr_b16 v[20:21], v12 offset:4096
    ds_read_b64_tr_b16 v[22:23], v12 offset:4608
    ds_read_b128 v[28:31], v18 offset:0
    s_waitcnt lgkmcnt(3)
    v_mfma_f32_32x32x16_bf16 v[36:51], v[24:27], v[32:35], v[36:51]
    ds_read_b64_tr_b16 v[24:25], v12 offset:6144
    ds_read_b64_tr_b16 v[26:27], v12 offset:6656
    ds_read_b128 v[32:35], v19 offset:0
    s_waitcnt lgkmcnt(3)
    v_mfma_f32_32x32x16_bf16 v[36:51], v[20:23], v[28:31], v[36:51]
    s_waitcnt lgkmcnt(0)
    v_add_u32 v12, 16384, v12
    v_add_u32 v16, 16384, v16
    v_add_u32 v17, 16384, v17
    v_add_u32 v18, 16384, v18
    v_add_u32 v19, 16384, v19
    s_waitcnt vmcnt(16)
    s_barrier
    ds_read_b64_tr_b16 v[20:21], v12 offset:0
    ds_read_b64_tr_b16 v[22:23], v12 offset:512
    ds_read_b128 v[28:31], v16 offset:0
    v_mfma_f32_32x32x16_bf16 v[36:51], v[24:27], v[32:35], v[36:51]
    ds_read_b64_tr_b16 v[24:25], v12 offset:2048
    ds_read_b64_tr_b16 v[26:27], v12 offset:2560
    ds_read_b128 v[32:35], v17 offset:0
    s_waitcnt lgkmcnt(3)
    v_mfma_f32_32x32x16_bf16 v[36:51], v[20:23], v[28:31], v[36:51]
    ds_read_b64_tr_b16 v[20:21], v12 offset:4096
    ds_read_b64_tr_b16 v[22:23], v12 offset:4608
    ds_read_b128 v[28:31], v18 offset:0
    s_waitcnt lgkmcnt(3)
    v_mfma_f32_32x32x16_bf16 v[36:51], v[24:27], v[32:35], v[36:51]
    ds_read_b64_tr_b16 v[24:25], v12 offset:6144
    ds_read_b64_tr_b16 v[26:27], v12 offset:6656
    ds_read_b128 v[32:35], v19 offset:0
    s_waitcnt lgkmcnt(3)
    v_mfma_f32_32x32x16_bf16 v[36:51], v[20:23], v[28:31], v[36:51]
    s_waitcnt lgkmcnt(0)
    v_add_u32 v12, 4294852608, v12
    v_add_u32 v16, 4294852608, v16
    v_add_u32 v17, 4294852608, v17
    v_add_u32 v18, 4294852608, v18
    v_add_u32 v19, 4294852608, v19
    s_waitcnt vmcnt(12)
    s_barrier
    ds_read_b64_tr_b16 v[20:21], v12 offset:0
    ds_read_b64_tr_b16 v[22:23], v12 offset:512
    ds_read_b128 v[28:31], v16 offset:0
    v_mfma_f32_32x32x16_bf16 v[36:51], v[24:27], v[32:35], v[36:51]
    ds_read_b64_tr_b16 v[24:25], v12 offset:2048
    ds_read_b64_tr_b16 v[26:27], v12 offset:2560
    ds_read_b128 v[32:35], v17 offset:0
    s_waitcnt lgkmcnt(3)
    v_mfma_f32_32x32x16_bf16 v[36:51], v[20:23], v[28:31], v[36:51]
    ds_read_b64_tr_b16 v[20:21], v12 offset:4096
    ds_read_b64_tr_b16 v[22:23], v12 offset:4608
    ds_read_b128 v[28:31], v18 offset:0
    s_waitcnt lgkmcnt(3)
    v_mfma_f32_32x32x16_bf16 v[36:51], v[24:27], v[32:35], v[36:51]
    ds_read_b64_tr_b16 v[24:25], v12 offset:6144
    ds_read_b64_tr_b16 v[26:27], v12 offset:6656
    ds_read_b128 v[32:35], v19 offset:0
    s_waitcnt lgkmcnt(3)
    v_mfma_f32_32x32x16_bf16 v[36:51], v[20:23], v[28:31], v[36:51]
    s_waitcnt lgkmcnt(0)
    v_add_u32 v12, 16384, v12
    v_add_u32 v16, 16384, v16
    v_add_u32 v17, 16384, v17
    v_add_u32 v18, 16384, v18
    v_add_u32 v19, 16384, v19
    s_waitcnt vmcnt(8)
    s_barrier
    ds_read_b64_tr_b16 v[20:21], v12 offset:0
    ds_read_b64_tr_b16 v[22:23], v12 offset:512
    ds_read_b128 v[28:31], v16 offset:0
    v_mfma_f32_32x32x16_bf16 v[36:51], v[24:27], v[32:35], v[36:51]
    ds_read_b64_tr_b16 v[24:25], v12 offset:2048
    ds_read_b64_tr_b16 v[26:27], v12 offset:2560
    ds_read_b128 v[32:35], v17 offset:0
    s_waitcnt lgkmcnt(3)
    v_mfma_f32_32x32x16_bf16 v[36:51], v[20:23], v[28:31], v[36:51]
    ds_read_b64_tr_b16 v[20:21], v12 offset:4096
    ds_read_b64_tr_b16 v[22:23], v12 offset:4608
    ds_read_b128 v[28:31], v18 offset:0
    s_waitcnt lgkmcnt(3)
    v_mfma_f32_32x32x16_bf16 v[36:51], v[24:27], v[32:35], v[36:51]
    ds_read_b64_tr_b16 v[24:25], v12 offset:6144
    ds_read_b64_tr_b16 v[26:27], v12 offset:6656
    ds_read_b128 v[32:35], v19 offset:0
    s_waitcnt lgkmcnt(3)
    v_mfma_f32_32x32x16_bf16 v[36:51], v[20:23], v[28:31], v[36:51]
    s_waitcnt lgkmcnt(0)
    v_add_u32 v12, 16384, v12
    v_add_u32 v16, 16384, v16
    v_add_u32 v17, 16384, v17
    v_add_u32 v18, 16384, v18
    v_add_u32 v19, 16384, v19
    s_waitcnt vmcnt(4)
    s_barrier
    ds_read_b64_tr_b16 v[20:21], v12 offset:0
    ds_read_b64_tr_b16 v[22:23], v12 offset:512
    ds_read_b128 v[28:31], v16 offset:0
    v_mfma_f32_32x32x16_bf16 v[36:51], v[24:27], v[32:35], v[36:51]
    ds_read_b64_tr_b16 v[24:25], v12 offset:2048
    ds_read_b64_tr_b16 v[26:27], v12 offset:2560
    ds_read_b128 v[32:35], v17 offset:0
    s_waitcnt lgkmcnt(3)
    v_mfma_f32_32x32x16_bf16 v[36:51], v[20:23], v[28:31], v[36:51]
    ds_read_b64_tr_b16 v[20:21], v12 offset:4096
    ds_read_b64_tr_b16 v[22:23], v12 offset:4608
    ds_read_b128 v[28:31], v18 offset:0
    s_waitcnt lgkmcnt(3)
    v_mfma_f32_32x32x16_bf16 v[36:51], v[24:27], v[32:35], v[36:51]
    ds_read_b64_tr_b16 v[24:25], v12 offset:6144
    ds_read_b64_tr_b16 v[26:27], v12 offset:6656
    ds_read_b128 v[32:35], v19 offset:0
    s_waitcnt lgkmcnt(3)
    v_mfma_f32_32x32x16_bf16 v[36:51], v[20:23], v[28:31], v[36:51]
    s_waitcnt lgkmcnt(0)
    v_add_u32 v12, 16384, v12
    v_add_u32 v16, 16384, v16
    v_add_u32 v17, 16384, v17
    v_add_u32 v18, 16384, v18
    v_add_u32 v19, 16384, v19
    s_waitcnt vmcnt(0)
    s_barrier
    ds_read_b64_tr_b16 v[20:21], v12 offset:0
    ds_read_b64_tr_b16 v[22:23], v12 offset:512
    ds_read_b128 v[28:31], v16 offset:0
    v_mfma_f32_32x32x16_bf16 v[36:51], v[24:27], v[32:35], v[36:51]
    ds_read_b64_tr_b16 v[24:25], v12 offset:2048
    ds_read_b64_tr_b16 v[26:27], v12 offset:2560
    ds_read_b128 v[32:35], v17 offset:0
    s_waitcnt lgkmcnt(3)
    v_mfma_f32_32x32x16_bf16 v[36:51], v[20:23], v[28:31], v[36:51]
    ds_read_b64_tr_b16 v[20:21], v12 offset:4096
    ds_read_b64_tr_b16 v[22:23], v12 offset:4608
    ds_read_b128 v[28:31], v18 offset:0
    s_waitcnt lgkmcnt(3)
    v_mfma_f32_32x32x16_bf16 v[36:51], v[24:27], v[32:35], v[36:51]
    ds_read_b64_tr_b16 v[24:25], v12 offset:6144
    ds_read_b64_tr_b16 v[26:27], v12 offset:6656
    ds_read_b128 v[32:35], v19 offset:0
    s_waitcnt lgkmcnt(3)
    v_mfma_f32_32x32x16_bf16 v[36:51], v[20:23], v[28:31], v[36:51]
    s_waitcnt lgkmcnt(0)
    v_mfma_f32_32x32x16_bf16 v[36:51], v[24:27], v[32:35], v[36:51]
    s_mul_i32 s50, s32, 32
    s_add_u32 s50, s50, s47
    s_lshl_b32 s50, s50, 10
    s_lshl_b32 s51, s33, 5
    s_add_u32 s51, s51, s48
    s_lshl_b32 s51, s51, 1
    s_add_u32 s50, s50, s51
    s_barrier
    v_and_b32 v2, 31, v1
    v_lshlrev_b32 v3, 6, v2
    v_lshrrev_b32 v4, 5, v1
    v_lshl_add_u32 v3, v4, 3, v3
    s_mul_i32 s30, s24, 2048
    v_add_u32 v3, s30, v3
    v_bfe_u32 v4, v2, 2, 2
    v_lshlrev_b32 v4, 4, v4
    v_xor_b32 v5, 0, v4
    v_add_u32 v5, v5, v3
    v_cvt_pk_bf16_f32 v20, v36, v37
    v_cvt_pk_bf16_f32 v21, v38, v39
    ds_write_b64 v5, v[20:21] offset:0
    v_xor_b32 v5, 16, v4
    v_add_u32 v5, v5, v3
    v_cvt_pk_bf16_f32 v22, v40, v41
    v_cvt_pk_bf16_f32 v23, v42, v43
    ds_write_b64 v5, v[22:23] offset:0
    v_xor_b32 v5, 32, v4
    v_add_u32 v5, v5, v3
    v_cvt_pk_bf16_f32 v24, v44, v45
    v_cvt_pk_bf16_f32 v25, v46, v47
    ds_write_b64 v5, v[24:25] offset:0
    v_xor_b32 v5, 48, v4
    v_add_u32 v5, v5, v3
    v_cvt_pk_bf16_f32 v26, v48, v49
    v_cvt_pk_bf16_f32 v27, v50, v51
    ds_write_b64 v5, v[26:27] offset:0
    v_lshrrev_b32 v2, 2, v1
    v_lshlrev_b32 v2, 6, v2
    s_mul_i32 s30, s24, 2048
    v_add_u32 v2, s30, v2
    v_and_b32 v3, 3, v1
    v_lshrrev_b32 v4, 4, v1
    v_xor_b32 v3, v3, v4
    v_lshlrev_b32 v3, 4, v3
    v_xor_b32 v4, 0, v3
    v_add_u32 v12, v4, v2
    v_lshrrev_b32 v2, 2, v1
    s_mov_b32 s30, 1024
    v_mul_lo_u32 v2, v2, s30
    v_and_b32 v3, 3, v1
    v_lshl_add_u32 v10, v3, 4, v2
    s_add_u32 s30, s50, 0
    buffer_load_dwordx4 v[44:47], v10, s[20:23], s30 offen
    s_add_u32 s30, s50, 16384
    buffer_load_dwordx4 v[48:51], v10, s[20:23], s30 offen
    s_waitcnt lgkmcnt(0)
    ds_read_b128 v[36:39], v12 offset:0
    ds_read_b128 v[40:43], v12 offset:1024
    s_waitcnt vmcnt(0) lgkmcnt(0)
    v_lshlrev_b32 v2, 16, v36
    v_and_b32 v3, 0xffff0000, v36
    v_lshlrev_b32 v4, 16, v44
    v_and_b32 v5, 0xffff0000, v44
    v_add_f32 v2, v2, v4
    v_add_f32 v3, v3, v5
    v_cvt_pk_bf16_f32 v36, v2, v3
    v_lshlrev_b32 v2, 16, v37
    v_and_b32 v3, 0xffff0000, v37
    v_lshlrev_b32 v4, 16, v45
    v_and_b32 v5, 0xffff0000, v45
    v_add_f32 v2, v2, v4
    v_add_f32 v3, v3, v5
    v_cvt_pk_bf16_f32 v37, v2, v3
    v_lshlrev_b32 v2, 16, v38
    v_and_b32 v3, 0xffff0000, v38
    v_lshlrev_b32 v4, 16, v46
    v_and_b32 v5, 0xffff0000, v46
    v_add_f32 v2, v2, v4
    v_add_f32 v3, v3, v5
    v_cvt_pk_bf16_f32 v38, v2, v3
    v_lshlrev_b32 v2, 16, v39
    v_and_b32 v3, 0xffff0000, v39
    v_lshlrev_b32 v4, 16, v47
    v_and_b32 v5, 0xffff0000, v47
    v_add_f32 v2, v2, v4
    v_add_f32 v3, v3, v5
    v_cvt_pk_bf16_f32 v39, v2, v3
    v_lshlrev_b32 v2, 16, v40
    v_and_b32 v3, 0xffff0000, v40
    v_lshlrev_b32 v4, 16, v48
    v_and_b32 v5, 0xffff0000, v48
    v_add_f32 v2, v2, v4
    v_add_f32 v3, v3, v5
    v_cvt_pk_bf16_f32 v40, v2, v3
    v_lshlrev_b32 v2, 16, v41
    v_and_b32 v3, 0xffff0000, v41
    v_lshlrev_b32 v4, 16, v49
    v_and_b32 v5, 0xffff0000, v49
    v_add_f32 v2, v2, v4
    v_add_f32 v3, v3, v5
    v_cvt_pk_bf16_f32 v41, v2, v3
    v_lshlrev_b32 v2, 16, v42
    v_and_b32 v3, 0xffff0000, v42
    v_lshlrev_b32 v4, 16, v50
    v_and_b32 v5, 0xffff0000, v50
    v_add_f32 v2, v2, v4
    v_add_f32 v3, v3, v5
    v_cvt_pk_bf16_f32 v42, v2, v3
    v_lshlrev_b32 v2, 16, v43
    v_and_b32 v3, 0xffff0000, v43
    v_lshlrev_b32 v4, 16, v51
    v_and_b32 v5, 0xffff0000, v51
    v_add_f32 v2, v2, v4
    v_add_f32 v3, v3, v5
    v_cvt_pk_bf16_f32 v43, v2, v3
    s_add_u32 s30, s50, 0
    buffer_store_dwordx4 v[36:39], v10, s[16:19], s30 offen
    s_add_u32 s30, s50, 16384
    buffer_store_dwordx4 v[40:43], v10, s[16:19], s30 offen
L_end_44:
    s_endpgm
.section .rodata,"a"
.p2align 6
.amdhsa_kernel kv_kernel
  .amdhsa_next_free_vgpr 224
  .amdhsa_next_free_sgpr 102
  .amdhsa_accum_offset 224
  .amdhsa_group_segment_fixed_size 0
  .amdhsa_kernarg_size 104
  .amdhsa_user_sgpr_count 2
  .amdhsa_user_sgpr_kernarg_segment_ptr 1
  .amdhsa_system_sgpr_workgroup_id_x 1
.end_amdhsa_kernel
.p2align 6
.amdhsa_kernel attn_kernel
  .amdhsa_next_free_vgpr 256
  .amdhsa_next_free_sgpr 102
  .amdhsa_accum_offset 256
  .amdhsa_group_segment_fixed_size 0
  .amdhsa_kernarg_size 104
  .amdhsa_user_sgpr_count 2
  .amdhsa_user_sgpr_kernarg_segment_ptr 1
  .amdhsa_system_sgpr_workgroup_id_x 1
.end_amdhsa_kernel
.p2align 6
.amdhsa_kernel oproj_kernel
  .amdhsa_next_free_vgpr 76
  .amdhsa_next_free_sgpr 102
  .amdhsa_accum_offset 76
  .amdhsa_group_segment_fixed_size 0
  .amdhsa_kernarg_size 104
  .amdhsa_user_sgpr_count 2
  .amdhsa_user_sgpr_kernarg_segment_ptr 1
  .amdhsa_system_sgpr_workgroup_id_x 1
.end_amdhsa_kernel
.p2align 6
.amdhsa_kernel redln_kernel
  .amdhsa_next_free_vgpr 48
  .amdhsa_next_free_sgpr 102
  .amdhsa_accum_offset 48
  .amdhsa_group_segment_fixed_size 0
  .amdhsa_kernarg_size 104
  .amdhsa_user_sgpr_count 2
  .amdhsa_user_sgpr_kernarg_segment_ptr 1
  .amdhsa_system_sgpr_workgroup_id_x 1
.end_amdhsa_kernel
.p2align 6
.amdhsa_kernel glu_kernel
  .amdhsa_next_free_vgpr 116
  .amdhsa_next_free_sgpr 102
  .amdhsa_accum_offset 116
  .amdhsa_group_segment_fixed_size 0
  .amdhsa_kernarg_size 104
  .amdhsa_user_sgpr_count 2
  .amdhsa_user_sgpr_kernarg_segment_ptr 1
  .amdhsa_system_sgpr_workgroup_id_x 1
.end_amdhsa_kernel
.p2align 6
.amdhsa_kernel down_kernel
  .amdhsa_next_free_vgpr 52
  .amdhsa_next_free_sgpr 102
  .amdhsa_accum_offset 52
  .amdhsa_group_segment_fixed_size 0
  .amdhsa_kernarg_size 104
  .amdhsa_user_sgpr_count 2
  .amdhsa_user_sgpr_kernarg_segment_ptr 1
  .amdhsa_system_sgpr_workgroup_id_x 1
.end_amdhsa_kernel
```
